```python
import torch

def _softmax(x, axis=-1):
    return torch.softmax(x, dim=axis)
def _gelu(x):
    return torch.nn.functional.gelu(x, approximate="tanh")
def _silu(x):
    return torch.nn.functional.silu(x)
def _sigmoid(x):
    return torch.sigmoid(x)
def _layernorm(x, axis=-1, eps=1e-5):
    m = x.mean(dim=axis, keepdim=True)
    v = x.var(dim=axis, keepdim=True, unbiased=False)
    return (x - m) / torch.sqrt(v + eps)
def _scatter_add(tgt, idx, src, axis=0):
    return tgt.clone().index_add_(axis, idx, src)
def _segment_sum(src, seg, n):
    out = torch.zeros((n,) + src.shape[1:], dtype=src.dtype)
    return out.index_add_(0, seg, src)
def _pad(x, pw):
    flat = tuple(v for pair in reversed(pw) for v in pair)
    return torch.nn.functional.pad(x, flat)

kernel_name = 'sequential_preLN__softmax_full_mha__glu_gated_glu__prompt'

def setup_inputs():

    _w = (lambda a: (lambda t: t.to(torch.bfloat16) if t.is_floating_point() else t)(torch.as_tensor(a)))
    def _A_setup():
        B, S, D = 1, 2048, 640
        return {
            "x": _w((lambda *s: torch.randn(*s, dtype=torch.bfloat16) * 0.05)(B, S, D)),
            "wqkv": _w((lambda *s: torch.randn(*s, dtype=torch.bfloat16) * 0.05)(D, 3 * D)),
            "wo": _w((lambda *s: torch.randn(*s, dtype=torch.bfloat16) * 0.05)(D, D)),
        }
    _A_in = _A_setup()

    def _B_setup():
        B, S, D, F = 1, 2048, 640, 1536
        return {
            "x": _w((lambda *s: torch.randn(*s, dtype=torch.bfloat16) * 0.05)(B, S, D)),
            "w_gate": _w((lambda *s: torch.randn(*s, dtype=torch.bfloat16) * 0.05)(D, F)),
            "w_up": _w((lambda *s: torch.randn(*s, dtype=torch.bfloat16) * 0.05)(D, F)),
            "w_down": _w((lambda *s: torch.randn(*s, dtype=torch.bfloat16) * 0.05)(F, D)),
        }
    _B_in = _B_setup()

    return {
        "A_x": _A_in["x"],
        "A_wqkv": _A_in["wqkv"],
        "A_wo": _A_in["wo"],
        "B_x": _B_in["x"],
        "B_w_gate": _B_in["w_gate"],
        "B_w_up": _B_in["w_up"],
        "B_w_down": _B_in["w_down"],
    }

def reference(A_x, A_wqkv, A_wo, B_x, B_w_gate, B_w_up, B_w_down):
    def _A_ref(x, wqkv, wo):
        B, S, D = x.shape
        H = 32; Dh = D // H
        qkv = (lambda x, *d: x.permute(*d))((x @ wqkv).reshape(B, S, 3, H, Dh), 2, 0, 3, 1, 4)
        q, k, v = qkv[0], qkv[1], qkv[2]
        scale = Dh ** -0.5
        scores = torch.einsum("bhqd,bhkd->bhqk", q, k) * scale
        p = _softmax(scores, axis=-1)
        o = torch.einsum("bhqk,bhkd->bhqd", p, v)
        return (lambda x, *d: x.permute(*d))(o, 0, 2, 1, 3).reshape(B, S, D) @ wo

    def _B_ref(x, w_gate, w_up, w_down):
        g = torch.einsum("bsd,df->bsf", x, w_gate)
        u = torch.einsum("bsd,df->bsf", x, w_up)
        h = _sigmoid(g) * u
        return torch.einsum("bsf,fd->bsd", h, w_down)

    x = A_x
    h = x + _A_ref(_layernorm(x, axis=-1), A_wqkv, A_wo)
    h2 = h + _B_ref(_layernorm(h, axis=-1), B_w_gate, B_w_up, B_w_down)
    return h2
```

```asm
; @launch grid=(256,1,1) block=(512,1,1) lds=163840
.amdgcn_target "amdgcn-amd-amdhsa--gfx950"
.text
.globl sequential_preLN__softmax_full_mha__glu_gated_glu__prompt_kernel
.p2align 8
.type sequential_preLN__softmax_full_mha__glu_gated_glu__prompt_kernel,@function
sequential_preLN__softmax_full_mha__glu_gated_glu__prompt_kernel:
    s_cmp_ge_u32 s2, 256
    s_cbranch_scc1 L_end
    s_load_dwordx4 s[4:7], s[0:1], 0
    s_load_dwordx2 s[8:9], s[0:1], 72
    s_load_dwordx2 s[44:45], s[0:1], 64
    s_load_dwordx8 s[48:55], s[0:1], 32
    s_and_b32 s10, s2, 7
    s_lshr_b32 s11, s2, 3
    v_lshrrev_b32 v1, 6, v0
    v_and_b32 v0, 63, v0
    s_nop 0
    v_readfirstlane_b32 s47, v1
    s_nop 3
    s_and_b32 s3, s47, 3
    s_cmp_lt_u32 s47, 4
    s_cbranch_scc1 L_compute
    s_lshr_b32 s12, s10, 1
    s_lshl_b32 s12, s12, 2
    s_and_b32 s13, s11, 3
    s_add_u32 s12, s12, s13
    s_and_b32 s13, s10, 1
    s_lshl_b32 s13, s13, 3
    s_lshr_b32 s14, s11, 2
    s_add_u32 s13, s13, s14
    s_mul_i32 s36, s12, 3
    s_add_u32 s36, s36, s13
    s_mul_i32 s37, s36, 6554
    s_lshr_b32 s37, s37, 16
    s_mul_i32 s37, s37, 10
    s_sub_u32 s36, s36, s37
    s_cmp_eq_u32 s13, 15
    s_cbranch_scc1 L_qspare
    v_lshrrev_b32 v1, 3, v0
    s_lshl_b32 s15, s12, 7
    s_lshl_b32 s32, s3, 5
    s_add_u32 s15, s15, s32
    v_add_u32 v1, s15, v1
    v_mul_u32_u24 v1, 1280, v1
    v_and_b32 v2, 7, v0
    v_lshrrev_b32 v3, 4, v0
    v_xor_b32 v2, v2, v3
    v_xor_b32 v3, 4, v2
    v_lshl_add_u32 v4, v2, 4, v1
    v_lshl_add_u32 v5, v3, 4, v1
    v_add_u32 v5, 9216, v5
    v_add_u32 v6, 18432, v4
    v_add_u32 v7, 18432, v5
    v_lshrrev_b32 v1, 4, v0
    s_lshl_b32 s15, s3, 4
    v_add_u32 v2, s15, v1
    v_mul_u32_u24 v2, 3840, v2
    v_lshlrev_b32 v1, 2, v1
    v_and_b32 v3, 15, v0
    v_xor_b32 v3, v3, v1
    v_lshl_add_u32 v2, v3, 4, v2
    s_lshl_b32 s15, s13, 8
    v_add_u32 v8, s15, v2
    v_xor_b32 v3, 32, v8
    v_add_u32 v9, 14336, v8
    v_add_u32 v10, 28672, v3
    v_add_u32 v11, 43008, v3
    s_lshl_b32 s33, s3, 12
    s_add_u32 s34, s33, 65536
    s_waitcnt lgkmcnt(0)
    s_mov_b32 s16, s4
    s_mov_b32 s17, s5
    s_mov_b32 s18, 2621440
    s_mov_b32 s19, 0x00020000
    s_mov_b32 s20, s6
    s_mov_b32 s21, s7
    s_mov_b32 s22, 2457600
    s_mov_b32 s23, 0x00020000
    s_add_u32 m0, s33, 0
    s_lshl_b32 s35, s36, 7
    buffer_load_dwordx4 v4, s[16:19], s35 offen offset:0 lds
    buffer_load_dwordx4 v5, s[16:19], s35 offen offset:1024 lds
    buffer_load_dwordx4 v6, s[16:19], s35 offen offset:2048 lds
    buffer_load_dwordx4 v7, s[16:19], s35 offen offset:3072 lds
    s_add_u32 m0, s34, 0
    s_mul_i32 s35, s36, 245760
    buffer_load_dwordx4 v8, s[20:23], s35 offen offset:0 lds
    buffer_load_dwordx4 v9, s[20:23], s35 offen offset:1024 lds
    buffer_load_dwordx4 v10, s[20:23], s35 offen offset:2048 lds
    buffer_load_dwordx4 v11, s[20:23], s35 offen offset:3072 lds
    s_add_u32 s36, s36, 1
    s_cmp_eq_u32 s36, 10
    s_cselect_b32 s36, 0, s36
    s_add_u32 m0, s33, 16384
    s_lshl_b32 s35, s36, 7
    buffer_load_dwordx4 v4, s[16:19], s35 offen offset:0 lds
    buffer_load_dwordx4 v5, s[16:19], s35 offen offset:1024 lds
    buffer_load_dwordx4 v6, s[16:19], s35 offen offset:2048 lds
    buffer_load_dwordx4 v7, s[16:19], s35 offen offset:3072 lds
    s_add_u32 m0, s34, 16384
    s_mul_i32 s35, s36, 245760
    buffer_load_dwordx4 v8, s[20:23], s35 offen offset:0 lds
    buffer_load_dwordx4 v9, s[20:23], s35 offen offset:1024 lds
    buffer_load_dwordx4 v10, s[20:23], s35 offen offset:2048 lds
    buffer_load_dwordx4 v11, s[20:23], s35 offen offset:3072 lds
    s_add_u32 s36, s36, 1
    s_cmp_eq_u32 s36, 10
    s_cselect_b32 s36, 0, s36
    s_mov_b32 s24, s44
    s_mov_b32 s25, s45
    s_mov_b32 s26, 256
    s_mov_b32 s27, 0x00020000
    s_add_u32 s28, s8, 19972096
    s_addc_u32 s29, s9, 0
    s_mov_b32 s30, 245760
    s_mov_b32 s31, 0x00020000
    s_add_u32 s92, s8, 19529728
    s_addc_u32 s93, s9, 0
    s_mov_b32 s94, 49152
    s_mov_b32 s95, 0x00020000
    v_and_b32 v1, 15, v0
    v_lshlrev_b32 v250, 2, v1
    v_min_u32 v3, 14, v1
    v_lshlrev_b32 v3, 2, v3
    s_lshl_b32 s40, s12, 7
    s_add_u32 s40, s40, 16384
    s_lshl_b32 s41, s13, 7
    s_add_u32 s41, s41, 18432
    v_add_u32 v3, s40, v3
    v_add_u32 v249, s41, v250
    v_cmp_gt_u32 vcc, 32, v0
    s_lshl_b32 s32, s13, 2
    s_add_u32 s40, s40, s32
    s_lshl_b32 s32, s12, 2
    s_add_u32 s41, s41, s32
    v_cndmask_b32 v249, v249, v3, vcc
    v_and_b32 v1, 31, v0
    v_lshrrev_b32 v2, 5, v0
    v_mul_u32_u24 v3, 5120, v2
    v_lshl_add_u32 v12, v1, 3, v3
    v_mul_u32_u24 v3, 2560, v2
    v_lshl_add_u32 v13, v1, 2, v3
    s_mul_i32 s38, s12, 10240
    s_lshl_b32 s32, s3, 8
    s_add_u32 s38, s38, s32
    s_mul_i32 s39, s13, 5120
    s_lshl_b32 s32, s3, 7
    s_add_u32 s39, s39, s32
    s_add_u32 s39, s39, 163840
    s_add_u32 s32, s32, 131072
    v_lshlrev_b32 v14, 2, v1
    v_add_u32 v14, s32, v14
    s_waitcnt vmcnt(8)
    s_barrier
    buffer_load_dword v251, v250, s[24:27], 0 offen sc1
    s_add_u32 m0, s33, 32768
    s_lshl_b32 s35, s36, 7
    buffer_load_dwordx4 v4, s[16:19], s35 offen offset:0 lds
    buffer_load_dwordx4 v5, s[16:19], s35 offen offset:1024 lds
    buffer_load_dwordx4 v6, s[16:19], s35 offen offset:2048 lds
    buffer_load_dwordx4 v7, s[16:19], s35 offen offset:3072 lds
    s_add_u32 m0, s34, 32768
    s_mul_i32 s35, s36, 245760
    buffer_load_dwordx4 v8, s[20:23], s35 offen offset:0 lds
    buffer_load_dwordx4 v9, s[20:23], s35 offen offset:1024 lds
    buffer_load_dwordx4 v10, s[20:23], s35 offen offset:2048 lds
    buffer_load_dwordx4 v11, s[20:23], s35 offen offset:3072 lds
    s_add_u32 s36, s36, 1
    s_cmp_eq_u32 s36, 10
    s_cselect_b32 s36, 0, s36
    s_add_u32 m0, s33, 49152
    s_lshl_b32 s35, s36, 7
    buffer_load_dwordx4 v4, s[16:19], s35 offen offset:0 lds
    buffer_load_dwordx4 v5, s[16:19], s35 offen offset:1024 lds
    buffer_load_dwordx4 v6, s[16:19], s35 offen offset:2048 lds
    buffer_load_dwordx4 v7, s[16:19], s35 offen offset:3072 lds
    s_add_u32 m0, s34, 49152
    s_mul_i32 s35, s36, 245760
    buffer_load_dwordx4 v8, s[20:23], s35 offen offset:0 lds
    buffer_load_dwordx4 v9, s[20:23], s35 offen offset:1024 lds
    buffer_load_dwordx4 v10, s[20:23], s35 offen offset:2048 lds
    buffer_load_dwordx4 v11, s[20:23], s35 offen offset:3072 lds
    s_add_u32 s36, s36, 1
    s_cmp_eq_u32 s36, 10
    s_cselect_b32 s36, 0, s36
    s_waitcnt vmcnt(17)
    s_barrier
    s_add_u32 m0, s33, 0
    s_lshl_b32 s35, s36, 7
    buffer_load_dwordx4 v4, s[16:19], s35 offen offset:0 lds
    buffer_load_dwordx4 v5, s[16:19], s35 offen offset:1024 lds
    buffer_load_dwordx4 v6, s[16:19], s35 offen offset:2048 lds
    buffer_load_dwordx4 v7, s[16:19], s35 offen offset:3072 lds
    s_add_u32 m0, s34, 0
    s_mul_i32 s35, s36, 245760
    buffer_load_dwordx4 v8, s[20:23], s35 offen offset:0 lds
    buffer_load_dwordx4 v9, s[20:23], s35 offen offset:1024 lds
    buffer_load_dwordx4 v10, s[20:23], s35 offen offset:2048 lds
    buffer_load_dwordx4 v11, s[20:23], s35 offen offset:3072 lds
    s_add_u32 s36, s36, 1
    s_cmp_eq_u32 s36, 10
    s_cselect_b32 s36, 0, s36
    s_waitcnt vmcnt(16)
    s_barrier
    s_waitcnt vmcnt(24)
    s_mov_b32 s46, 0
    s_branch L_ww1_c
L_ww1:
    buffer_load_dword v251, v250, s[24:27], 0 offen sc1
    s_add_u32 s46, s46, 1
    s_waitcnt vmcnt(0)
L_ww1_c:
    v_cmp_eq_u32 vcc, 0, v251
    s_cmp_gt_u32 s46, 0x20000
    s_cbranch_scc1 L_ww1_x
    s_cmp_lg_u64 vcc, 0
    s_cbranch_scc1 L_ww1
L_ww1_x:
    s_cmp_eq_u32 s3, 0
    s_cselect_b32 s32, s40, 0x100000
    v_mov_b32 v1, 1
    s_mov_b64 exec, 1
    buffer_store_dword v1, off, s[92:95], s32 sc1
    s_mov_b64 exec, -1
    s_cmp_eq_u32 s3, 0
    s_cselect_b32 s32, s41, 0x100000
    v_mov_b32 v1, 1
    s_mov_b64 exec, 1
    buffer_store_dword v1, off, s[92:95], s32 sc1
    s_mov_b64 exec, -1
    s_add_u32 m0, s33, 16384
    s_lshl_b32 s35, s36, 7
    buffer_load_dwordx4 v4, s[16:19], s35 offen offset:0 lds
    buffer_load_dwordx4 v5, s[16:19], s35 offen offset:1024 lds
    buffer_load_dwordx4 v6, s[16:19], s35 offen offset:2048 lds
    buffer_load_dwordx4 v7, s[16:19], s35 offen offset:3072 lds
    s_add_u32 m0, s34, 16384
    s_mul_i32 s35, s36, 245760
    buffer_load_dwordx4 v8, s[20:23], s35 offen offset:0 lds
    buffer_load_dwordx4 v9, s[20:23], s35 offen offset:1024 lds
    buffer_load_dwordx4 v10, s[20:23], s35 offen offset:2048 lds
    buffer_load_dwordx4 v11, s[20:23], s35 offen offset:3072 lds
    s_add_u32 s36, s36, 1
    s_cmp_eq_u32 s36, 10
    s_cselect_b32 s36, 0, s36
    s_waitcnt vmcnt(18)
    s_barrier
    s_add_u32 m0, s33, 32768
    s_lshl_b32 s35, s36, 7
    buffer_load_dwordx4 v4, s[16:19], s35 offen offset:0 lds
    buffer_load_dwordx4 v5, s[16:19], s35 offen offset:1024 lds
    buffer_load_dwordx4 v6, s[16:19], s35 offen offset:2048 lds
    buffer_load_dwordx4 v7, s[16:19], s35 offen offset:3072 lds
    s_add_u32 m0, s34, 32768
    s_mul_i32 s35, s36, 245760
    buffer_load_dwordx4 v8, s[20:23], s35 offen offset:0 lds
    buffer_load_dwordx4 v9, s[20:23], s35 offen offset:1024 lds
    buffer_load_dwordx4 v10, s[20:23], s35 offen offset:2048 lds
    buffer_load_dwordx4 v11, s[20:23], s35 offen offset:3072 lds
    s_add_u32 s36, s36, 1
    s_cmp_eq_u32 s36, 10
    s_cselect_b32 s36, 0, s36
    s_waitcnt vmcnt(18)
    s_barrier
    s_add_u32 m0, s33, 49152
    s_lshl_b32 s35, s36, 7
    buffer_load_dwordx4 v4, s[16:19], s35 offen offset:0 lds
    buffer_load_dwordx4 v5, s[16:19], s35 offen offset:1024 lds
    buffer_load_dwordx4 v6, s[16:19], s35 offen offset:2048 lds
    buffer_load_dwordx4 v7, s[16:19], s35 offen offset:3072 lds
    s_add_u32 m0, s34, 49152
    s_mul_i32 s35, s36, 245760
    buffer_load_dwordx4 v8, s[20:23], s35 offen offset:0 lds
    buffer_load_dwordx4 v9, s[20:23], s35 offen offset:1024 lds
    buffer_load_dwordx4 v10, s[20:23], s35 offen offset:2048 lds
    buffer_load_dwordx4 v11, s[20:23], s35 offen offset:3072 lds
    s_add_u32 s36, s36, 1
    s_cmp_eq_u32 s36, 10
    s_cselect_b32 s36, 0, s36
    s_waitcnt vmcnt(16)
    s_barrier
    buffer_load_dword v251, v249, s[92:95], 0 offen sc1
    s_add_u32 m0, s33, 0
    s_lshl_b32 s35, s36, 7
    buffer_load_dwordx4 v4, s[16:19], s35 offen offset:0 lds
    buffer_load_dwordx4 v5, s[16:19], s35 offen offset:1024 lds
    buffer_load_dwordx4 v6, s[16:19], s35 offen offset:2048 lds
    buffer_load_dwordx4 v7, s[16:19], s35 offen offset:3072 lds
    s_add_u32 m0, s34, 0
    s_mul_i32 s35, s36, 245760
    buffer_load_dwordx4 v8, s[20:23], s35 offen offset:0 lds
    buffer_load_dwordx4 v9, s[20:23], s35 offen offset:1024 lds
    buffer_load_dwordx4 v10, s[20:23], s35 offen offset:2048 lds
    buffer_load_dwordx4 v11, s[20:23], s35 offen offset:3072 lds
    s_add_u32 s36, s36, 1
    s_cmp_eq_u32 s36, 10
    s_cselect_b32 s36, 0, s36
    s_waitcnt vmcnt(17)
    s_barrier
    s_add_u32 m0, s33, 16384
    s_lshl_b32 s35, s36, 7
    buffer_load_dwordx4 v4, s[16:19], s35 offen offset:0 lds
    buffer_load_dwordx4 v5, s[16:19], s35 offen offset:1024 lds
    buffer_load_dwordx4 v6, s[16:19], s35 offen offset:2048 lds
    buffer_load_dwordx4 v7, s[16:19], s35 offen offset:3072 lds
    s_add_u32 m0, s34, 16384
    s_mul_i32 s35, s36, 245760
    buffer_load_dwordx4 v8, s[20:23], s35 offen offset:0 lds
    buffer_load_dwordx4 v9, s[20:23], s35 offen offset:1024 lds
    buffer_load_dwordx4 v10, s[20:23], s35 offen offset:2048 lds
    buffer_load_dwordx4 v11, s[20:23], s35 offen offset:3072 lds
    s_add_u32 s36, s36, 1
    s_cmp_eq_u32 s36, 10
    s_cselect_b32 s36, 0, s36
    s_waitcnt vmcnt(16)
    s_mov_b32 s46, 0
    s_branch L_ww2_c
L_ww2:
    buffer_load_dword v251, v249, s[92:95], 0 offen sc1
    s_add_u32 s46, s46, 1
    s_waitcnt vmcnt(0)
L_ww2_c:
    v_cmp_eq_u32 vcc, 0, v251
    s_cmp_gt_u32 s46, 0x20000
    s_cbranch_scc1 L_ww2_x
    s_cmp_lg_u64 vcc, 0
    s_cbranch_scc1 L_ww2
L_ww2_x:
    buffer_load_dwordx2 v[20:21], v12, s[28:31], s38 offen offset:0 sc1
    buffer_load_dword v30, v13, s[28:31], s39 offen offset:0 sc1
    buffer_load_dwordx2 v[22:23], v12, s[28:31], s38 offen offset:1024 sc1
    buffer_load_dword v31, v13, s[28:31], s39 offen offset:512 sc1
    buffer_load_dwordx2 v[24:25], v12, s[28:31], s38 offen offset:2048 sc1
    buffer_load_dword v32, v13, s[28:31], s39 offen offset:1024 sc1
    buffer_load_dwordx2 v[26:27], v12, s[28:31], s38 offen offset:3072 sc1
    buffer_load_dword v33, v13, s[28:31], s39 offen offset:1536 sc1
    s_add_u32 s38, s38, 4096
    buffer_load_dwordx2 v[28:29], v12, s[28:31], s38 offen offset:0 sc1
    buffer_load_dword v34, v13, s[28:31], s39 offen offset:2048 sc1
    s_waitcnt vmcnt(27)
    s_barrier
    s_waitcnt vmcnt(18)
    s_barrier
    s_waitcnt vmcnt(0)
    v_add_f32 v20, v20, v22
    v_add_f32 v21, v21, v23
    v_add_f32 v30, v30, v31
    v_add_f32 v20, v20, v24
    v_add_f32 v21, v21, v25
    v_add_f32 v30, v30, v32
    v_add_f32 v20, v20, v26
    v_add_f32 v21, v21, v27
    v_add_f32 v30, v30, v33
    v_add_f32 v20, v20, v28
    v_add_f32 v21, v21, v29
    v_add_f32 v30, v30, v34
    s_nop 2
    v_mov_b32 v22, v20
    v_mov_b32 v23, v21
    v_mov_b32 v24, v30
    s_nop 1
    v_permlane32_swap_b32 v20, v22
    v_permlane32_swap_b32 v21, v23
    v_permlane32_swap_b32 v30, v24
    s_nop 1
    v_add_f32 v20, v20, v22
    v_add_f32 v21, v21, v23
    v_add_f32 v30, v30, v24
    v_mul_f32 v20, 0x3acccccd, v20
    v_mul_f32 v21, 0x3acccccd, v21
    v_fma_f32 v21, -v20, v20, v21
    v_max_f32 v21, 0, v21
    v_cvt_pk_bf16_f32 v21, v20, v21
    v_lshlrev_b32 v20, 16, v21
    v_and_b32 v21, 0xffff0000, v21
    v_add_f32 v21, 0x3727c5ac, v21
    v_cvt_pk_bf16_f32 v21, 0, v21
    v_sqrt_f32 v21, v21
    s_nop 0
    v_cvt_pk_bf16_f32 v21, 0, v21
    v_rcp_f32 v21, v21
    ds_write_b32 v14, v20
    ds_write_b32 v14, v30 offset:1024
    ds_write_b32 v14, v21 offset:512
    s_waitcnt lgkmcnt(0)
    s_waitcnt vmcnt(10)
    s_barrier
    s_branch L_qjoin
L_qspare:
    s_waitcnt lgkmcnt(0)
    s_mov_b32 s24, s44
    s_mov_b32 s25, s45
    s_mov_b32 s26, 256
    s_mov_b32 s27, 0x00020000
    s_add_u32 s92, s8, 19529728
    s_addc_u32 s93, s9, 0
    s_mov_b32 s94, 49152
    s_mov_b32 s95, 0x00020000
    s_cmp_lg_u32 s3, 0
    s_cbranch_scc1 L_qjoin
    v_lshlrev_b32 v2, 4, v0
    v_mov_b32 v4, 0
    v_mov_b32 v5, 0
    v_mov_b32 v6, 0
    v_mov_b32 v7, 0
    s_mul_i32 s20, s12, 3072
    buffer_store_dwordx4 v[4:7], v2, s[92:95], s20 offen sc1
    buffer_store_dwordx4 v[4:7], v2, s[92:95], s20 offen offset:1024 sc1
    buffer_store_dwordx4 v[4:7], v2, s[92:95], s20 offen offset:2048 sc1
    s_lshl_b32 s20, s12, 2
    v_mov_b32 v1, 1
    s_waitcnt vmcnt(0)
    s_mov_b64 exec, 1
    buffer_store_dword v1, off, s[24:27], s20 sc1
    s_mov_b64 exec, -1
    v_and_b32 v1, 15, v0
    v_lshlrev_b32 v250, 2, v1
    s_mov_b32 s46, 0
L_ww3:
    buffer_load_dword v251, v250, s[24:27], 0 offen sc1
    s_add_u32 s46, s46, 1
    s_waitcnt vmcnt(0)
L_ww3_c:
    v_cmp_eq_u32 vcc, 0, v251
    s_cmp_gt_u32 s46, 0x20000
    s_cbranch_scc1 L_ww3_x
    s_cmp_lg_u64 vcc, 0
    s_cbranch_scc1 L_ww3
L_ww3_x:
L_qjoin:
    s_lshl_b32 s42, s13, 7
    s_lshl_b32 s32, s12, 2
    s_add_u32 s42, s42, s32
    s_add_u32 s42, s42, 20480
    s_load_dwordx2 s[6:7], s[0:1], 16
    v_lshlrev_b32 v2, 4, v0
    s_lshl_b32 s12, s10, 2
    s_lshr_b32 s13, s11, 3
    s_add_u32 s12, s12, s13
    s_and_b32 s13, s11, 7
    s_and_b32 s15, s3, 1
    s_lshr_b32 s16, s3, 1
    s_mul_i32 s21, s15, 81920
    s_mul_i32 s22, s16, 40960
    s_add_u32 s21, s21, s22
    s_cmp_eq_u32 s15, 1
    s_cbranch_scc1 L_vprep
    s_mul_i32 s23, s12, 81920
    s_add_u32 s23, s23, s22
    s_movk_i32 s20, 5120
    v_mov_b32 v243, v2
    v_mov_b32 v244, v2
    v_mov_b32 v245, v2
    v_mov_b32 v246, v2
    v_add_u32 v247, 4096, v2
    s_branch L_kvprep
L_vprep:
    s_mul_i32 s23, s12, 640
    s_mul_i32 s22, s16, 1310720
    s_add_u32 s23, s23, s22
    s_add_u32 s23, s23, 2621440
    s_mov_b32 s20, 163840
    v_add_u32 v1, 0, v0
    v_mul_u32_u24 v3, 3277, v1
    v_lshrrev_b32 v3, 16, v3
    v_mul_u32_u24 v6, 20, v3
    v_sub_u32 v6, v1, v6
    v_lshlrev_b32 v6, 5, v6
    v_and_b32 v7, 1, v3
    v_lshl_add_u32 v6, v7, 4, v6
    v_lshrrev_b32 v3, 1, v3
    v_mul_u32_u24 v3, 20480, v3
    v_add_u32 v6, v6, v3
    v_subrev_u32 v243, 0, v6
    v_add_u32 v1, 64, v0
    v_mul_u32_u24 v3, 3277, v1
    v_lshrrev_b32 v3, 16, v3
    v_mul_u32_u24 v6, 20, v3
    v_sub_u32 v6, v1, v6
    v_lshlrev_b32 v6, 5, v6
    v_and_b32 v7, 1, v3
    v_lshl_add_u32 v6, v7, 4, v6
    v_lshrrev_b32 v3, 1, v3
    v_mul_u32_u24 v3, 20480, v3
    v_add_u32 v6, v6, v3
    v_subrev_u32 v244, 1024, v6
    v_add_u32 v1, 128, v0
    v_mul_u32_u24 v3, 3277, v1
    v_lshrrev_b32 v3, 16, v3
    v_mul_u32_u24 v6, 20, v3
    v_sub_u32 v6, v1, v6
    v_lshlrev_b32 v6, 5, v6
    v_and_b32 v7, 1, v3
    v_lshl_add_u32 v6, v7, 4, v6
    v_lshrrev_b32 v3, 1, v3
    v_mul_u32_u24 v3, 20480, v3
    v_add_u32 v6, v6, v3
    v_subrev_u32 v245, 2048, v6
    v_add_u32 v1, 192, v0
    v_mul_u32_u24 v3, 3277, v1
    v_lshrrev_b32 v3, 16, v3
    v_mul_u32_u24 v6, 20, v3
    v_sub_u32 v6, v1, v6
    v_lshlrev_b32 v6, 5, v6
    v_and_b32 v7, 1, v3
    v_lshl_add_u32 v6, v7, 4, v6
    v_lshrrev_b32 v3, 1, v3
    v_mul_u32_u24 v3, 20480, v3
    v_add_u32 v6, v6, v3
    v_subrev_u32 v246, 3072, v6
    v_add_u32 v1, 256, v0
    v_mul_u32_u24 v3, 3277, v1
    v_lshrrev_b32 v3, 16, v3
    v_mul_u32_u24 v6, 20, v3
    v_sub_u32 v6, v1, v6
    v_lshlrev_b32 v6, 5, v6
    v_and_b32 v7, 1, v3
    v_lshl_add_u32 v6, v7, 4, v6
    v_lshrrev_b32 v3, 1, v3
    v_mul_u32_u24 v3, 20480, v3
    v_add_u32 v6, v6, v3
    v_subrev_u32 v247, 0, v6
L_kvprep:
    s_add_u32 s16, s8, 2621440
    s_addc_u32 s17, s9, 0
    s_mov_b32 s18, 5242880
    s_mov_b32 s19, 0x00020000
    s_add_u32 s92, s8, 19529728
    s_addc_u32 s93, s9, 0
    s_mov_b32 s94, 49152
    s_mov_b32 s95, 0x00020000
    s_mul_i32 s32, s12, 20
    s_add_u32 s33, s32, 19
    s_lshr_b32 s32, s32, 7
    s_lshr_b32 s33, s33, 7
    v_mov_b32 v3, s32
    v_mov_b32 v6, s33
    v_and_b32 v1, 16, v0
    v_cmp_eq_u32 vcc, 0, v1
    v_lshrrev_b32 v7, 5, v0
    v_mul_u32_u24 v7, 5, v7
    v_cndmask_b32 v3, v6, v3, vcc
    v_lshlrev_b32 v3, 7, v3
    v_add_u32 v3, 20480, v3
    v_add_u32 v7, 5, v7
    v_lshl_add_u32 v248, v7, 7, v3
    v_and_b32 v1, 15, v0
    v_lshl_add_u32 v248, v1, 2, v248
    v_and_b32 v1, 1, v0
    v_lshl_add_u32 v249, v1, 2, v3
    s_lshl_b32 s32, s13, 3
    v_add_u32 v249, s32, v249
    s_waitcnt lgkmcnt(0)
    s_barrier
    s_cmp_eq_u32 s3, 0
    s_cselect_b32 s32, s42, 0x100000
    v_mov_b32 v1, 1
    v_lshlrev_b32 v3, 11, v0
    s_mov_b64 exec, 0xff
    buffer_store_dword v1, v3, s[92:95], s32 offen sc1
    s_mov_b64 exec, -1
    s_lshl_b32 s32, s10, 11
    v_add_u32 v248, s32, v248
    v_add_u32 v249, s32, v249
    v_and_b32 v1, 31, v0
    v_lshrrev_b32 v3, 5, v0
    v_mul_u32_u24 v4, 3072, v3
    v_lshl_add_u32 v240, v1, 2, v4
    v_mul_u32_u24 v5, 768, v3
    v_lshl_add_u32 v241, v1, 3, v5
    v_lshlrev_b32 v242, 3, v1
    v_add_u32 v3, 0, v0
    v_min_u32 v3, 59, v3
    v_mul_u32_u24 v4, 13108, v3
    v_lshrrev_b32 v4, 16, v4
    v_mul_u32_u24 v5, 5, v4
    v_sub_u32 v5, v3, v5
    v_mul_u32_u24 v4, 1280, v4
    v_lshl_add_u32 v230, v5, 7, v4
    v_add_u32 v3, 0, v0
    v_min_u32 v3, 24, v3
    v_mul_u32_u24 v4, 13108, v3
    v_lshrrev_b32 v4, 16, v4
    v_mul_u32_u24 v5, 5, v4
    v_sub_u32 v5, v3, v5
    v_mul_u32_u24 v4, 1280, v4
    v_lshl_add_u32 v231, v5, 7, v4
    s_lshr_b32 s12, s10, 1
    s_lshl_b32 s12, s12, 3
    s_and_b32 s13, s11, 7
    s_add_u32 s12, s12, s13
    s_and_b32 s13, s10, 1
    s_lshl_b32 s13, s13, 2
    s_lshr_b32 s14, s11, 3
    s_add_u32 s13, s13, s14
    s_mul_i32 s32, s3, 40960
    s_mul_i32 s33, s13, 160
    s_add_u32 s32, s32, s33
    v_add_u32 v1, 0, v0
    v_mul_u32_u24 v5, 6554, v1
    v_lshrrev_b32 v5, 16, v5
    v_mul_u32_u24 v6, 10, v5
    v_sub_u32 v6, v1, v6
    v_mul_u32_u24 v5, 1280, v5
    v_lshl_add_u32 v5, v6, 4, v5
    v_add_u32 v5, s32, v5
    v_subrev_u32 v12, 0, v5
    v_add_u32 v1, 64, v0
    v_mul_u32_u24 v5, 6554, v1
    v_lshrrev_b32 v5, 16, v5
    v_mul_u32_u24 v6, 10, v5
    v_sub_u32 v6, v1, v6
    v_mul_u32_u24 v5, 1280, v5
    v_lshl_add_u32 v5, v6, 4, v5
    v_add_u32 v5, s32, v5
    v_subrev_u32 v13, 1024, v5
    v_add_u32 v1, 128, v0
    v_mul_u32_u24 v5, 6554, v1
    v_lshrrev_b32 v5, 16, v5
    v_mul_u32_u24 v6, 10, v5
    v_sub_u32 v6, v1, v6
    v_mul_u32_u24 v5, 1280, v5
    v_lshl_add_u32 v5, v6, 4, v5
    v_add_u32 v5, s32, v5
    v_subrev_u32 v14, 2048, v5
    v_add_u32 v1, 192, v0
    v_mul_u32_u24 v5, 6554, v1
    v_lshrrev_b32 v5, 16, v5
    v_mul_u32_u24 v6, 10, v5
    v_sub_u32 v6, v1, v6
    v_mul_u32_u24 v5, 1280, v5
    v_lshl_add_u32 v5, v6, 4, v5
    v_add_u32 v5, s32, v5
    v_subrev_u32 v15, 3072, v5
    v_add_u32 v1, 256, v0
    v_mul_u32_u24 v5, 6554, v1
    v_lshrrev_b32 v5, 16, v5
    v_mul_u32_u24 v6, 10, v5
    v_sub_u32 v6, v1, v6
    v_mul_u32_u24 v5, 1280, v5
    v_lshl_add_u32 v5, v6, 4, v5
    v_add_u32 v5, s32, v5
    v_subrev_u32 v16, 0, v5
    s_mul_i32 s34, s3, 5120
    v_lshlrev_b32 v17, 4, v0
    v_add_u32 v17, s34, v17
    v_add_u32 v18, 61440, v17
    v_add_u32 v19, 122880, v17
    s_lshl_b32 s37, s12, 7
    s_lshr_b32 s12, s10, 2
    s_lshl_b32 s12, s12, 3
    s_and_b32 s13, s11, 7
    s_add_u32 s12, s12, s13
    s_and_b32 s13, s10, 3
    s_lshl_b32 s13, s13, 2
    s_lshr_b32 s14, s11, 3
    s_add_u32 s13, s13, s14
    s_mul_i32 s15, s12, 40
    s_lshr_b32 s32, s3, 1
    s_mul_i32 s32, s32, 20
    s_add_u32 s15, s15, s32
    s_mul_i32 s32, s13, 192
    s_mul_i32 s33, s13, 245760
    s_and_b32 s34, s3, 1
    s_mul_i32 s34, s34, 6144
    s_add_u32 s33, s33, s34
    v_lshrrev_b32 v1, 3, v0
    v_add_u32 v1, 0, v1
    v_mul_u32_u24 v4, 43, v1
    v_lshrrev_b32 v4, 8, v4
    v_mul_u32_u24 v3, 6, v4
    v_sub_u32 v3, v1, v3
    v_and_b32 v6, 1, v0
    v_lshl_add_u32 v3, v3, 1, v6
    v_bfe_u32 v6, v0, 1, 2
    v_lshl_add_u32 v4, v4, 2, v6
    v_add_u32 v4, s15, v4
    v_mul_u32_u24 v5, 3072, v4
    v_lshl_add_u32 v5, v3, 4, v5
    v_add_u32 v180, s32, v5
    v_lshrrev_b32 v5, 5, v4
    v_mul_u32_u24 v5, 12288, v5
    v_bfe_u32 v6, v4, 2, 1
    v_lshl_add_u32 v5, v6, 9, v5
    v_bfe_u32 v6, v4, 3, 2
    v_lshl_add_u32 v5, v6, 7, v5
    v_and_b32 v6, 3, v4
    v_lshl_add_u32 v5, v6, 5, v5
    v_and_b32 v6, 1, v3
    v_lshl_add_u32 v5, v6, 4, v5
    v_lshrrev_b32 v6, 1, v3
    v_lshl_add_u32 v5, v6, 10, v5
    v_add_u32 v184, s33, v5
    v_lshrrev_b32 v1, 3, v0
    v_add_u32 v1, 8, v1
    v_mul_u32_u24 v4, 43, v1
    v_lshrrev_b32 v4, 8, v4
    v_mul_u32_u24 v3, 6, v4
    v_sub_u32 v3, v1, v3
    v_and_b32 v6, 1, v0
    v_lshl_add_u32 v3, v3, 1, v6
    v_bfe_u32 v6, v0, 1, 2
    v_lshl_add_u32 v4, v4, 2, v6
    v_add_u32 v4, s15, v4
    v_mul_u32_u24 v5, 3072, v4
    v_lshl_add_u32 v5, v3, 4, v5
    v_add_u32 v181, s32, v5
    v_lshrrev_b32 v5, 5, v4
    v_mul_u32_u24 v5, 12288, v5
    v_bfe_u32 v6, v4, 2, 1
    v_lshl_add_u32 v5, v6, 9, v5
    v_bfe_u32 v6, v4, 3, 2
    v_lshl_add_u32 v5, v6, 7, v5
    v_and_b32 v6, 3, v4
    v_lshl_add_u32 v5, v6, 5, v5
    v_and_b32 v6, 1, v3
    v_lshl_add_u32 v5, v6, 4, v5
    v_lshrrev_b32 v6, 1, v3
    v_lshl_add_u32 v5, v6, 10, v5
    v_add_u32 v185, s33, v5
    v_lshrrev_b32 v1, 3, v0
    v_add_u32 v1, 16, v1
    v_mul_u32_u24 v4, 43, v1
    v_lshrrev_b32 v4, 8, v4
    v_mul_u32_u24 v3, 6, v4
    v_sub_u32 v3, v1, v3
    v_and_b32 v6, 1, v0
    v_lshl_add_u32 v3, v3, 1, v6
    v_bfe_u32 v6, v0, 1, 2
    v_lshl_add_u32 v4, v4, 2, v6
    v_add_u32 v4, s15, v4
    v_mul_u32_u24 v5, 3072, v4
    v_lshl_add_u32 v5, v3, 4, v5
    v_add_u32 v182, s32, v5
    v_lshrrev_b32 v5, 5, v4
    v_mul_u32_u24 v5, 12288, v5
    v_bfe_u32 v6, v4, 2, 1
    v_lshl_add_u32 v5, v6, 9, v5
    v_bfe_u32 v6, v4, 3, 2
    v_lshl_add_u32 v5, v6, 7, v5
    v_and_b32 v6, 3, v4
    v_lshl_add_u32 v5, v6, 5, v5
    v_and_b32 v6, 1, v3
    v_lshl_add_u32 v5, v6, 4, v5
    v_lshrrev_b32 v6, 1, v3
    v_lshl_add_u32 v5, v6, 10, v5
    v_add_u32 v186, s33, v5
    v_lshrrev_b32 v1, 3, v0
    v_add_u32 v1, 24, v1
    v_mul_u32_u24 v4, 43, v1
    v_lshrrev_b32 v4, 8, v4
    v_mul_u32_u24 v3, 6, v4
    v_sub_u32 v3, v1, v3
    v_and_b32 v6, 1, v0
    v_lshl_add_u32 v3, v3, 1, v6
    v_bfe_u32 v6, v0, 1, 2
    v_lshl_add_u32 v4, v4, 2, v6
    v_add_u32 v4, s15, v4
    v_mul_u32_u24 v5, 3072, v4
    v_lshl_add_u32 v5, v3, 4, v5
    v_add_u32 v183, s32, v5
    v_lshrrev_b32 v5, 5, v4
    v_mul_u32_u24 v5, 12288, v5
    v_bfe_u32 v6, v4, 2, 1
    v_lshl_add_u32 v5, v6, 9, v5
    v_bfe_u32 v6, v4, 3, 2
    v_lshl_add_u32 v5, v6, 7, v5
    v_and_b32 v6, 3, v4
    v_lshl_add_u32 v5, v6, 5, v5
    v_and_b32 v6, 1, v3
    v_lshl_add_u32 v5, v6, 4, v5
    v_lshrrev_b32 v6, 1, v3
    v_lshl_add_u32 v5, v6, 10, v5
    v_add_u32 v187, s33, v5
    s_lshl_b32 s15, s12, 3
    s_lshl_b32 s32, s3, 1
    s_add_u32 s15, s15, s32
    s_mul_i32 s15, s15, 20480
    v_add_u32 v4, s15, v2
    v_add_u32 v5, 18432, v4
    s_cmp_lg_u32 s3, 0
    s_cbranch_scc1 L_qnp
    s_mov_b32 s46, 0
L_ww4:
    s_sleep 12
    buffer_load_dword v251, v248, s[92:95], 0 offen sc1
    buffer_load_dword v253, v249, s[92:95], 0 offen sc1
    s_add_u32 s46, s46, 1
    s_waitcnt vmcnt(0)
L_ww4_c:
    v_min_u32 v251, v251, v253
    v_cmp_eq_u32 vcc, 0, v251
    s_cmp_gt_u32 s46, 0x20000
    s_cbranch_scc1 L_ww4_x
    s_cmp_lg_u64 vcc, 0
    s_cbranch_scc1 L_ww4
L_ww4_x:
L_qnp:
    s_barrier
    s_add_u32 m0, s21, 0
    s_nop 0
    buffer_load_dwordx4 v243, s[16:19], s23 offen offset:0 sc1 lds
    buffer_load_dwordx4 v244, s[16:19], s23 offen offset:1024 sc1 lds
    buffer_load_dwordx4 v245, s[16:19], s23 offen offset:2048 sc1 lds
    buffer_load_dwordx4 v246, s[16:19], s23 offen offset:3072 sc1 lds
    s_add_u32 m0, s21, 4096
    s_nop 0
    buffer_load_dwordx4 v247, s[16:19], s23 offen sc1 lds
    s_add_u32 s23, s23, s20
    s_add_u32 m0, s21, 5120
    s_nop 0
    buffer_load_dwordx4 v243, s[16:19], s23 offen offset:0 sc1 lds
    buffer_load_dwordx4 v244, s[16:19], s23 offen offset:1024 sc1 lds
    buffer_load_dwordx4 v245, s[16:19], s23 offen offset:2048 sc1 lds
    buffer_load_dwordx4 v246, s[16:19], s23 offen offset:3072 sc1 lds
    s_add_u32 m0, s21, 9216
    s_nop 0
    buffer_load_dwordx4 v247, s[16:19], s23 offen sc1 lds
    s_add_u32 s23, s23, s20
    s_waitcnt vmcnt(3)
    v_mov_b32 v1, 0x3f803f80
    v_cmp_gt_u32 vcc, 4, v0
    v_lshlrev_b32 v3, 2, v0
    v_add_u32 v3, s21, v3
    v_cndmask_b32 v1, 0, v1, vcc
    s_mov_b64 exec, 0xff
    ds_write_b32 v3, v1
    ds_write_b32 v3, v1 offset:640
    s_mov_b64 exec, -1
    s_waitcnt lgkmcnt(0)
    s_barrier
    s_add_u32 m0, s21, 10240
    s_nop 0
    buffer_load_dwordx4 v243, s[16:19], s23 offen offset:0 sc1 lds
    buffer_load_dwordx4 v244, s[16:19], s23 offen offset:1024 sc1 lds
    buffer_load_dwordx4 v245, s[16:19], s23 offen offset:2048 sc1 lds
    buffer_load_dwordx4 v246, s[16:19], s23 offen offset:3072 sc1 lds
    s_add_u32 m0, s21, 14336
    s_nop 0
    buffer_load_dwordx4 v247, s[16:19], s23 offen sc1 lds
    s_add_u32 s23, s23, s20
    s_add_u32 m0, s21, 15360
    s_nop 0
    buffer_load_dwordx4 v243, s[16:19], s23 offen offset:0 sc1 lds
    buffer_load_dwordx4 v244, s[16:19], s23 offen offset:1024 sc1 lds
    buffer_load_dwordx4 v245, s[16:19], s23 offen offset:2048 sc1 lds
    buffer_load_dwordx4 v246, s[16:19], s23 offen offset:3072 sc1 lds
    s_add_u32 m0, s21, 19456
    s_nop 0
    buffer_load_dwordx4 v247, s[16:19], s23 offen sc1 lds
    s_add_u32 s23, s23, s20
    s_add_u32 m0, s21, 20480
    s_nop 0
    buffer_load_dwordx4 v243, s[16:19], s23 offen offset:0 sc1 lds
    buffer_load_dwordx4 v244, s[16:19], s23 offen offset:1024 sc1 lds
    buffer_load_dwordx4 v245, s[16:19], s23 offen offset:2048 sc1 lds
    buffer_load_dwordx4 v246, s[16:19], s23 offen offset:3072 sc1 lds
    s_add_u32 m0, s21, 24576
    s_nop 0
    buffer_load_dwordx4 v247, s[16:19], s23 offen sc1 lds
    s_add_u32 s23, s23, s20
    s_add_u32 m0, s21, 25600
    s_nop 0
    buffer_load_dwordx4 v243, s[16:19], s23 offen offset:0 sc1 lds
    buffer_load_dwordx4 v244, s[16:19], s23 offen offset:1024 sc1 lds
    buffer_load_dwordx4 v245, s[16:19], s23 offen offset:2048 sc1 lds
    buffer_load_dwordx4 v246, s[16:19], s23 offen offset:3072 sc1 lds
    s_add_u32 m0, s21, 29696
    s_nop 0
    buffer_load_dwordx4 v247, s[16:19], s23 offen sc1 lds
    s_add_u32 s23, s23, s20
    s_add_u32 m0, s21, 30720
    s_nop 0
    buffer_load_dwordx4 v243, s[16:19], s23 offen offset:0 sc1 lds
    buffer_load_dwordx4 v244, s[16:19], s23 offen offset:1024 sc1 lds
    buffer_load_dwordx4 v245, s[16:19], s23 offen offset:2048 sc1 lds
    buffer_load_dwordx4 v246, s[16:19], s23 offen offset:3072 sc1 lds
    s_add_u32 m0, s21, 34816
    s_nop 0
    buffer_load_dwordx4 v247, s[16:19], s23 offen sc1 lds
    s_add_u32 s23, s23, s20
    s_add_u32 m0, s21, 35840
    s_nop 0
    buffer_load_dwordx4 v243, s[16:19], s23 offen offset:0 sc1 lds
    buffer_load_dwordx4 v244, s[16:19], s23 offen offset:1024 sc1 lds
    buffer_load_dwordx4 v245, s[16:19], s23 offen offset:2048 sc1 lds
    buffer_load_dwordx4 v246, s[16:19], s23 offen offset:3072 sc1 lds
    s_add_u32 m0, s21, 39936
    s_nop 0
    buffer_load_dwordx4 v247, s[16:19], s23 offen sc1 lds
    s_add_u32 s23, s23, s20
    s_waitcnt vmcnt(0)
    s_barrier
    s_setprio 3
    s_and_b32 s33, s10, 1
    s_mul_i32 s33, s33, 640
    s_mov_b32 s28, s6
    s_mov_b32 s29, s7
    s_mov_b32 s30, 819200
    s_mov_b32 s31, 0x00020000
    s_lshl_b32 s32, s11, 2
    s_add_u32 s32, s32, s3
    s_mul_i32 s32, s32, 6400
    s_add_u32 s32, s32, s33
    buffer_load_dword v252, v231, s[28:31], s32 offen
    s_mov_b32 s28, s52
    s_mov_b32 s29, s53
    s_mov_b32 s30, 1966080
    s_mov_b32 s31, 0x00020000
    s_lshl_b32 s32, s11, 2
    s_add_u32 s32, s32, s3
    s_mul_i32 s32, s32, 15360
    s_add_u32 s32, s32, s33
    buffer_load_dword v252, v230, s[28:31], s32 offen
    s_lshr_b32 s12, s10, 2
    s_lshl_b32 s12, s12, 3
    s_and_b32 s13, s11, 7
    s_add_u32 s12, s12, s13
    s_and_b32 s13, s10, 3
    s_lshl_b32 s13, s13, 2
    s_lshr_b32 s14, s11, 3
    s_add_u32 s13, s13, s14
    s_and_b32 s32, s3, 1
    s_cmp_eq_u32 s32, 0
    s_cselect_b32 s28, s48, s50
    s_cselect_b32 s29, s49, s51
    s_mov_b32 s30, 1966080
    s_mov_b32 s31, 0x00020000
    s_lshr_b32 s33, s3, 1
    s_mul_i32 s34, s12, 122880
    s_mul_i32 s35, s13, 192
    s_add_u32 s34, s34, s35
    s_mul_i32 s35, s33, 96
    s_add_u32 s34, s34, s35
    s_mov_b32 s40, 0xffffff
    s_mov_b32 s41, 0xffffff
    s_mov_b64 exec, s[40:41]
    s_mov_b64 exec, -1
    buffer_load_dwordx4 v[160:163], v180, s[28:31], 0 offen
    buffer_load_dwordx4 v[164:167], v181, s[28:31], 0 offen
    buffer_load_dwordx4 v[168:171], v182, s[28:31], 0 offen
    s_mov_b32 exec_hi, 0xffff
    buffer_load_dwordx4 v[172:175], v183, s[28:31], 0 offen
    s_mov_b64 exec, s[40:41]
    buffer_load_dword v200, v240, s[28:31], s34 offen
    s_add_u32 s34, s34, 6144
    buffer_load_dword v201, v240, s[28:31], s34 offen
    s_add_u32 s34, s34, 6144
    buffer_load_dword v202, v240, s[28:31], s34 offen
    s_add_u32 s34, s34, 6144
    buffer_load_dword v203, v240, s[28:31], s34 offen
    s_add_u32 s34, s34, 6144
    buffer_load_dword v204, v240, s[28:31], s34 offen
    s_add_u32 s34, s34, 6144
    buffer_load_dword v205, v240, s[28:31], s34 offen
    s_add_u32 s34, s34, 6144
    buffer_load_dword v206, v240, s[28:31], s34 offen
    s_add_u32 s34, s34, 6144
    buffer_load_dword v207, v240, s[28:31], s34 offen
    s_add_u32 s34, s34, 6144
    buffer_load_dword v208, v240, s[28:31], s34 offen
    s_add_u32 s34, s34, 6144
    buffer_load_dword v209, v240, s[28:31], s34 offen
    s_add_u32 s34, s34, 6144
    buffer_load_dword v210, v240, s[28:31], s34 offen
    s_add_u32 s34, s34, 6144
    buffer_load_dword v211, v240, s[28:31], s34 offen
    s_add_u32 s34, s34, 6144
    buffer_load_dword v212, v240, s[28:31], s34 offen
    s_add_u32 s34, s34, 6144
    buffer_load_dword v213, v240, s[28:31], s34 offen
    s_add_u32 s34, s34, 6144
    buffer_load_dword v214, v240, s[28:31], s34 offen
    s_add_u32 s34, s34, 6144
    buffer_load_dword v215, v240, s[28:31], s34 offen
    s_add_u32 s34, s34, 6144
    buffer_load_dword v216, v240, s[28:31], s34 offen
    s_add_u32 s34, s34, 6144
    buffer_load_dword v217, v240, s[28:31], s34 offen
    s_add_u32 s34, s34, 6144
    buffer_load_dword v218, v240, s[28:31], s34 offen
    s_add_u32 s34, s34, 6144
    buffer_load_dword v219, v240, s[28:31], s34 offen
    s_add_u32 s34, s34, 6144
    s_mov_b64 exec, -1
    v_mov_b32 v224, -1
    v_mov_b32 v225, -1
    v_mov_b32 v226, -1
    v_mov_b32 v227, -1
    s_lshl_b32 s32, s2, 2
    s_add_u32 s32, s32, s3
    s_add_u32 s28, s8, 7864320
    s_addc_u32 s29, s9, 0
    s_mov_b32 s30, 11665408
    s_mov_b32 s31, 0x00020000
    s_mul_i32 s33, s32, 5120
    buffer_store_dwordx4 v[224:227], v2, s[28:31], s33 offen offset:0 sc1
    buffer_store_dwordx4 v[224:227], v2, s[28:31], s33 offen offset:1024 sc1
    buffer_store_dwordx4 v[224:227], v2, s[28:31], s33 offen offset:2048 sc1
    buffer_store_dwordx4 v[224:227], v2, s[28:31], s33 offen offset:3072 sc1
    s_add_u32 s33, s33, 4096
    buffer_store_dwordx4 v[224:227], v2, s[28:31], s33 offen offset:0 sc1
    s_lshl_b32 s33, s32, 7
    s_add_u32 s33, s33, 11534336
    s_mov_b64 exec, 0xff
    buffer_store_dwordx4 v[224:227], v2, s[28:31], s33 offen sc1
    s_mov_b64 exec, -1
    s_mov_b32 s20, s52
    s_mov_b32 s21, s53
    s_mov_b32 s22, 1966080
    s_mov_b32 s23, 0x00020000
    s_add_u32 s24, s8, 20217856
    s_addc_u32 s25, s9, 0
    s_mov_b32 s26, 3932160
    s_mov_b32 s27, 0x00020000
    s_waitcnt vmcnt(26)
    buffer_store_dwordx4 v[160:163], v184, s[24:27], 0 offen sc1
    buffer_store_dwordx4 v[164:167], v185, s[24:27], 0 offen sc1
    buffer_store_dwordx4 v[168:171], v186, s[24:27], 0 offen sc1
    s_mov_b32 exec_hi, 0xffff
    buffer_store_dwordx4 v[172:175], v187, s[24:27], 0 offen sc1
    s_mov_b64 exec, -1
    s_mov_b32 s35, 0
    buffer_load_dwordx4 v[20:23], v12, s[20:23], s35 offen offset:0
    buffer_load_dwordx4 v[24:27], v13, s[20:23], s35 offen offset:1024
    buffer_load_dwordx4 v[28:31], v14, s[20:23], s35 offen offset:2048
    buffer_load_dwordx4 v[32:35], v15, s[20:23], s35 offen offset:3072
    buffer_load_dwordx4 v[36:39], v16, s[20:23], s35 offen offset:0
    s_mov_b32 s35, 163840
    buffer_load_dwordx4 v[40:43], v12, s[20:23], s35 offen offset:0
    buffer_load_dwordx4 v[44:47], v13, s[20:23], s35 offen offset:1024
    buffer_load_dwordx4 v[48:51], v14, s[20:23], s35 offen offset:2048
    buffer_load_dwordx4 v[52:55], v15, s[20:23], s35 offen offset:3072
    buffer_load_dwordx4 v[56:59], v16, s[20:23], s35 offen offset:0
    s_mov_b64 exec, s[40:41]
    s_add_u32 s24, s8, 19578880
    s_addc_u32 s25, s9, 0
    s_mov_b32 s26, 393216
    s_mov_b32 s27, 0x00020000
    s_and_b32 s32, s3, 1
    s_lshr_b32 s33, s3, 1
    s_mul_i32 s36, s32, 384
    s_mul_i32 s35, s33, 192
    s_add_u32 s36, s36, s35
    s_lshl_b32 s38, s13, 4
    s_mul_i32 s39, s38, 768
    s_add_u32 s39, s39, s36
    s_add_u32 s38, s38, s12
    s_mul_i32 s35, s38, 768
    s_add_u32 s35, s35, s36
    s_waitcnt vmcnt(20)
    v_lshlrev_b32 v220, 16, v200
    v_and_b32 v221, 0xffff0000, v200
    v_lshlrev_b32 v222, 16, v201
    v_and_b32 v223, 0xffff0000, v201
    v_add_f32 v220, v220, v222
    v_add_f32 v221, v221, v223
    v_lshlrev_b32 v222, 16, v202
    v_and_b32 v223, 0xffff0000, v202
    v_add_f32 v220, v220, v222
    v_add_f32 v221, v221, v223
    v_lshlrev_b32 v222, 16, v203
    v_and_b32 v223, 0xffff0000, v203
    v_add_f32 v220, v220, v222
    v_add_f32 v221, v221, v223
    v_lshlrev_b32 v222, 16, v204
    v_and_b32 v223, 0xffff0000, v204
    v_add_f32 v220, v220, v222
    v_add_f32 v221, v221, v223
    v_lshlrev_b32 v222, 16, v205
    v_and_b32 v223, 0xffff0000, v205
    v_add_f32 v220, v220, v222
    v_add_f32 v221, v221, v223
    v_lshlrev_b32 v222, 16, v206
    v_and_b32 v223, 0xffff0000, v206
    v_add_f32 v220, v220, v222
    v_add_f32 v221, v221, v223
    v_lshlrev_b32 v222, 16, v207
    v_and_b32 v223, 0xffff0000, v207
    v_add_f32 v220, v220, v222
    v_add_f32 v221, v221, v223
    v_lshlrev_b32 v222, 16, v208
    v_and_b32 v223, 0xffff0000, v208
    v_add_f32 v220, v220, v222
    v_add_f32 v221, v221, v223
    v_lshlrev_b32 v222, 16, v209
    v_and_b32 v223, 0xffff0000, v209
    v_add_f32 v220, v220, v222
    v_add_f32 v221, v221, v223
    v_lshlrev_b32 v222, 16, v210
    v_and_b32 v223, 0xffff0000, v210
    v_add_f32 v220, v220, v222
    v_add_f32 v221, v221, v223
    v_lshlrev_b32 v222, 16, v211
    v_and_b32 v223, 0xffff0000, v211
    v_add_f32 v220, v220, v222
    v_add_f32 v221, v221, v223
    v_lshlrev_b32 v222, 16, v212
    v_and_b32 v223, 0xffff0000, v212
    v_add_f32 v220, v220, v222
    v_add_f32 v221, v221, v223
    v_lshlrev_b32 v222, 16, v213
    v_and_b32 v223, 0xffff0000, v213
    v_add_f32 v220, v220, v222
    v_add_f32 v221, v221, v223
    v_lshlrev_b32 v222, 16, v214
    v_and_b32 v223, 0xffff0000, v214
    v_add_f32 v220, v220, v222
    v_add_f32 v221, v221, v223
    v_lshlrev_b32 v222, 16, v215
    v_and_b32 v223, 0xffff0000, v215
    v_add_f32 v220, v220, v222
    v_add_f32 v221, v221, v223
    v_lshlrev_b32 v222, 16, v216
    v_and_b32 v223, 0xffff0000, v216
    v_add_f32 v220, v220, v222
    v_add_f32 v221, v221, v223
    v_lshlrev_b32 v222, 16, v217
    v_and_b32 v223, 0xffff0000, v217
    v_add_f32 v220, v220, v222
    v_add_f32 v221, v221, v223
    v_lshlrev_b32 v222, 16, v218
    v_and_b32 v223, 0xffff0000, v218
    v_add_f32 v220, v220, v222
    v_add_f32 v221, v221, v223
    v_lshlrev_b32 v222, 16, v219
    v_and_b32 v223, 0xffff0000, v219
    v_add_f32 v220, v220, v222
    v_add_f32 v221, v221, v223
    s_mov_b64 exec, -1
    s_nop 2
    v_mov_b32 v222, v220
    v_mov_b32 v223, v221
    s_nop 1
    v_permlane32_swap_b32 v220, v222
    v_permlane32_swap_b32 v221, v223
    s_nop 1
    v_add_f32 v220, v220, v222
    v_add_f32 v221, v221, v223
    s_mov_b64 exec, 0xffffff
    buffer_store_dwordx2 v[220:221], v242, s[24:27], s35 offen sc1
    s_mov_b64 exec, -1
    s_lshl_b32 s38, s38, 2
    s_add_u32 s38, s38, s3
    s_lshl_b32 s38, s38, 2
    s_add_u32 s38, s38, 12288
    s_lshl_b32 s42, s13, 8
    s_add_u32 s42, s42, 12288
    s_waitcnt vmcnt(0)
    v_mov_b32 v1, 1
    s_mov_b64 exec, 1
    buffer_store_dword v1, off, s[92:95], s38 sc1
    s_mov_b64 exec, -1
    s_lshl_b32 s32, s2, 2
    s_add_u32 s32, s32, s3
    s_and_b32 s32, s32, 15
    s_lshl_b32 s32, s32, 8
    s_mov_b64 exec, 1
    buffer_atomic_add v1, off, s[92:95], s32 sc1
    s_mov_b64 exec, -1
    s_mov_b32 s35, 327680
    buffer_load_dwordx4 v[60:63], v12, s[20:23], s35 offen offset:0
    buffer_load_dwordx4 v[64:67], v13, s[20:23], s35 offen offset:1024
    buffer_load_dwordx4 v[68:71], v14, s[20:23], s35 offen offset:2048
    buffer_load_dwordx4 v[72:75], v15, s[20:23], s35 offen offset:3072
    buffer_load_dwordx4 v[76:79], v16, s[20:23], s35 offen offset:0
    s_mov_b32 s35, 491520
    buffer_load_dwordx4 v[80:83], v12, s[20:23], s35 offen offset:0
    buffer_load_dwordx4 v[84:87], v13, s[20:23], s35 offen offset:1024
    buffer_load_dwordx4 v[88:91], v14, s[20:23], s35 offen offset:2048
    buffer_load_dwordx4 v[92:95], v15, s[20:23], s35 offen offset:3072
    buffer_load_dwordx4 v[96:99], v16, s[20:23], s35 offen offset:0
    s_mov_b32 s35, 655360
    buffer_load_dwordx4 v[100:103], v12, s[20:23], s35 offen offset:0
    buffer_load_dwordx4 v[104:107], v13, s[20:23], s35 offen offset:1024
    buffer_load_dwordx4 v[108:111], v14, s[20:23], s35 offen offset:2048
    buffer_load_dwordx4 v[112:115], v15, s[20:23], s35 offen offset:3072
    buffer_load_dwordx4 v[116:119], v16, s[20:23], s35 offen offset:0
    s_mov_b32 s35, 819200
    buffer_load_dwordx4 v[120:123], v12, s[20:23], s35 offen offset:0
    buffer_load_dwordx4 v[124:127], v13, s[20:23], s35 offen offset:1024
    buffer_load_dwordx4 v[128:131], v14, s[20:23], s35 offen offset:2048
    buffer_load_dwordx4 v[132:135], v15, s[20:23], s35 offen offset:3072
    buffer_load_dwordx4 v[136:139], v16, s[20:23], s35 offen offset:0
    s_mov_b32 s35, 1310720
    buffer_load_dwordx4 v[140:143], v12, s[20:23], s35 offen offset:0
    buffer_load_dwordx4 v[144:147], v13, s[20:23], s35 offen offset:1024
    buffer_load_dwordx4 v[148:151], v14, s[20:23], s35 offen offset:2048
    buffer_load_dwordx4 v[152:155], v15, s[20:23], s35 offen offset:3072
    buffer_load_dwordx4 v[156:159], v16, s[20:23], s35 offen offset:0
    s_mov_b32 s35, 1474560
    buffer_load_dwordx4 v[160:163], v12, s[20:23], s35 offen offset:0
    buffer_load_dwordx4 v[164:167], v13, s[20:23], s35 offen offset:1024
    buffer_load_dwordx4 v[168:171], v14, s[20:23], s35 offen offset:2048
    buffer_load_dwordx4 v[172:175], v15, s[20:23], s35 offen offset:3072
    buffer_load_dwordx4 v[176:179], v16, s[20:23], s35 offen offset:0
    s_mov_b32 s35, 1638400
    buffer_load_dwordx4 v[180:183], v12, s[20:23], s35 offen offset:0
    buffer_load_dwordx4 v[184:187], v13, s[20:23], s35 offen offset:1024
    buffer_load_dwordx4 v[188:191], v14, s[20:23], s35 offen offset:2048
    buffer_load_dwordx4 v[192:195], v15, s[20:23], s35 offen offset:3072
    buffer_load_dwordx4 v[196:199], v16, s[20:23], s35 offen offset:0
    s_mov_b32 s35, 1802240
    buffer_load_dwordx4 v[200:203], v12, s[20:23], s35 offen offset:0
    buffer_load_dwordx4 v[204:207], v13, s[20:23], s35 offen offset:1024
    buffer_load_dwordx4 v[208:211], v14, s[20:23], s35 offen offset:2048
    buffer_load_dwordx4 v[212:215], v15, s[20:23], s35 offen offset:3072
    buffer_load_dwordx4 v[216:219], v16, s[20:23], s35 offen offset:0
    v_and_b32 v250, 63, v0
    v_lshlrev_b32 v250, 2, v250
    s_mov_b32 s46, 0
L_poll5:
    s_sleep 16
    buffer_load_dword v251, v250, s[92:95], s42 offen sc1
    s_waitcnt vmcnt(0)
    v_cmp_eq_u32 vcc, 0, v251
    s_add_u32 s46, s46, 1
    s_nop 2
    s_cmp_eq_u64 vcc, 0
    s_cbranch_scc1 L_poll5_x
    s_cmp_lt_u32 s46, 0x40000
    s_cbranch_scc1 L_poll5
L_poll5_x:
    s_mov_b64 exec, s[40:41]
    buffer_load_dwordx2 v[224:225], v241, s[24:27], s39 offen sc1
    s_add_u32 s39, s39, 1536
    buffer_load_dwordx2 v[226:227], v241, s[24:27], s39 offen sc1
    s_add_u32 s39, s39, 1536
    buffer_load_dwordx2 v[228:229], v241, s[24:27], s39 offen sc1
    s_add_u32 s39, s39, 1536
    buffer_load_dwordx2 v[230:231], v241, s[24:27], s39 offen sc1
    s_add_u32 s39, s39, 1536
    buffer_load_dwordx2 v[232:233], v241, s[24:27], s39 offen sc1
    s_add_u32 s39, s39, 1536
    buffer_load_dwordx2 v[234:235], v241, s[24:27], s39 offen sc1
    s_add_u32 s39, s39, 1536
    buffer_load_dwordx2 v[236:237], v241, s[24:27], s39 offen sc1
    s_add_u32 s39, s39, 1536
    buffer_load_dwordx2 v[238:239], v241, s[24:27], s39 offen sc1
    s_add_u32 s39, s39, 1536
    s_waitcnt vmcnt(0)
    v_add_f32 v224, v224, v226
    v_add_f32 v225, v225, v227
    v_add_f32 v224, v224, v228
    v_add_f32 v225, v225, v229
    v_add_f32 v224, v224, v230
    v_add_f32 v225, v225, v231
    v_add_f32 v224, v224, v232
    v_add_f32 v225, v225, v233
    v_add_f32 v224, v224, v234
    v_add_f32 v225, v225, v235
    v_add_f32 v224, v224, v236
    v_add_f32 v225, v225, v237
    v_add_f32 v224, v224, v238
    v_add_f32 v225, v225, v239
    s_mov_b64 exec, -1
    s_nop 2
    v_mov_b32 v226, v224
    v_mov_b32 v227, v225
    s_nop 1
    v_permlane32_swap_b32 v224, v226
    v_permlane32_swap_b32 v225, v227
    s_nop 1
    v_add_f32 v224, v224, v226
    v_add_f32 v225, v225, v227
    s_mul_i32 s35, s2, 768
    s_add_u32 s35, s35, s36
    s_add_u32 s35, s35, 196608
    s_mov_b64 exec, 0xffffff
    buffer_store_dwordx2 v[224:225], v242, s[24:27], s35 offen
    s_nop 1
    s_mov_b64 exec, -1
    s_cmp_lg_u32 s3, 0
    s_cbranch_scc1 L_npw
    v_and_b32 v1, 15, v0
    v_lshlrev_b32 v1, 8, v1
    s_mov_b32 s46, 0
L_pw6:
    buffer_load_dword v224, v1, s[92:95], 0 offen sc1
    s_add_u32 s46, s46, 1
    s_waitcnt vmcnt(0)
    v_cmp_ne_u32 vcc, 64, v224
    s_cmp_gt_u32 s46, 0x20000
    s_cbranch_scc1 L_pw6_x
    s_cmp_eq_u64 vcc, 0
    s_cbranch_scc1 L_pw6_x
    s_sleep 16
    s_branch L_pw6
L_pw6_x:
    s_add_u32 s24, s8, 20217856
    s_addc_u32 s25, s9, 0
    s_mov_b32 s26, 3932160
    s_mov_b32 s27, 0x00020000
    s_and_b32 s32, s10, 3
    s_lshl_b32 s32, s32, 7
    s_lshl_b32 s33, s11, 2
    s_add_u32 s32, s32, s33
    s_mul_i32 s32, s32, 7680
    v_lshlrev_b32 v1, 7, v0
    buffer_load_dword v252, v1, s[24:27], s32 offen sc1
    s_add_u32 s32, s32, 8192
    buffer_load_dword v252, v1, s[24:27], s32 offen sc1
    s_add_u32 s32, s32, 8192
    buffer_load_dword v252, v1, s[24:27], s32 offen sc1
    s_add_u32 s32, s32, 8192
    buffer_load_dword v252, v1, s[24:27], s32 offen sc1
    s_add_u32 s32, s32, 8192
L_npw:
    s_mov_b32 s20, s6
    s_mov_b32 s21, s7
    s_mov_b32 s22, 819200
    s_mov_b32 s23, 0x00020000
    s_mul_i32 s34, s3, 40960
    s_add_u32 s34, s34, 704
    s_lshr_b32 s35, s10, 1
    s_add_u32 s35, s35, s3
    s_add_u32 s35, s35, 1
    s_and_b32 s35, s35, 3
    s_mul_i32 s35, s35, 204800
    s_mul_i32 s32, s3, 40960
    v_subrev_u32 v220, s32, v12
    v_subrev_u32 v221, s32, v13
    v_subrev_u32 v222, s32, v14
    v_subrev_u32 v223, s32, v15
    v_subrev_u32 v224, s32, v16
    s_barrier
    s_add_u32 m0, s34, 0
    s_nop 0
    buffer_load_dwordx4 v220, s[20:23], s35 offen offset:0 lds
    buffer_load_dwordx4 v221, s[20:23], s35 offen offset:1024 lds
    buffer_load_dwordx4 v222, s[20:23], s35 offen offset:2048 lds
    buffer_load_dwordx4 v223, s[20:23], s35 offen offset:3072 lds
    s_add_u32 m0, s34, 4096
    s_nop 0
    buffer_load_dwordx4 v224, s[20:23], s35 offen lds
    s_add_u32 s35, s35, 40960
    s_add_u32 m0, s34, 5120
    s_nop 0
    buffer_load_dwordx4 v220, s[20:23], s35 offen offset:0 lds
    buffer_load_dwordx4 v221, s[20:23], s35 offen offset:1024 lds
    buffer_load_dwordx4 v222, s[20:23], s35 offen offset:2048 lds
    buffer_load_dwordx4 v223, s[20:23], s35 offen offset:3072 lds
    s_add_u32 m0, s34, 9216
    s_nop 0
    buffer_load_dwordx4 v224, s[20:23], s35 offen lds
    s_add_u32 s35, s35, 40960
    s_add_u32 m0, s34, 10240
    s_nop 0
    buffer_load_dwordx4 v220, s[20:23], s35 offen offset:0 lds
    buffer_load_dwordx4 v221, s[20:23], s35 offen offset:1024 lds
    buffer_load_dwordx4 v222, s[20:23], s35 offen offset:2048 lds
    buffer_load_dwordx4 v223, s[20:23], s35 offen offset:3072 lds
    s_add_u32 m0, s34, 14336
    s_nop 0
    buffer_load_dwordx4 v224, s[20:23], s35 offen lds
    s_add_u32 s35, s35, 40960
    s_add_u32 m0, s34, 15360
    s_nop 0
    buffer_load_dwordx4 v220, s[20:23], s35 offen offset:0 lds
    buffer_load_dwordx4 v221, s[20:23], s35 offen offset:1024 lds
    buffer_load_dwordx4 v222, s[20:23], s35 offen offset:2048 lds
    buffer_load_dwordx4 v223, s[20:23], s35 offen offset:3072 lds
    s_add_u32 m0, s34, 19456
    s_nop 0
    buffer_load_dwordx4 v224, s[20:23], s35 offen lds
    s_add_u32 s35, s35, 40960
    s_add_u32 m0, s34, 20480
    s_nop 0
    buffer_load_dwordx4 v220, s[20:23], s35 offen offset:0 lds
    buffer_load_dwordx4 v221, s[20:23], s35 offen offset:1024 lds
    buffer_load_dwordx4 v222, s[20:23], s35 offen offset:2048 lds
    buffer_load_dwordx4 v223, s[20:23], s35 offen offset:3072 lds
    s_add_u32 m0, s34, 24576
    s_nop 0
    buffer_load_dwordx4 v224, s[20:23], s35 offen lds
    s_add_u32 s35, s35, 40960
    s_setprio 0
    s_waitcnt vmcnt(0)
    s_barrier
    s_add_u32 s16, s8, 10485760
    s_addc_u32 s17, s9, 0
    s_mov_b32 s18, 2621440
    s_mov_b32 s19, 0x00020000
    s_add_u32 s20, s8, 20217856
    s_addc_u32 s21, s9, 0
    s_mov_b32 s22, 3932160
    s_mov_b32 s23, 0x00020000
    s_mul_i32 s40, s13, 245760
    s_mul_i32 s34, s3, 6144
    s_add_u32 s40, s40, s34
    s_lshl_b32 s33, s3, 12
    s_add_u32 s34, s34, 49152
    v_add_u32 v3, s33, v2
    s_mov_b32 s46, 0
    s_add_u32 s24, s8, 19398656
    s_addc_u32 s25, s9, 0
    s_mov_b32 s26, 131072
    s_mov_b32 s27, 0x00020000
    s_lshl_b32 s32, s12, 3
    s_lshl_b32 s41, s3, 1
    s_add_u32 s41, s41, s32
    s_lshl_b32 s41, s41, 10
    v_bfe_u32 v6, v0, 4, 1
    v_lshlrev_b32 v6, 10, v6
    v_lshrrev_b32 v1, 5, v0
    v_lshl_add_u32 v6, v1, 9, v6
    v_and_b32 v1, 15, v0
    v_lshl_add_u32 v6, v1, 3, v6
    v_and_b32 v1, 31, v0
    s_lshl_b32 s32, s3, 8
    s_add_u32 s32, s32, 16384
    v_lshlrev_b32 v7, 3, v1
    v_add_u32 v7, s32, v7
    s_barrier
    s_barrier
    s_add_u32 m0, s34, 0
    s_add_u32 s35, s40, 0
    buffer_load_dwordx4 v2, s[20:23], s35 offen offset:0 sc1 lds
    buffer_load_dwordx4 v2, s[20:23], s35 offen offset:1024 sc1 lds
    buffer_load_dwordx4 v2, s[20:23], s35 offen offset:2048 sc1 lds
    s_add_u32 m0, s34, 3072
    s_add_u32 s35, s40, 3072
    buffer_load_dwordx4 v2, s[20:23], s35 offen offset:0 sc1 lds
    buffer_load_dwordx4 v2, s[20:23], s35 offen offset:1024 sc1 lds
    buffer_load_dwordx4 v2, s[20:23], s35 offen offset:2048 sc1 lds
    s_add_u32 m0, s34, 24576
    s_add_u32 s35, s40, 24576
    buffer_load_dwordx4 v2, s[20:23], s35 offen offset:0 sc1 lds
    buffer_load_dwordx4 v2, s[20:23], s35 offen offset:1024 sc1 lds
    buffer_load_dwordx4 v2, s[20:23], s35 offen offset:2048 sc1 lds
    s_add_u32 m0, s34, 27648
    s_add_u32 s35, s40, 27648
    buffer_load_dwordx4 v2, s[20:23], s35 offen offset:0 sc1 lds
    buffer_load_dwordx4 v2, s[20:23], s35 offen offset:1024 sc1 lds
    buffer_load_dwordx4 v2, s[20:23], s35 offen offset:2048 sc1 lds
    s_add_u32 m0, s34, 49152
    s_add_u32 s35, s40, 49152
    buffer_load_dwordx4 v2, s[20:23], s35 offen offset:0 sc1 lds
    buffer_load_dwordx4 v2, s[20:23], s35 offen offset:1024 sc1 lds
    buffer_load_dwordx4 v2, s[20:23], s35 offen offset:2048 sc1 lds
    s_add_u32 m0, s34, 52224
    s_add_u32 s35, s40, 52224
    buffer_load_dwordx4 v2, s[20:23], s35 offen offset:0 sc1 lds
    buffer_load_dwordx4 v2, s[20:23], s35 offen offset:1024 sc1 lds
    buffer_load_dwordx4 v2, s[20:23], s35 offen offset:2048 sc1 lds
    s_add_u32 m0, s33, 0
    s_movk_i32 s35, 0
    buffer_load_dwordx4 v4, s[16:19], s35 offen offset:0 sc1 lds
    buffer_load_dwordx4 v4, s[16:19], s35 offen offset:1024 sc1 lds
    buffer_load_dwordx4 v5, s[16:19], s35 offen offset:2048 sc1 lds
    buffer_load_dwordx4 v5, s[16:19], s35 offen offset:3072 sc1 lds
    s_waitcnt vmcnt(0)
L_gv0:
    ds_read_b128 v[224:227], v3 offset:0
    ds_read_b128 v[228:231], v3 offset:1024
    ds_read_b128 v[232:235], v3 offset:2048
    ds_read_b128 v[236:239], v3 offset:3072
    s_waitcnt lgkmcnt(0)
    v_max3_u32 v224, v224, v225, v226
    v_max3_u32 v224, v224, v227, v228
    v_max3_u32 v224, v224, v229, v230
    v_max3_u32 v224, v224, v231, v232
    v_max3_u32 v224, v224, v233, v234
    v_max3_u32 v224, v224, v235, v236
    v_max3_u32 v224, v224, v237, v238
    v_max_u32 v224, v224, v239
    v_cmp_eq_u32 vcc, -1, v224
    s_nop 3
    s_cmp_lg_u64 vcc, 0
    s_cbranch_scc1 L_gr0
L_go0:
    s_add_u32 m0, s33, 16384
    s_movk_i32 s35, 2048
    buffer_load_dwordx4 v4, s[16:19], s35 offen offset:0 sc1 lds
    buffer_load_dwordx4 v4, s[16:19], s35 offen offset:1024 sc1 lds
    buffer_load_dwordx4 v5, s[16:19], s35 offen offset:2048 sc1 lds
    buffer_load_dwordx4 v5, s[16:19], s35 offen offset:3072 sc1 lds
    s_add_u32 m0, s33, 32768
    s_movk_i32 s35, 4096
    buffer_load_dwordx4 v4, s[16:19], s35 offen offset:0 sc1 lds
    buffer_load_dwordx4 v4, s[16:19], s35 offen offset:1024 sc1 lds
    buffer_load_dwordx4 v5, s[16:19], s35 offen offset:2048 sc1 lds
    buffer_load_dwordx4 v5, s[16:19], s35 offen offset:3072 sc1 lds
    s_waitcnt vmcnt(24)
    s_barrier
    s_waitcnt vmcnt(4)
L_gv1:
    ds_read_b128 v[224:227], v3 offset:16384
    ds_read_b128 v[228:231], v3 offset:17408
    ds_read_b128 v[232:235], v3 offset:18432
    ds_read_b128 v[236:239], v3 offset:19456
    s_waitcnt lgkmcnt(0)
    v_max3_u32 v224, v224, v225, v226
    v_max3_u32 v224, v224, v227, v228
    v_max3_u32 v224, v224, v229, v230
    v_max3_u32 v224, v224, v231, v232
    v_max3_u32 v224, v224, v233, v234
    v_max3_u32 v224, v224, v235, v236
    v_max3_u32 v224, v224, v237, v238
    v_max_u32 v224, v224, v239
    v_cmp_eq_u32 vcc, -1, v224
    s_nop 3
    s_cmp_lg_u64 vcc, 0
    s_cbranch_scc1 L_gr1
L_go1:
    s_waitcnt vmcnt(18)
    s_barrier
    s_add_u32 m0, s33, 0
    s_movk_i32 s35, 6144
    buffer_load_dwordx4 v4, s[16:19], s35 offen offset:0 sc1 lds
    buffer_load_dwordx4 v4, s[16:19], s35 offen offset:1024 sc1 lds
    buffer_load_dwordx4 v5, s[16:19], s35 offen offset:2048 sc1 lds
    buffer_load_dwordx4 v5, s[16:19], s35 offen offset:3072 sc1 lds
    s_add_u32 m0, s34, 0
    s_add_u32 s35, s40, 73728
    buffer_load_dwordx4 v2, s[20:23], s35 offen offset:0 sc1 lds
    buffer_load_dwordx4 v2, s[20:23], s35 offen offset:1024 sc1 lds
    buffer_load_dwordx4 v2, s[20:23], s35 offen offset:2048 sc1 lds
    s_add_u32 m0, s34, 3072
    s_add_u32 s35, s40, 76800
    buffer_load_dwordx4 v2, s[20:23], s35 offen offset:0 sc1 lds
    buffer_load_dwordx4 v2, s[20:23], s35 offen offset:1024 sc1 lds
    buffer_load_dwordx4 v2, s[20:23], s35 offen offset:2048 sc1 lds
    s_waitcnt vmcnt(10)
L_gv2:
    ds_read_b128 v[224:227], v3 offset:32768
    ds_read_b128 v[228:231], v3 offset:33792
    ds_read_b128 v[232:235], v3 offset:34816
    ds_read_b128 v[236:239], v3 offset:35840
    s_waitcnt lgkmcnt(0)
    v_max3_u32 v224, v224, v225, v226
    v_max3_u32 v224, v224, v227, v228
    v_max3_u32 v224, v224, v229, v230
    v_max3_u32 v224, v224, v231, v232
    v_max3_u32 v224, v224, v233, v234
    v_max3_u32 v224, v224, v235, v236
    v_max3_u32 v224, v224, v237, v238
    v_max_u32 v224, v224, v239
    v_cmp_eq_u32 vcc, -1, v224
    s_nop 3
    s_cmp_lg_u64 vcc, 0
    s_cbranch_scc1 L_gr2
L_go2:
    s_waitcnt vmcnt(22)
    s_barrier
    s_add_u32 m0, s33, 16384
    s_movk_i32 s35, 8192
    buffer_load_dwordx4 v4, s[16:19], s35 offen offset:0 sc1 lds
    buffer_load_dwordx4 v4, s[16:19], s35 offen offset:1024 sc1 lds
    buffer_load_dwordx4 v5, s[16:19], s35 offen offset:2048 sc1 lds
    buffer_load_dwordx4 v5, s[16:19], s35 offen offset:3072 sc1 lds
    s_add_u32 m0, s34, 24576
    s_add_u32 s35, s40, 98304
    buffer_load_dwordx4 v2, s[20:23], s35 offen offset:0 sc1 lds
    buffer_load_dwordx4 v2, s[20:23], s35 offen offset:1024 sc1 lds
    buffer_load_dwordx4 v2, s[20:23], s35 offen offset:2048 sc1 lds
    s_add_u32 m0, s34, 27648
    s_add_u32 s35, s40, 101376
    buffer_load_dwordx4 v2, s[20:23], s35 offen offset:0 sc1 lds
    buffer_load_dwordx4 v2, s[20:23], s35 offen offset:1024 sc1 lds
    buffer_load_dwordx4 v2, s[20:23], s35 offen offset:2048 sc1 lds
    s_waitcnt vmcnt(16)
L_gv3:
    ds_read_b128 v[224:227], v3 offset:0
    ds_read_b128 v[228:231], v3 offset:1024
    ds_read_b128 v[232:235], v3 offset:2048
    ds_read_b128 v[236:239], v3 offset:3072
    s_waitcnt lgkmcnt(0)
    v_max3_u32 v224, v224, v225, v226
    v_max3_u32 v224, v224, v227, v228
    v_max3_u32 v224, v224, v229, v230
    v_max3_u32 v224, v224, v231, v232
    v_max3_u32 v224, v224, v233, v234
    v_max3_u32 v224, v224, v235, v236
    v_max3_u32 v224, v224, v237, v238
    v_max_u32 v224, v224, v239
    v_cmp_eq_u32 vcc, -1, v224
    s_nop 3
    s_cmp_lg_u64 vcc, 0
    s_cbranch_scc1 L_gr3
L_go3:
    s_waitcnt vmcnt(10)
    s_barrier
    s_add_u32 m0, s33, 32768
    s_movk_i32 s35, 10240
    buffer_load_dwordx4 v4, s[16:19], s35 offen offset:0 sc1 lds
    buffer_load_dwordx4 v4, s[16:19], s35 offen offset:1024 sc1 lds
    buffer_load_dwordx4 v5, s[16:19], s35 offen offset:2048 sc1 lds
    buffer_load_dwordx4 v5, s[16:19], s35 offen offset:3072 sc1 lds
    s_add_u32 m0, s34, 49152
    s_add_u32 s35, s40, 122880
    buffer_load_dwordx4 v2, s[20:23], s35 offen offset:0 sc1 lds
    buffer_load_dwordx4 v2, s[20:23], s35 offen offset:1024 sc1 lds
    buffer_load_dwordx4 v2, s[20:23], s35 offen offset:2048 sc1 lds
    s_add_u32 m0, s34, 52224
    s_add_u32 s35, s40, 125952
    buffer_load_dwordx4 v2, s[20:23], s35 offen offset:0 sc1 lds
    buffer_load_dwordx4 v2, s[20:23], s35 offen offset:1024 sc1 lds
    buffer_load_dwordx4 v2, s[20:23], s35 offen offset:2048 sc1 lds
    s_waitcnt vmcnt(16)
L_gv4:
    ds_read_b128 v[224:227], v3 offset:16384
    ds_read_b128 v[228:231], v3 offset:17408
    ds_read_b128 v[232:235], v3 offset:18432
    ds_read_b128 v[236:239], v3 offset:19456
    s_waitcnt lgkmcnt(0)
    v_max3_u32 v224, v224, v225, v226
    v_max3_u32 v224, v224, v227, v228
    v_max3_u32 v224, v224, v229, v230
    v_max3_u32 v224, v224, v231, v232
    v_max3_u32 v224, v224, v233, v234
    v_max3_u32 v224, v224, v235, v236
    v_max3_u32 v224, v224, v237, v238
    v_max_u32 v224, v224, v239
    v_cmp_eq_u32 vcc, -1, v224
    s_nop 3
    s_cmp_lg_u64 vcc, 0
    s_cbranch_scc1 L_gr4
L_go4:
    s_waitcnt vmcnt(10)
    s_barrier
    s_add_u32 m0, s33, 0
    s_movk_i32 s35, 12288
    buffer_load_dwordx4 v4, s[16:19], s35 offen offset:0 sc1 lds
    buffer_load_dwordx4 v4, s[16:19], s35 offen offset:1024 sc1 lds
    buffer_load_dwordx4 v5, s[16:19], s35 offen offset:2048 sc1 lds
    buffer_load_dwordx4 v5, s[16:19], s35 offen offset:3072 sc1 lds
    s_add_u32 m0, s34, 0
    s_add_u32 s35, s40, 147456
    buffer_load_dwordx4 v2, s[20:23], s35 offen offset:0 sc1 lds
    buffer_load_dwordx4 v2, s[20:23], s35 offen offset:1024 sc1 lds
    buffer_load_dwordx4 v2, s[20:23], s35 offen offset:2048 sc1 lds
    s_add_u32 m0, s34, 3072
    s_add_u32 s35, s40, 150528
    buffer_load_dwordx4 v2, s[20:23], s35 offen offset:0 sc1 lds
    buffer_load_dwordx4 v2, s[20:23], s35 offen offset:1024 sc1 lds
    buffer_load_dwordx4 v2, s[20:23], s35 offen offset:2048 sc1 lds
    s_waitcnt vmcnt(16)
L_gv5:
    ds_read_b128 v[224:227], v3 offset:32768
    ds_read_b128 v[228:231], v3 offset:33792
    ds_read_b128 v[232:235], v3 offset:34816
    ds_read_b128 v[236:239], v3 offset:35840
    s_waitcnt lgkmcnt(0)
    v_max3_u32 v224, v224, v225, v226
    v_max3_u32 v224, v224, v227, v228
    v_max3_u32 v224, v224, v229, v230
    v_max3_u32 v224, v224, v231, v232
    v_max3_u32 v224, v224, v233, v234
    v_max3_u32 v224, v224, v235, v236
    v_max3_u32 v224, v224, v237, v238
    v_max_u32 v224, v224, v239
    v_cmp_eq_u32 vcc, -1, v224
    s_nop 3
    s_cmp_lg_u64 vcc, 0
    s_cbranch_scc1 L_gr5
L_go5:
    s_waitcnt vmcnt(10)
    s_barrier
    s_add_u32 m0, s33, 16384
    s_movk_i32 s35, 14336
    buffer_load_dwordx4 v4, s[16:19], s35 offen offset:0 sc1 lds
    buffer_load_dwordx4 v4, s[16:19], s35 offen offset:1024 sc1 lds
    buffer_load_dwordx4 v5, s[16:19], s35 offen offset:2048 sc1 lds
    buffer_load_dwordx4 v5, s[16:19], s35 offen offset:3072 sc1 lds
    s_add_u32 m0, s34, 24576
    s_add_u32 s35, s40, 172032
    buffer_load_dwordx4 v2, s[20:23], s35 offen offset:0 sc1 lds
    buffer_load_dwordx4 v2, s[20:23], s35 offen offset:1024 sc1 lds
    buffer_load_dwordx4 v2, s[20:23], s35 offen offset:2048 sc1 lds
    s_add_u32 m0, s34, 27648
    s_add_u32 s35, s40, 175104
    buffer_load_dwordx4 v2, s[20:23], s35 offen offset:0 sc1 lds
    buffer_load_dwordx4 v2, s[20:23], s35 offen offset:1024 sc1 lds
    buffer_load_dwordx4 v2, s[20:23], s35 offen offset:2048 sc1 lds
    s_waitcnt vmcnt(16)
L_gv6:
    ds_read_b128 v[224:227], v3 offset:0
    ds_read_b128 v[228:231], v3 offset:1024
    ds_read_b128 v[232:235], v3 offset:2048
    ds_read_b128 v[236:239], v3 offset:3072
    s_waitcnt lgkmcnt(0)
    v_max3_u32 v224, v224, v225, v226
    v_max3_u32 v224, v224, v227, v228
    v_max3_u32 v224, v224, v229, v230
    v_max3_u32 v224, v224, v231, v232
    v_max3_u32 v224, v224, v233, v234
    v_max3_u32 v224, v224, v235, v236
    v_max3_u32 v224, v224, v237, v238
    v_max_u32 v224, v224, v239
    v_cmp_eq_u32 vcc, -1, v224
    s_nop 3
    s_cmp_lg_u64 vcc, 0
    s_cbranch_scc1 L_gr6
L_go6:
    s_waitcnt vmcnt(10)
    s_barrier
    s_add_u32 m0, s33, 32768
    s_movk_i32 s35, 16384
    buffer_load_dwordx4 v4, s[16:19], s35 offen offset:0 sc1 lds
    buffer_load_dwordx4 v4, s[16:19], s35 offen offset:1024 sc1 lds
    buffer_load_dwordx4 v5, s[16:19], s35 offen offset:2048 sc1 lds
    buffer_load_dwordx4 v5, s[16:19], s35 offen offset:3072 sc1 lds
    s_add_u32 m0, s34, 49152
    s_add_u32 s35, s40, 196608
    buffer_load_dwordx4 v2, s[20:23], s35 offen offset:0 sc1 lds
    buffer_load_dwordx4 v2, s[20:23], s35 offen offset:1024 sc1 lds
    buffer_load_dwordx4 v2, s[20:23], s35 offen offset:2048 sc1 lds
    s_add_u32 m0, s34, 52224
    s_add_u32 s35, s40, 199680
    buffer_load_dwordx4 v2, s[20:23], s35 offen offset:0 sc1 lds
    buffer_load_dwordx4 v2, s[20:23], s35 offen offset:1024 sc1 lds
    buffer_load_dwordx4 v2, s[20:23], s35 offen offset:2048 sc1 lds
    buffer_load_dwordx2 v[240:241], v6, s[24:27], s41 offen offset:0 sc1
    buffer_load_dwordx2 v[242:243], v6, s[24:27], s41 offen offset:128 sc1
    buffer_load_dwordx2 v[244:245], v6, s[24:27], s41 offen offset:256 sc1
    buffer_load_dwordx2 v[246:247], v6, s[24:27], s41 offen offset:384 sc1
    s_waitcnt vmcnt(20)
L_gv7:
    ds_read_b128 v[224:227], v3 offset:16384
    ds_read_b128 v[228:231], v3 offset:17408
    ds_read_b128 v[232:235], v3 offset:18432
    ds_read_b128 v[236:239], v3 offset:19456
    s_waitcnt lgkmcnt(0)
    v_max3_u32 v224, v224, v225, v226
    v_max3_u32 v224, v224, v227, v228
    v_max3_u32 v224, v224, v229, v230
    v_max3_u32 v224, v224, v231, v232
    v_max3_u32 v224, v224, v233, v234
    v_max3_u32 v224, v224, v235, v236
    v_max3_u32 v224, v224, v237, v238
    v_max_u32 v224, v224, v239
    v_cmp_eq_u32 vcc, -1, v224
    s_nop 3
    s_cmp_lg_u64 vcc, 0
    s_cbranch_scc1 L_gr7
L_go7:
    s_waitcnt vmcnt(14)
    s_barrier
    s_add_u32 m0, s33, 0
    s_movk_i32 s35, 18432
    buffer_load_dwordx4 v4, s[16:19], s35 offen offset:0 sc1 lds
    buffer_load_dwordx4 v4, s[16:19], s35 offen offset:1024 sc1 lds
    buffer_load_dwordx4 v5, s[16:19], s35 offen offset:2048 sc1 lds
    buffer_load_dwordx4 v5, s[16:19], s35 offen offset:3072 sc1 lds
    s_add_u32 m0, s34, 0
    s_add_u32 s35, s40, 221184
    buffer_load_dwordx4 v2, s[20:23], s35 offen offset:0 sc1 lds
    buffer_load_dwordx4 v2, s[20:23], s35 offen offset:1024 sc1 lds
    buffer_load_dwordx4 v2, s[20:23], s35 offen offset:2048 sc1 lds
    s_add_u32 m0, s34, 3072
    s_add_u32 s35, s40, 224256
    buffer_load_dwordx4 v2, s[20:23], s35 offen offset:0 sc1 lds
    buffer_load_dwordx4 v2, s[20:23], s35 offen offset:1024 sc1 lds
    buffer_load_dwordx4 v2, s[20:23], s35 offen offset:2048 sc1 lds
    s_waitcnt vmcnt(20)
L_gv8:
    ds_read_b128 v[224:227], v3 offset:32768
    ds_read_b128 v[228:231], v3 offset:33792
    ds_read_b128 v[232:235], v3 offset:34816
    ds_read_b128 v[236:239], v3 offset:35840
    s_waitcnt lgkmcnt(0)
    v_max3_u32 v224, v224, v225, v226
    v_max3_u32 v224, v224, v227, v228
    v_max3_u32 v224, v224, v229, v230
    v_max3_u32 v224, v224, v231, v232
    v_max3_u32 v224, v224, v233, v234
    v_max3_u32 v224, v224, v235, v236
    v_max3_u32 v224, v224, v237, v238
    v_max_u32 v224, v224, v239
    v_cmp_eq_u32 vcc, -1, v224
    s_nop 3
    s_cmp_lg_u64 vcc, 0
    s_cbranch_scc1 L_gr8
L_go8:
    s_waitcnt vmcnt(14)
    s_barrier
    s_mov_b32 s20, s52
    s_mov_b32 s21, s53
    s_mov_b32 s22, 1966080
    s_mov_b32 s23, 0x00020000
    s_mov_b32 s35, 983040
    s_mul_i32 s34, s3, 5120
    s_add_u32 m0, s34, 122880
    s_nop 0
    buffer_load_dwordx4 v12, s[20:23], s35 offen offset:0 lds
    buffer_load_dwordx4 v13, s[20:23], s35 offen offset:1024 lds
    buffer_load_dwordx4 v14, s[20:23], s35 offen offset:2048 lds
    buffer_load_dwordx4 v15, s[20:23], s35 offen offset:3072 lds
    s_add_u32 m0, s34, 126976
    s_nop 0
    buffer_load_dwordx4 v16, s[20:23], s35 offen lds
    s_waitcnt vmcnt(15)
L_gsv:
    v_max3_u32 v1, v240, v241, v242
    v_max3_u32 v1, v1, v243, v244
    v_max3_u32 v1, v1, v245, v246
    v_max_u32 v1, v1, v247
    v_cmp_eq_u32 vcc, -1, v1
    s_nop 3
    s_cmp_lg_u64 vcc, 0
    s_cbranch_scc1 L_gsr
L_gso:
    v_add_f32 v240, v240, v242
    v_add_f32 v241, v241, v243
    v_add_f32 v240, v240, v244
    v_add_f32 v241, v241, v245
    v_add_f32 v240, v240, v246
    v_add_f32 v241, v241, v247
    s_nop 2
    v_mov_b32 v242, v240
    v_mov_b32 v243, v241
    s_nop 1
    v_permlane32_swap_b32 v240, v242
    v_permlane32_swap_b32 v241, v243
    s_nop 1
    v_add_f32 v240, v240, v242
    v_add_f32 v241, v241, v243
    v_mul_f32 v240, 0x3acccccd, v240
    v_mul_f32 v241, 0x3acccccd, v241
    v_fma_f32 v241, -v240, v240, v241
    v_max_f32 v241, 0, v241
    v_cvt_pk_bf16_f32 v241, v240, v241
    v_lshlrev_b32 v240, 16, v241
    v_and_b32 v241, 0xffff0000, v241
    v_add_f32 v241, 0x3727c5ac, v241
    v_cvt_pk_bf16_f32 v241, 0, v241
    v_sqrt_f32 v241, v241
    s_nop 0
    v_cvt_pk_bf16_f32 v241, 0, v241
    v_rcp_f32 v241, v241
    s_nop 0
    ds_write_b64 v7, v[240:241]
    s_waitcnt lgkmcnt(0)
    s_waitcnt vmcnt(11)
L_gv9:
    ds_read_b128 v[224:227], v3 offset:0
    ds_read_b128 v[228:231], v3 offset:1024
    ds_read_b128 v[232:235], v3 offset:2048
    ds_read_b128 v[236:239], v3 offset:3072
    s_waitcnt lgkmcnt(0)
    v_max3_u32 v224, v224, v225, v226
    v_max3_u32 v224, v224, v227, v228
    v_max3_u32 v224, v224, v229, v230
    v_max3_u32 v224, v224, v231, v232
    v_max3_u32 v224, v224, v233, v234
    v_max3_u32 v224, v224, v235, v236
    v_max3_u32 v224, v224, v237, v238
    v_max_u32 v224, v224, v239
    v_cmp_eq_u32 vcc, -1, v224
    s_nop 3
    s_cmp_lg_u64 vcc, 0
    s_cbranch_scc1 L_gr9
L_go9:
    s_waitcnt vmcnt(5)
    s_barrier
    s_mov_b32 s35, 1146880
    s_mul_i32 s34, s3, 5120
    s_add_u32 m0, s34, 143360
    s_nop 0
    buffer_load_dwordx4 v12, s[20:23], s35 offen offset:0 lds
    buffer_load_dwordx4 v13, s[20:23], s35 offen offset:1024 lds
    buffer_load_dwordx4 v14, s[20:23], s35 offen offset:2048 lds
    buffer_load_dwordx4 v15, s[20:23], s35 offen offset:3072 lds
    s_add_u32 m0, s34, 147456
    s_nop 0
    buffer_load_dwordx4 v16, s[20:23], s35 offen lds
    s_mov_b32 s20, s52
    s_mov_b32 s21, s53
    s_mov_b32 s22, 1966080
    s_mov_b32 s23, 0x00020000
    s_add_u32 s37, s37, 8192
    s_barrier
    ds_write_b128 v17, v[20:23] offset:0
    ds_write_b128 v17, v[24:27] offset:1024
    ds_write_b128 v17, v[28:31] offset:2048
    ds_write_b128 v17, v[32:35] offset:3072
    ds_write_b128 v17, v[36:39] offset:4096
    s_waitcnt lgkmcnt(0)
    s_barrier
    ds_write_b128 v17, v[40:43] offset:20480
    ds_write_b128 v17, v[44:47] offset:21504
    ds_write_b128 v17, v[48:51] offset:22528
    ds_write_b128 v17, v[52:55] offset:23552
    ds_write_b128 v17, v[56:59] offset:24576
    ds_write_b128 v17, v[60:63] offset:40960
    ds_write_b128 v17, v[64:67] offset:41984
    ds_write_b128 v17, v[68:71] offset:43008
    ds_write_b128 v17, v[72:75] offset:44032
    ds_write_b128 v17, v[76:79] offset:45056
    ds_write_b128 v18, v[80:83] offset:0
    ds_write_b128 v18, v[84:87] offset:1024
    ds_write_b128 v18, v[88:91] offset:2048
    ds_write_b128 v18, v[92:95] offset:3072
    ds_write_b128 v18, v[96:99] offset:4096
    ds_write_b128 v18, v[100:103] offset:20480
    ds_write_b128 v18, v[104:107] offset:21504
    ds_write_b128 v18, v[108:111] offset:22528
    ds_write_b128 v18, v[112:115] offset:23552
    ds_write_b128 v18, v[116:119] offset:24576
    ds_write_b128 v18, v[120:123] offset:40960
    ds_write_b128 v18, v[124:127] offset:41984
    ds_write_b128 v18, v[128:131] offset:43008
    ds_write_b128 v18, v[132:135] offset:44032
    ds_write_b128 v18, v[136:139] offset:45056
    s_waitcnt lgkmcnt(0)
    s_waitcnt vmcnt(0)
    s_cmp_lg_u32 s3, 0
    s_cbranch_scc1 L_np7
    v_and_b32 v250, 31, v0
    v_lshlrev_b32 v250, 2, v250
    s_mov_b32 s46, 0
L_poll8:
    s_sleep 4
    buffer_load_dword v251, v250, s[92:95], s37 offen sc1
    s_waitcnt vmcnt(0)
    v_cmp_eq_u32 vcc, 0, v251
    s_add_u32 s46, s46, 1
    s_nop 2
    s_cmp_eq_u64 vcc, 0
    s_cbranch_scc1 L_poll8_x
    s_cmp_lt_u32 s46, 0x40000
    s_cbranch_scc1 L_poll8
L_poll8_x:
L_np7:
    s_barrier
    s_barrier
    ds_write_b128 v17, v[140:143] offset:0
    ds_write_b128 v17, v[144:147] offset:1024
    ds_write_b128 v17, v[148:151] offset:2048
    ds_write_b128 v17, v[152:155] offset:3072
    ds_write_b128 v17, v[156:159] offset:4096
    ds_write_b128 v17, v[160:163] offset:20480
    ds_write_b128 v17, v[164:167] offset:21504
    ds_write_b128 v17, v[168:171] offset:22528
    ds_write_b128 v17, v[172:175] offset:23552
    ds_write_b128 v17, v[176:179] offset:24576
    ds_write_b128 v17, v[180:183] offset:40960
    ds_write_b128 v17, v[184:187] offset:41984
    ds_write_b128 v17, v[188:191] offset:43008
    ds_write_b128 v17, v[192:195] offset:44032
    ds_write_b128 v17, v[196:199] offset:45056
    ds_write_b128 v18, v[200:203] offset:0
    ds_write_b128 v18, v[204:207] offset:1024
    ds_write_b128 v18, v[208:211] offset:2048
    ds_write_b128 v18, v[212:215] offset:3072
    ds_write_b128 v18, v[216:219] offset:4096
    s_waitcnt lgkmcnt(0)
    s_barrier
    s_endpgm
L_compute:
    s_getpc_b64 s[16:17]
L_pc0:
    s_sub_u32 s16, s16, L_pc0-sequential_preLN__softmax_full_mha__glu_gated_glu__prompt_kernel
    s_subb_u32 s17, s17, 0
    s_lshl_b32 s32, s11, 2
    s_add_u32 s32, s32, s3
    s_lshl_b32 s32, s32, 9
    v_lshlrev_b32 v1, 7, v0
    v_add_u32 v1, s32, v1
    v_mov_b32 v3, s17
    v_add_co_u32 v2, vcc, s16, v1
    s_nop 1
    v_addc_co_u32 v3, vcc, 0, v3, vcc
    v_cmp_gt_u32 vcc, L_end-sequential_preLN__softmax_full_mha__glu_gated_glu__prompt_kernel, v1
    s_nop 3
    s_mov_b64 exec, 15
    s_and_b64 exec, exec, vcc
    s_cbranch_execz L_nowc
    global_load_dword v252, v[2:3], off
L_nowc:
    s_mov_b64 exec, -1
    s_cmp_lg_u32 s3, 0
    s_cbranch_scc1 L_nowt
    s_waitcnt lgkmcnt(0)
    v_lshlrev_b32 v1, 21, v0
    s_mov_b64 exec, 0xfff
    s_mov_b32 s16, s8
    s_mov_b32 s17, s9
    s_mov_b32 s18, 24150016
    s_mov_b32 s19, 0x00020000
    buffer_load_dword v252, v1, s[16:19], 0 offen sc1
    s_mov_b32 s16, s48
    s_mov_b32 s17, s49
    s_mov_b32 s18, 1966080
    s_mov_b32 s19, 0x00020000
    buffer_load_dword v252, v1, s[16:19], 0 offen sc1
    s_mov_b32 s16, s50
    s_mov_b32 s17, s51
    s_mov_b32 s18, 1966080
    s_mov_b32 s19, 0x00020000
    buffer_load_dword v252, v1, s[16:19], 0 offen sc1
    s_mov_b32 s16, s52
    s_mov_b32 s17, s53
    s_mov_b32 s18, 1966080
    s_mov_b32 s19, 0x00020000
    buffer_load_dword v252, v1, s[16:19], 0 offen sc1
    s_mov_b32 s16, s54
    s_mov_b32 s17, s55
    s_mov_b32 s18, 2621440
    s_mov_b32 s19, 0x00020000
    buffer_load_dword v252, v1, s[16:19], 0 offen sc1
    s_mov_b64 exec, -1
L_nowt:
    s_lshr_b32 s12, s10, 1
    s_lshl_b32 s12, s12, 2
    s_and_b32 s13, s11, 3
    s_add_u32 s12, s12, s13
    s_and_b32 s13, s10, 1
    s_lshl_b32 s13, s13, 3
    s_lshr_b32 s14, s11, 2
    s_add_u32 s13, s13, s14
    s_mul_i32 s36, s12, 3
    s_add_u32 s36, s36, s13
    s_mul_i32 s37, s36, 6554
    s_lshr_b32 s37, s37, 16
    s_mul_i32 s37, s37, 10
    s_sub_u32 s36, s36, s37
    s_cmp_eq_u32 s13, 15
    s_cbranch_scc1 L_qdone
    s_lshr_b32 s15, s3, 1
    s_and_b32 s14, s3, 1
    v_and_b32 v1, 15, v0
    v_lshlrev_b32 v1, 7, v1
    v_lshrrev_b32 v2, 4, v0
    v_bfe_u32 v3, v0, 1, 3
    v_xor_b32 v2, v2, v3
    s_lshl_b32 s32, s3, 12
    v_add_u32 v1, s32, v1
    v_lshl_add_u32 v136, v2, 4, v1
    v_xor_b32 v137, 64, v136
    v_xor_b32 v138, 4096, v136
    v_xor_b32 v139, 4096, v137
    v_lshrrev_b32 v1, 4, v0
    v_bfe_u32 v2, v0, 2, 2
    v_lshl_add_u32 v3, v1, 3, v2
    v_lshlrev_b32 v3, 8, v3
    v_and_b32 v4, 3, v0
    v_lshl_add_u32 v3, v4, 3, v3
    v_add_u32 v3, 65536, v3
    v_and_b32 v1, 1, v1
    v_lshl_or_b32 v2, v2, 1, v1
    s_lshl_b32 s32, s14, 2
    s_lshl_b32 s33, s15, 1
    s_add_u32 s32, s32, s33
    v_xor_b32 v2, s32, v2
    v_lshl_add_u32 v140, v2, 5, v3
    v_xor_b32 v141, 32, v140
    v_xor_b32 v142, 64, v140
    v_xor_b32 v143, 96, v140
    s_mul_i32 s38, s12, 10
    s_add_u32 s38, s38, s36
    s_lshl_b32 s38, s38, 10
    s_lshl_b32 s32, s3, 8
    s_add_u32 s38, s38, s32
    s_mul_i32 s39, s13, 10
    s_add_u32 s39, s39, s36
    s_lshl_b32 s39, s39, 9
    s_lshl_b32 s32, s14, 8
    s_lshl_b32 s33, s15, 7
    s_add_u32 s39, s39, s32
    s_add_u32 s39, s39, s33
    s_add_u32 s39, s39, 163840
    s_waitcnt lgkmcnt(0)
    s_mov_b32 s28, s8
    s_mov_b32 s29, s9
    s_mov_b32 s30, 7864320
    s_mov_b32 s31, 0x00020000
    s_add_u32 s24, s8, 19972096
    s_addc_u32 s25, s9, 0
    s_mov_b32 s26, 245760
    s_mov_b32 s27, 0x00020000
    v_mov_b32 v144, 0
    v_mov_b32 v145, 0
    v_mov_b32 v146, 0
    v_mov_b32 v147, 0
    v_mov_b32 v148, 0
    v_mov_b32 v149, 0
    v_mov_b32 v150, 0x3f803f80
    s_lshl_b32 s44, s12, 2
    s_add_u32 s44, s44, s3
    s_xor_b32 s45, s44, 1
    s_cmp_ge_u32 s13, 10
    s_cbranch_scc1 L_vtype
    s_mul_i32 s44, s44, 1280
    s_mul_i32 s45, s45, 1280
    s_cmp_ge_u32 s13, 5
    s_cselect_b32 s40, 5, 0
    s_cselect_b32 s41, 2621440, 0
    s_cselect_b32 s42, 1.0, 0x3ea52b5c
    s_sub_u32 s40, s13, s40
    s_add_u32 s44, s44, s41
    s_add_u32 s45, s45, s41
    s_lshl_b32 s32, s40, 5
    s_lshl_b32 s33, s14, 4
    s_add_u32 s32, s32, s33
    s_lshl_b32 s33, s15, 3
    s_add_u32 s32, s32, s33
    v_lshrrev_b32 v1, 4, v0
    v_add_u32 v1, s32, v1
    v_and_b32 v2, 15, v0
    v_xor_b32 v3, 0, v1
    v_mul_u32_u24 v4, 205, v3
    v_lshrrev_b32 v4, 10, v4
    v_mul_u32_u24 v5, 5, v4
    v_sub_u32 v5, v3, v5
    v_and_b32 v6, 1, v4
    v_sub_u32 v5, v5, v6
    v_min_u32 v5, 4, v5
    v_mul_u32_u24 v4, 81920, v4
    v_lshrrev_b32 v6, 1, v5
    v_lshlrev_b32 v6, 9, v6
    v_and_b32 v7, 1, v5
    v_lshl_add_u32 v6, v7, 3, v6
    v_add_u32 v4, v4, v6
    v_cmp_eq_u32 vcc, 4, v5
    v_mov_b32 v6, 16
    s_nop 0
    v_cndmask_b32 v6, v6, 8, vcc
    v_mad_u32_u24 v160, v6, v2, v4
    v_lshl_add_u32 v161, v6, 4, v160
    v_xor_b32 v3, 4, v1
    v_mul_u32_u24 v4, 205, v3
    v_lshrrev_b32 v4, 10, v4
    v_mul_u32_u24 v5, 5, v4
    v_sub_u32 v5, v3, v5
    v_and_b32 v6, 1, v4
    v_sub_u32 v5, v5, v6
    v_min_u32 v5, 4, v5
    v_mul_u32_u24 v4, 81920, v4
    v_lshrrev_b32 v6, 1, v5
    v_lshlrev_b32 v6, 9, v6
    v_and_b32 v7, 1, v5
    v_lshl_add_u32 v6, v7, 3, v6
    v_add_u32 v4, v4, v6
    v_cmp_eq_u32 vcc, 4, v5
    v_mov_b32 v6, 16
    s_nop 0
    v_cndmask_b32 v6, v6, 8, vcc
    v_mad_u32_u24 v162, v6, v2, v4
    v_lshl_add_u32 v163, v6, 4, v162
    v_xor_b32 v3, 8, v1
    v_mul_u32_u24 v4, 205, v3
    v_lshrrev_b32 v4, 10, v4
    v_mul_u32_u24 v5, 5, v4
    v_sub_u32 v5, v3, v5
    v_and_b32 v6, 1, v4
    v_sub_u32 v5, v5, v6
    v_min_u32 v5, 4, v5
    v_mul_u32_u24 v4, 81920, v4
    v_lshrrev_b32 v6, 1, v5
    v_lshlrev_b32 v6, 9, v6
    v_and_b32 v7, 1, v5
    v_lshl_add_u32 v6, v7, 3, v6
    v_add_u32 v4, v4, v6
    v_cmp_eq_u32 vcc, 4, v5
    v_mov_b32 v6, 16
    s_nop 0
    v_cndmask_b32 v6, v6, 8, vcc
    v_mad_u32_u24 v164, v6, v2, v4
    v_lshl_add_u32 v165, v6, 4, v164
    v_xor_b32 v3, 12, v1
    v_mul_u32_u24 v4, 205, v3
    v_lshrrev_b32 v4, 10, v4
    v_mul_u32_u24 v5, 5, v4
    v_sub_u32 v5, v3, v5
    v_and_b32 v6, 1, v4
    v_sub_u32 v5, v5, v6
    v_min_u32 v5, 4, v5
    v_mul_u32_u24 v4, 81920, v4
    v_lshrrev_b32 v6, 1, v5
    v_lshlrev_b32 v6, 9, v6
    v_and_b32 v7, 1, v5
    v_lshl_add_u32 v6, v7, 3, v6
    v_add_u32 v4, v4, v6
    v_cmp_eq_u32 vcc, 4, v5
    v_mov_b32 v6, 16
    s_nop 0
    v_cndmask_b32 v6, v6, 8, vcc
    v_mad_u32_u24 v166, v6, v2, v4
    v_lshl_add_u32 v167, v6, 4, v166
    v_and_b32 v1, 15, v0
    v_lshlrev_b32 v1, 2, v1
    v_and_b32 v2, 48, v0
    s_lshl_b32 s32, s3, 7
    s_add_u32 s32, s32, 131072
    v_add_u32 v168, s32, v1
    v_xor_b32 v169, 128, v168
    s_lshl_b32 s32, s14, 8
    s_lshl_b32 s33, s15, 7
    s_add_u32 s32, s32, s33
    s_add_u32 s32, s32, 132096
    v_add_u32 v170, s32, v2
    v_xor_b32 v171, 128, v170
    s_mov_b32 s36, 1
    s_mov_b32 s37, 2
    s_mov_b32 s41, 16384
    s_mov_b32 s40, 16384
    s_barrier
    ds_read_b128 v[72:75], v136 offset:0
    ds_read_b64_tr_b16 v[104:105], v140 offset:0
    ds_read_b64_tr_b16 v[106:107], v140 offset:1024
    ds_read_b64_tr_b16 v[108:109], v141 offset:0
    ds_read_b64_tr_b16 v[110:111], v141 offset:1024
    ds_read_b64_tr_b16 v[112:113], v142 offset:0
    ds_read_b64_tr_b16 v[114:115], v142 offset:1024
    ds_read_b64_tr_b16 v[116:117], v143 offset:0
    ds_read_b64_tr_b16 v[118:119], v143 offset:1024
    ds_read_b128 v[76:79], v136 offset:2048
    ds_read_b128 v[80:83], v138 offset:0
    ds_read_b128 v[84:87], v138 offset:2048
    s_waitcnt lgkmcnt(0)
    v_mfma_f32_16x16x32_bf16 v[8:11], v[104:107], v[72:75], 0
    ds_read_b128 v[88:91], v137 offset:0
    v_mfma_f32_16x16x32_bf16 v[12:15], v[108:111], v[72:75], 0
    ds_read_b64_tr_b16 v[120:121], v140 offset:8192
    v_mfma_f32_16x16x32_bf16 v[16:19], v[112:115], v[72:75], 0
    ds_read_b64_tr_b16 v[122:123], v140 offset:9216
    v_mfma_f32_16x16x32_bf16 v[20:23], v[116:119], v[72:75], 0
    ds_read_b64_tr_b16 v[124:125], v141 offset:8192
    v_mfma_f32_16x16x32_bf16 v[24:27], v[104:107], v[76:79], 0
    ds_read_b64_tr_b16 v[126:127], v141 offset:9216
    v_mfma_f32_16x16x32_bf16 v[28:31], v[108:111], v[76:79], 0
    ds_read_b64_tr_b16 v[128:129], v142 offset:8192
    v_mfma_f32_16x16x32_bf16 v[32:35], v[112:115], v[76:79], 0
    ds_read_b64_tr_b16 v[130:131], v142 offset:9216
    v_mfma_f32_16x16x32_bf16 v[36:39], v[116:119], v[76:79], 0
    ds_read_b64_tr_b16 v[132:133], v143 offset:8192
    v_mfma_f32_16x16x32_bf16 v[40:43], v[104:107], v[80:83], 0
    ds_read_b64_tr_b16 v[134:135], v143 offset:9216
    v_mfma_f32_16x16x32_bf16 v[44:47], v[108:111], v[80:83], 0
    ds_read_b128 v[92:95], v137 offset:2048
    v_mfma_f32_16x16x32_bf16 v[48:51], v[112:115], v[80:83], 0
    ds_read_b128 v[96:99], v139 offset:0
    v_mfma_f32_16x16x32_bf16 v[52:55], v[116:119], v[80:83], 0
    ds_read_b128 v[100:103], v139 offset:2048
    v_mfma_f32_16x16x32_bf16 v[56:59], v[104:107], v[84:87], 0
    v_mfma_f32_16x16x32_bf16 v[60:63], v[108:111], v[84:87], 0
    v_mfma_f32_16x16x32_bf16 v[64:67], v[112:115], v[84:87], 0
    v_mfma_f32_16x16x32_bf16 v[68:71], v[116:119], v[84:87], 0
    v_dot2c_f32_bf16 v144, v72, v150
    v_dot2c_f32_bf16 v145, v72, v72
    v_dot2c_f32_bf16 v148, v104, v150
    v_dot2c_f32_bf16 v144, v73, v150
    v_dot2c_f32_bf16 v145, v73, v73
    v_dot2c_f32_bf16 v148, v105, v150
    v_dot2c_f32_bf16 v144, v74, v150
    v_dot2c_f32_bf16 v145, v74, v74
    v_dot2c_f32_bf16 v148, v106, v150
    v_dot2c_f32_bf16 v144, v75, v150
    v_dot2c_f32_bf16 v145, v75, v75
    v_dot2c_f32_bf16 v148, v107, v150
    v_dot2c_f32_bf16 v146, v76, v150
    v_dot2c_f32_bf16 v147, v76, v76
    v_dot2c_f32_bf16 v149, v108, v150
    v_dot2c_f32_bf16 v146, v77, v150
    v_dot2c_f32_bf16 v147, v77, v77
    v_dot2c_f32_bf16 v149, v109, v150
    v_dot2c_f32_bf16 v146, v78, v150
    v_dot2c_f32_bf16 v147, v78, v78
    v_dot2c_f32_bf16 v149, v110, v150
    v_dot2c_f32_bf16 v146, v79, v150
    v_dot2c_f32_bf16 v147, v79, v79
    v_dot2c_f32_bf16 v149, v111, v150
    s_waitcnt lgkmcnt(0)
    v_mfma_f32_16x16x32_bf16 v[8:11], v[120:123], v[88:91], v[8:11]
    v_add_u32 v136, s40, v136
    v_mfma_f32_16x16x32_bf16 v[12:15], v[124:127], v[88:91], v[12:15]
    v_add_u32 v137, s40, v137
    v_mfma_f32_16x16x32_bf16 v[16:19], v[128:131], v[88:91], v[16:19]
    v_add_u32 v138, s40, v138
    v_mfma_f32_16x16x32_bf16 v[20:23], v[132:135], v[88:91], v[20:23]
    v_add_u32 v139, s40, v139
    v_mfma_f32_16x16x32_bf16 v[24:27], v[120:123], v[92:95], v[24:27]
    v_add_u32 v140, s40, v140
    v_mfma_f32_16x16x32_bf16 v[28:31], v[124:127], v[92:95], v[28:31]
    v_add_u32 v141, s40, v141
    v_mfma_f32_16x16x32_bf16 v[32:35], v[128:131], v[92:95], v[32:35]
    v_add_u32 v142, s40, v142
    v_mfma_f32_16x16x32_bf16 v[36:39], v[132:135], v[92:95], v[36:39]
    v_add_u32 v143, s40, v143
    v_mfma_f32_16x16x32_bf16 v[40:43], v[120:123], v[96:99], v[40:43]
    v_mfma_f32_16x16x32_bf16 v[44:47], v[124:127], v[96:99], v[44:47]
    v_mfma_f32_16x16x32_bf16 v[48:51], v[128:131], v[96:99], v[48:51]
    v_mfma_f32_16x16x32_bf16 v[52:55], v[132:135], v[96:99], v[52:55]
    v_mfma_f32_16x16x32_bf16 v[56:59], v[120:123], v[100:103], v[56:59]
    v_mfma_f32_16x16x32_bf16 v[60:63], v[124:127], v[100:103], v[60:63]
    v_mfma_f32_16x16x32_bf16 v[64:67], v[128:131], v[100:103], v[64:67]
    v_mfma_f32_16x16x32_bf16 v[68:71], v[132:135], v[100:103], v[68:71]
    v_dot2c_f32_bf16 v144, v88, v150
    v_dot2c_f32_bf16 v145, v88, v88
    v_dot2c_f32_bf16 v148, v120, v150
    v_dot2c_f32_bf16 v144, v89, v150
    v_dot2c_f32_bf16 v145, v89, v89
    v_dot2c_f32_bf16 v148, v121, v150
    v_dot2c_f32_bf16 v144, v90, v150
    v_dot2c_f32_bf16 v145, v90, v90
    v_dot2c_f32_bf16 v148, v122, v150
    v_dot2c_f32_bf16 v144, v91, v150
    v_dot2c_f32_bf16 v145, v91, v91
    v_dot2c_f32_bf16 v148, v123, v150
    v_dot2c_f32_bf16 v146, v92, v150
    v_dot2c_f32_bf16 v147, v92, v92
    v_dot2c_f32_bf16 v149, v124, v150
    v_dot2c_f32_bf16 v146, v93, v150
    v_dot2c_f32_bf16 v147, v93, v93
    v_dot2c_f32_bf16 v149, v125, v150
    v_dot2c_f32_bf16 v146, v94, v150
    v_dot2c_f32_bf16 v147, v94, v94
    v_dot2c_f32_bf16 v149, v126, v150
    v_dot2c_f32_bf16 v146, v95, v150
    v_dot2c_f32_bf16 v147, v95, v95
    v_dot2c_f32_bf16 v149, v127, v150
    s_nop 2
    v_mov_b32 v152, v144
    v_mov_b32 v153, v145
    v_mov_b32 v154, v146
    v_mov_b32 v155, v147
    v_mov_b32 v156, v148
    v_mov_b32 v157, v149
    s_nop 1
    v_permlane32_swap_b32 v144, v152
    v_permlane32_swap_b32 v145, v153
    v_permlane32_swap_b32 v146, v154
    v_permlane32_swap_b32 v147, v155
    v_permlane32_swap_b32 v148, v156
    v_permlane32_swap_b32 v149, v157
    s_nop 1
    v_add_f32 v144, v144, v152
    v_add_f32 v145, v145, v153
    v_add_f32 v146, v146, v154
    v_add_f32 v147, v147, v155
    v_add_f32 v148, v148, v156
    v_add_f32 v149, v149, v157
    v_mov_b32 v152, v144
    v_mov_b32 v153, v145
    v_mov_b32 v154, v146
    v_mov_b32 v155, v147
    v_mov_b32 v156, v148
    v_mov_b32 v157, v149
    s_nop 1
    v_permlane16_swap_b32 v144, v152
    v_permlane16_swap_b32 v145, v153
    v_permlane16_swap_b32 v146, v154
    v_permlane16_swap_b32 v147, v155
    v_permlane16_swap_b32 v148, v156
    v_permlane16_swap_b32 v149, v157
    v_cmp_gt_u32 vcc, 16, v0
    s_nop 0
    v_add_f32 v144, v144, v152
    v_add_f32 v145, v145, v153
    v_add_f32 v146, v146, v154
    v_add_f32 v147, v147, v155
    v_add_f32 v148, v148, v156
    v_add_f32 v149, v149, v157
    v_cndmask_b32 v144, v146, v144, vcc
    v_cndmask_b32 v145, v147, v145, vcc
    v_cndmask_b32 v148, v149, v148, vcc
    v_lshlrev_b32 v1, 3, v0
    v_lshlrev_b32 v2, 2, v0
    s_mov_b32 exec_hi, 0
    buffer_store_dwordx2 v[144:145], v1, s[24:27], s38 offen sc1
    buffer_store_dword v148, v2, s[24:27], s39 offen sc1
    s_mov_b64 exec, -1
    s_barrier
    ds_read_b128 v[72:75], v136 offset:0
    ds_read_b64_tr_b16 v[104:105], v140 offset:0
    ds_read_b64_tr_b16 v[106:107], v140 offset:1024
    ds_read_b64_tr_b16 v[108:109], v141 offset:0
    ds_read_b64_tr_b16 v[110:111], v141 offset:1024
    ds_read_b64_tr_b16 v[112:113], v142 offset:0
    ds_read_b64_tr_b16 v[114:115], v142 offset:1024
    ds_read_b64_tr_b16 v[116:117], v143 offset:0
    ds_read_b64_tr_b16 v[118:119], v143 offset:1024
    ds_read_b128 v[76:79], v136 offset:2048
    ds_read_b128 v[80:83], v138 offset:0
    ds_read_b128 v[84:87], v138 offset:2048
    s_branch L_qinqk
    .p2align 6
L_qloopqk:
    s_waitcnt vmcnt(0) lgkmcnt(0)
    v_mfma_f32_16x16x32_bf16 v[8:11], v[120:123], v[88:91], v[8:11]
    s_barrier
    v_mfma_f32_16x16x32_bf16 v[12:15], v[124:127], v[88:91], v[12:15]
    ds_read_b128 v[72:75], v136 offset:0
    v_mfma_f32_16x16x32_bf16 v[16:19], v[128:131], v[88:91], v[16:19]
    ds_read_b64_tr_b16 v[104:105], v140 offset:0
    v_mfma_f32_16x16x32_bf16 v[20:23], v[132:135], v[88:91], v[20:23]
    ds_read_b64_tr_b16 v[106:107], v140 offset:1024
    v_mfma_f32_16x16x32_bf16 v[24:27], v[120:123], v[92:95], v[24:27]
    ds_read_b64_tr_b16 v[108:109], v141 offset:0
    v_mfma_f32_16x16x32_bf16 v[28:31], v[124:127], v[92:95], v[28:31]
    ds_read_b64_tr_b16 v[110:111], v141 offset:1024
    v_mfma_f32_16x16x32_bf16 v[32:35], v[128:131], v[92:95], v[32:35]
    ds_read_b64_tr_b16 v[112:113], v142 offset:0
    v_mfma_f32_16x16x32_bf16 v[36:39], v[132:135], v[92:95], v[36:39]
    ds_read_b64_tr_b16 v[114:115], v142 offset:1024
    v_mfma_f32_16x16x32_bf16 v[40:43], v[120:123], v[96:99], v[40:43]
    ds_read_b64_tr_b16 v[116:117], v143 offset:0
    v_mfma_f32_16x16x32_bf16 v[44:47], v[124:127], v[96:99], v[44:47]
    ds_read_b64_tr_b16 v[118:119], v143 offset:1024
    v_mfma_f32_16x16x32_bf16 v[48:51], v[128:131], v[96:99], v[48:51]
    ds_read_b128 v[76:79], v136 offset:2048
    v_mfma_f32_16x16x32_bf16 v[52:55], v[132:135], v[96:99], v[52:55]
    ds_read_b128 v[80:83], v138 offset:0
    v_mfma_f32_16x16x32_bf16 v[56:59], v[120:123], v[100:103], v[56:59]
    ds_read_b128 v[84:87], v138 offset:2048
    v_mfma_f32_16x16x32_bf16 v[60:63], v[124:127], v[100:103], v[60:63]
    s_add_u32 s37, s37, 1
    s_cmp_eq_u32 s37, 4
    v_mfma_f32_16x16x32_bf16 v[64:67], v[128:131], v[100:103], v[64:67]
    s_cselect_b32 s40, 4294918144, s41
    s_cselect_b32 s37, 0, s37
    v_mfma_f32_16x16x32_bf16 v[68:71], v[132:135], v[100:103], v[68:71]
L_qinqk:
    s_waitcnt lgkmcnt(0)
    v_mfma_f32_16x16x32_bf16 v[8:11], v[104:107], v[72:75], v[8:11]
    ds_read_b128 v[88:91], v137 offset:0
    v_mfma_f32_16x16x32_bf16 v[12:15], v[108:111], v[72:75], v[12:15]
    ds_read_b64_tr_b16 v[120:121], v140 offset:8192
    v_mfma_f32_16x16x32_bf16 v[16:19], v[112:115], v[72:75], v[16:19]
    ds_read_b64_tr_b16 v[122:123], v140 offset:9216
    v_mfma_f32_16x16x32_bf16 v[20:23], v[116:119], v[72:75], v[20:23]
    ds_read_b64_tr_b16 v[124:125], v141 offset:8192
    v_mfma_f32_16x16x32_bf16 v[24:27], v[104:107], v[76:79], v[24:27]
    ds_read_b64_tr_b16 v[126:127], v141 offset:9216
    v_mfma_f32_16x16x32_bf16 v[28:31], v[108:111], v[76:79], v[28:31]
    ds_read_b64_tr_b16 v[128:129], v142 offset:8192
    v_mfma_f32_16x16x32_bf16 v[32:35], v[112:115], v[76:79], v[32:35]
    ds_read_b64_tr_b16 v[130:131], v142 offset:9216
    v_mfma_f32_16x16x32_bf16 v[36:39], v[116:119], v[76:79], v[36:39]
    ds_read_b64_tr_b16 v[132:133], v143 offset:8192
    v_mfma_f32_16x16x32_bf16 v[40:43], v[104:107], v[80:83], v[40:43]
    ds_read_b64_tr_b16 v[134:135], v143 offset:9216
    v_mfma_f32_16x16x32_bf16 v[44:47], v[108:111], v[80:83], v[44:47]
    ds_read_b128 v[92:95], v137 offset:2048
    v_mfma_f32_16x16x32_bf16 v[48:51], v[112:115], v[80:83], v[48:51]
    ds_read_b128 v[96:99], v139 offset:0
    v_mfma_f32_16x16x32_bf16 v[52:55], v[116:119], v[80:83], v[52:55]
    ds_read_b128 v[100:103], v139 offset:2048
    v_mfma_f32_16x16x32_bf16 v[56:59], v[104:107], v[84:87], v[56:59]
    v_add_u32 v136, s40, v136
    v_add_u32 v137, s40, v137
    v_mfma_f32_16x16x32_bf16 v[60:63], v[108:111], v[84:87], v[60:63]
    v_add_u32 v138, s40, v138
    v_add_u32 v139, s40, v139
    v_mfma_f32_16x16x32_bf16 v[64:67], v[112:115], v[84:87], v[64:67]
    v_add_u32 v140, s40, v140
    v_add_u32 v141, s40, v141
    v_mfma_f32_16x16x32_bf16 v[68:71], v[116:119], v[84:87], v[68:71]
    v_add_u32 v142, s40, v142
    v_add_u32 v143, s40, v143
    s_add_u32 s36, s36, 1
    s_cmp_lt_u32 s36, 10
    s_cbranch_scc1 L_qloopqk
    s_waitcnt lgkmcnt(0)
    v_mfma_f32_16x16x32_bf16 v[8:11], v[120:123], v[88:91], v[8:11]
    ds_read_b32 v72, v168 offset:0
    v_mfma_f32_16x16x32_bf16 v[12:15], v[124:127], v[88:91], v[12:15]
    ds_read_b32 v73, v168 offset:64
    v_mfma_f32_16x16x32_bf16 v[16:19], v[128:131], v[88:91], v[16:19]
    ds_read_b32 v74, v169 offset:0
    v_mfma_f32_16x16x32_bf16 v[20:23], v[132:135], v[88:91], v[20:23]
    ds_read_b32 v75, v169 offset:64
    v_mfma_f32_16x16x32_bf16 v[24:27], v[120:123], v[92:95], v[24:27]
    ds_read_b32 v76, v168 offset:512
    v_mfma_f32_16x16x32_bf16 v[28:31], v[124:127], v[92:95], v[28:31]
    ds_read_b32 v77, v168 offset:576
    v_mfma_f32_16x16x32_bf16 v[32:35], v[128:131], v[92:95], v[32:35]
    ds_read_b32 v78, v169 offset:512
    v_mfma_f32_16x16x32_bf16 v[36:39], v[132:135], v[92:95], v[36:39]
    ds_read_b32 v79, v169 offset:576
    v_mfma_f32_16x16x32_bf16 v[40:43], v[120:123], v[96:99], v[40:43]
    ds_read_b128 v[104:107], v170 offset:0
    v_mfma_f32_16x16x32_bf16 v[44:47], v[124:127], v[96:99], v[44:47]
    ds_read_b128 v[108:111], v170 offset:64
    v_mfma_f32_16x16x32_bf16 v[48:51], v[128:131], v[96:99], v[48:51]
    ds_read_b128 v[112:115], v171 offset:0
    v_mfma_f32_16x16x32_bf16 v[52:55], v[132:135], v[96:99], v[52:55]
    ds_read_b128 v[116:119], v171 offset:64
    v_mfma_f32_16x16x32_bf16 v[56:59], v[120:123], v[100:103], v[56:59]
    v_mfma_f32_16x16x32_bf16 v[60:63], v[124:127], v[100:103], v[60:63]
    v_mfma_f32_16x16x32_bf16 v[64:67], v[128:131], v[100:103], v[64:67]
    v_mfma_f32_16x16x32_bf16 v[68:71], v[132:135], v[100:103], v[68:71]
    s_waitcnt lgkmcnt(0)
    v_sub_f32 v152, 0, v72
    v_mul_f32 v154, s42, v76
    v_mov_b32 v153, v152
    v_mov_b32 v155, v154
    v_pk_fma_f32 v[8:9], v[104:105], v[152:153], v[8:9]
    v_pk_fma_f32 v[10:11], v[106:107], v[152:153], v[10:11]
    v_pk_fma_f32 v[12:13], v[108:109], v[152:153], v[12:13]
    v_pk_fma_f32 v[14:15], v[110:111], v[152:153], v[14:15]
    v_pk_fma_f32 v[16:17], v[112:113], v[152:153], v[16:17]
    v_pk_fma_f32 v[18:19], v[114:115], v[152:153], v[18:19]
    v_pk_fma_f32 v[20:21], v[116:117], v[152:153], v[20:21]
    v_pk_fma_f32 v[22:23], v[118:119], v[152:153], v[22:23]
    v_pk_mul_f32 v[8:9], v[8:9], v[154:155]
    v_pk_mul_f32 v[10:11], v[10:11], v[154:155]
    v_pk_mul_f32 v[12:13], v[12:13], v[154:155]
    v_pk_mul_f32 v[14:15], v[14:15], v[154:155]
    v_pk_mul_f32 v[16:17], v[16:17], v[154:155]
    v_pk_mul_f32 v[18:19], v[18:19], v[154:155]
    v_pk_mul_f32 v[20:21], v[20:21], v[154:155]
    v_pk_mul_f32 v[22:23], v[22:23], v[154:155]
    v_cvt_pk_bf16_f32 v8, v8, v9
    v_cvt_pk_bf16_f32 v9, v10, v11
    v_cvt_pk_bf16_f32 v10, v12, v13
    v_cvt_pk_bf16_f32 v11, v14, v15
    v_cvt_pk_bf16_f32 v12, v16, v17
    v_cvt_pk_bf16_f32 v13, v18, v19
    v_cvt_pk_bf16_f32 v14, v20, v21
    v_cvt_pk_bf16_f32 v15, v22, v23
    buffer_store_dwordx2 v[8:9], v160, s[28:31], s44 offen sc1
    buffer_store_dwordx2 v[10:11], v162, s[28:31], s44 offen sc1
    buffer_store_dwordx2 v[12:13], v164, s[28:31], s44 offen sc1
    buffer_store_dwordx2 v[14:15], v166, s[28:31], s44 offen sc1
    v_sub_f32 v152, 0, v73
    v_mul_f32 v154, s42, v77
    v_mov_b32 v153, v152
    v_mov_b32 v155, v154
    v_pk_fma_f32 v[24:25], v[104:105], v[152:153], v[24:25]
    v_pk_fma_f32 v[26:27], v[106:107], v[152:153], v[26:27]
    v_pk_fma_f32 v[28:29], v[108:109], v[152:153], v[28:29]
    v_pk_fma_f32 v[30:31], v[110:111], v[152:153], v[30:31]
    v_pk_fma_f32 v[32:33], v[112:113], v[152:153], v[32:33]
    v_pk_fma_f32 v[34:35], v[114:115], v[152:153], v[34:35]
    v_pk_fma_f32 v[36:37], v[116:117], v[152:153], v[36:37]
    v_pk_fma_f32 v[38:39], v[118:119], v[152:153], v[38:39]
    v_pk_mul_f32 v[24:25], v[24:25], v[154:155]
    v_pk_mul_f32 v[26:27], v[26:27], v[154:155]
    v_pk_mul_f32 v[28:29], v[28:29], v[154:155]
    v_pk_mul_f32 v[30:31], v[30:31], v[154:155]
    v_pk_mul_f32 v[32:33], v[32:33], v[154:155]
    v_pk_mul_f32 v[34:35], v[34:35], v[154:155]
    v_pk_mul_f32 v[36:37], v[36:37], v[154:155]
    v_pk_mul_f32 v[38:39], v[38:39], v[154:155]
    v_cvt_pk_bf16_f32 v24, v24, v25
    v_cvt_pk_bf16_f32 v25, v26, v27
    v_cvt_pk_bf16_f32 v26, v28, v29
    v_cvt_pk_bf16_f32 v27, v30, v31
    v_cvt_pk_bf16_f32 v28, v32, v33
    v_cvt_pk_bf16_f32 v29, v34, v35
    v_cvt_pk_bf16_f32 v30, v36, v37
    v_cvt_pk_bf16_f32 v31, v38, v39
    buffer_store_dwordx2 v[24:25], v161, s[28:31], s44 offen sc1
    buffer_store_dwordx2 v[26:27], v163, s[28:31], s44 offen sc1
    buffer_store_dwordx2 v[28:29], v165, s[28:31], s44 offen sc1
    buffer_store_dwordx2 v[30:31], v167, s[28:31], s44 offen sc1
    v_sub_f32 v152, 0, v74
    v_mul_f32 v154, s42, v78
    v_mov_b32 v153, v152
    v_mov_b32 v155, v154
    v_pk_fma_f32 v[40:41], v[104:105], v[152:153], v[40:41]
    v_pk_fma_f32 v[42:43], v[106:107], v[152:153], v[42:43]
    v_pk_fma_f32 v[44:45], v[108:109], v[152:153], v[44:45]
    v_pk_fma_f32 v[46:47], v[110:111], v[152:153], v[46:47]
    v_pk_fma_f32 v[48:49], v[112:113], v[152:153], v[48:49]
    v_pk_fma_f32 v[50:51], v[114:115], v[152:153], v[50:51]
    v_pk_fma_f32 v[52:53], v[116:117], v[152:153], v[52:53]
    v_pk_fma_f32 v[54:55], v[118:119], v[152:153], v[54:55]
    v_pk_mul_f32 v[40:41], v[40:41], v[154:155]
    v_pk_mul_f32 v[42:43], v[42:43], v[154:155]
    v_pk_mul_f32 v[44:45], v[44:45], v[154:155]
    v_pk_mul_f32 v[46:47], v[46:47], v[154:155]
    v_pk_mul_f32 v[48:49], v[48:49], v[154:155]
    v_pk_mul_f32 v[50:51], v[50:51], v[154:155]
    v_pk_mul_f32 v[52:53], v[52:53], v[154:155]
    v_pk_mul_f32 v[54:55], v[54:55], v[154:155]
    v_cvt_pk_bf16_f32 v40, v40, v41
    v_cvt_pk_bf16_f32 v41, v42, v43
    v_cvt_pk_bf16_f32 v42, v44, v45
    v_cvt_pk_bf16_f32 v43, v46, v47
    v_cvt_pk_bf16_f32 v44, v48, v49
    v_cvt_pk_bf16_f32 v45, v50, v51
    v_cvt_pk_bf16_f32 v46, v52, v53
    v_cvt_pk_bf16_f32 v47, v54, v55
    buffer_store_dwordx2 v[40:41], v160, s[28:31], s45 offen sc1
    buffer_store_dwordx2 v[42:43], v162, s[28:31], s45 offen sc1
    buffer_store_dwordx2 v[44:45], v164, s[28:31], s45 offen sc1
    buffer_store_dwordx2 v[46:47], v166, s[28:31], s45 offen sc1
    v_sub_f32 v152, 0, v75
    v_mul_f32 v154, s42, v79
    v_mov_b32 v153, v152
    v_mov_b32 v155, v154
    v_pk_fma_f32 v[56:57], v[104:105], v[152:153], v[56:57]
    v_pk_fma_f32 v[58:59], v[106:107], v[152:153], v[58:59]
    v_pk_fma_f32 v[60:61], v[108:109], v[152:153], v[60:61]
    v_pk_fma_f32 v[62:63], v[110:111], v[152:153], v[62:63]
    v_pk_fma_f32 v[64:65], v[112:113], v[152:153], v[64:65]
    v_pk_fma_f32 v[66:67], v[114:115], v[152:153], v[66:67]
    v_pk_fma_f32 v[68:69], v[116:117], v[152:153], v[68:69]
    v_pk_fma_f32 v[70:71], v[118:119], v[152:153], v[70:71]
    v_pk_mul_f32 v[56:57], v[56:57], v[154:155]
    v_pk_mul_f32 v[58:59], v[58:59], v[154:155]
    v_pk_mul_f32 v[60:61], v[60:61], v[154:155]
    v_pk_mul_f32 v[62:63], v[62:63], v[154:155]
    v_pk_mul_f32 v[64:65], v[64:65], v[154:155]
    v_pk_mul_f32 v[66:67], v[66:67], v[154:155]
    v_pk_mul_f32 v[68:69], v[68:69], v[154:155]
    v_pk_mul_f32 v[70:71], v[70:71], v[154:155]
    v_cvt_pk_bf16_f32 v56, v56, v57
    v_cvt_pk_bf16_f32 v57, v58, v59
    v_cvt_pk_bf16_f32 v58, v60, v61
    v_cvt_pk_bf16_f32 v59, v62, v63
    v_cvt_pk_bf16_f32 v60, v64, v65
    v_cvt_pk_bf16_f32 v61, v66, v67
    v_cvt_pk_bf16_f32 v62, v68, v69
    v_cvt_pk_bf16_f32 v63, v70, v71
    buffer_store_dwordx2 v[56:57], v161, s[28:31], s45 offen sc1
    buffer_store_dwordx2 v[58:59], v163, s[28:31], s45 offen sc1
    buffer_store_dwordx2 v[60:61], v165, s[28:31], s45 offen sc1
    buffer_store_dwordx2 v[62:63], v167, s[28:31], s45 offen sc1
    s_branch L_qdone
L_vtype:
    s_mul_i32 s44, s44, 40960
    s_mul_i32 s45, s45, 40960
    s_add_u32 s44, s44, 5242880
    s_add_u32 s45, s45, 5242880
    s_sub_u32 s40, s13, 10
    s_lshl_b32 s32, s40, 7
    s_lshl_b32 s33, s14, 6
    s_add_u32 s32, s32, s33
    s_lshl_b32 s33, s15, 5
    s_add_u32 s32, s32, s33
    v_and_b32 v1, 15, v0
    v_add_u32 v1, s32, v1
    v_lshrrev_b32 v2, 5, v0
    v_lshl_add_u32 v1, v2, 4, v1
    v_and_b32 v2, 16, v0
    v_lshl_add_u32 v160, v1, 5, v2
    v_xor_b32 v161, 1024, v160
    v_add_u32 v162, 20480, v160
    v_add_u32 v163, 20480, v161
    v_and_b32 v1, 15, v0
    v_lshlrev_b32 v1, 2, v1
    v_and_b32 v2, 48, v0
    s_lshl_b32 s32, s3, 7
    s_add_u32 s32, s32, 131072
    v_add_u32 v168, s32, v2
    v_xor_b32 v169, 128, v168
    s_lshl_b32 s32, s14, 8
    s_lshl_b32 s33, s15, 7
    s_add_u32 s32, s32, s33
    s_add_u32 s32, s32, 132096
    v_add_u32 v170, s32, v1
    v_xor_b32 v171, 128, v170
    s_mov_b32 s36, 1
    s_mov_b32 s37, 2
    s_mov_b32 s41, 16384
    s_mov_b32 s40, 16384
    s_barrier
    ds_read_b128 v[72:75], v136 offset:0
    ds_read_b64_tr_b16 v[104:105], v140 offset:0
    ds_read_b64_tr_b16 v[106:107], v140 offset:1024
    ds_read_b64_tr_b16 v[108:109], v141 offset:0
    ds_read_b64_tr_b16 v[110:111], v141 offset:1024
    ds_read_b64_tr_b16 v[112:113], v142 offset:0
    ds_read_b64_tr_b16 v[114:115], v142 offset:1024
    ds_read_b64_tr_b16 v[116:117], v143 offset:0
    ds_read_b64_tr_b16 v[118:119], v143 offset:1024
    ds_read_b128 v[76:79], v136 offset:2048
    ds_read_b128 v[80:83], v138 offset:0
    ds_read_b128 v[84:87], v138 offset:2048
    s_waitcnt lgkmcnt(0)
    v_mfma_f32_16x16x32_bf16 v[8:11], v[72:75], v[104:107], 0
    ds_read_b128 v[88:91], v137 offset:0
    v_mfma_f32_16x16x32_bf16 v[12:15], v[72:75], v[108:111], 0
    ds_read_b64_tr_b16 v[120:121], v140 offset:8192
    v_mfma_f32_16x16x32_bf16 v[16:19], v[72:75], v[112:115], 0
    ds_read_b64_tr_b16 v[122:123], v140 offset:9216
    v_mfma_f32_16x16x32_bf16 v[20:23], v[72:75], v[116:119], 0
    ds_read_b64_tr_b16 v[124:125], v141 offset:8192
    v_mfma_f32_16x16x32_bf16 v[24:27], v[76:79], v[104:107], 0
    ds_read_b64_tr_b16 v[126:127], v141 offset:9216
    v_mfma_f32_16x16x32_bf16 v[28:31], v[76:79], v[108:111], 0
    ds_read_b64_tr_b16 v[128:129], v142 offset:8192
    v_mfma_f32_16x16x32_bf16 v[32:35], v[76:79], v[112:115], 0
    ds_read_b64_tr_b16 v[130:131], v142 offset:9216
    v_mfma_f32_16x16x32_bf16 v[36:39], v[76:79], v[116:119], 0
    ds_read_b64_tr_b16 v[132:133], v143 offset:8192
    v_mfma_f32_16x16x32_bf16 v[40:43], v[80:83], v[104:107], 0
    ds_read_b64_tr_b16 v[134:135], v143 offset:9216
    v_mfma_f32_16x16x32_bf16 v[44:47], v[80:83], v[108:111], 0
    ds_read_b128 v[92:95], v137 offset:2048
    v_mfma_f32_16x16x32_bf16 v[48:51], v[80:83], v[112:115], 0
    ds_read_b128 v[96:99], v139 offset:0
    v_mfma_f32_16x16x32_bf16 v[52:55], v[80:83], v[116:119], 0
    ds_read_b128 v[100:103], v139 offset:2048
    v_mfma_f32_16x16x32_bf16 v[56:59], v[84:87], v[104:107], 0
    v_mfma_f32_16x16x32_bf16 v[60:63], v[84:87], v[108:111], 0
    v_mfma_f32_16x16x32_bf16 v[64:67], v[84:87], v[112:115], 0
    v_mfma_f32_16x16x32_bf16 v[68:71], v[84:87], v[116:119], 0
    v_dot2c_f32_bf16 v144, v72, v150
    v_dot2c_f32_bf16 v145, v72, v72
    v_dot2c_f32_bf16 v148, v104, v150
    v_dot2c_f32_bf16 v144, v73, v150
    v_dot2c_f32_bf16 v145, v73, v73
    v_dot2c_f32_bf16 v148, v105, v150
    v_dot2c_f32_bf16 v144, v74, v150
    v_dot2c_f32_bf16 v145, v74, v74
    v_dot2c_f32_bf16 v148, v106, v150
    v_dot2c_f32_bf16 v144, v75, v150
    v_dot2c_f32_bf16 v145, v75, v75
    v_dot2c_f32_bf16 v148, v107, v150
    v_dot2c_f32_bf16 v146, v76, v150
    v_dot2c_f32_bf16 v147, v76, v76
    v_dot2c_f32_bf16 v149, v108, v150
    v_dot2c_f32_bf16 v146, v77, v150
    v_dot2c_f32_bf16 v147, v77, v77
    v_dot2c_f32_bf16 v149, v109, v150
    v_dot2c_f32_bf16 v146, v78, v150
    v_dot2c_f32_bf16 v147, v78, v78
    v_dot2c_f32_bf16 v149, v110, v150
    v_dot2c_f32_bf16 v146, v79, v150
    v_dot2c_f32_bf16 v147, v79, v79
    v_dot2c_f32_bf16 v149, v111, v150
    s_waitcnt lgkmcnt(0)
    v_mfma_f32_16x16x32_bf16 v[8:11], v[88:91], v[120:123], v[8:11]
    v_add_u32 v136, s40, v136
    v_mfma_f32_16x16x32_bf16 v[12:15], v[88:91], v[124:127], v[12:15]
    v_add_u32 v137, s40, v137
    v_mfma_f32_16x16x32_bf16 v[16:19], v[88:91], v[128:131], v[16:19]
    v_add_u32 v138, s40, v138
    v_mfma_f32_16x16x32_bf16 v[20:23], v[88:91], v[132:135], v[20:23]
    v_add_u32 v139, s40, v139
    v_mfma_f32_16x16x32_bf16 v[24:27], v[92:95], v[120:123], v[24:27]
    v_add_u32 v140, s40, v140
    v_mfma_f32_16x16x32_bf16 v[28:31], v[92:95], v[124:127], v[28:31]
    v_add_u32 v141, s40, v141
    v_mfma_f32_16x16x32_bf16 v[32:35], v[92:95], v[128:131], v[32:35]
    v_add_u32 v142, s40, v142
    v_mfma_f32_16x16x32_bf16 v[36:39], v[92:95], v[132:135], v[36:39]
    v_add_u32 v143, s40, v143
    v_mfma_f32_16x16x32_bf16 v[40:43], v[96:99], v[120:123], v[40:43]
    v_mfma_f32_16x16x32_bf16 v[44:47], v[96:99], v[124:127], v[44:47]
    v_mfma_f32_16x16x32_bf16 v[48:51], v[96:99], v[128:131], v[48:51]
    v_mfma_f32_16x16x32_bf16 v[52:55], v[96:99], v[132:135], v[52:55]
    v_mfma_f32_16x16x32_bf16 v[56:59], v[100:103], v[120:123], v[56:59]
    v_mfma_f32_16x16x32_bf16 v[60:63], v[100:103], v[124:127], v[60:63]
    v_mfma_f32_16x16x32_bf16 v[64:67], v[100:103], v[128:131], v[64:67]
    v_mfma_f32_16x16x32_bf16 v[68:71], v[100:103], v[132:135], v[68:71]
    v_dot2c_f32_bf16 v144, v88, v150
    v_dot2c_f32_bf16 v145, v88, v88
    v_dot2c_f32_bf16 v148, v120, v150
    v_dot2c_f32_bf16 v144, v89, v150
    v_dot2c_f32_bf16 v145, v89, v89
    v_dot2c_f32_bf16 v148, v121, v150
    v_dot2c_f32_bf16 v144, v90, v150
    v_dot2c_f32_bf16 v145, v90, v90
    v_dot2c_f32_bf16 v148, v122, v150
    v_dot2c_f32_bf16 v144, v91, v150
    v_dot2c_f32_bf16 v145, v91, v91
    v_dot2c_f32_bf16 v148, v123, v150
    v_dot2c_f32_bf16 v146, v92, v150
    v_dot2c_f32_bf16 v147, v92, v92
    v_dot2c_f32_bf16 v149, v124, v150
    v_dot2c_f32_bf16 v146, v93, v150
    v_dot2c_f32_bf16 v147, v93, v93
    v_dot2c_f32_bf16 v149, v125, v150
    v_dot2c_f32_bf16 v146, v94, v150
    v_dot2c_f32_bf16 v147, v94, v94
    v_dot2c_f32_bf16 v149, v126, v150
    v_dot2c_f32_bf16 v146, v95, v150
    v_dot2c_f32_bf16 v147, v95, v95
    v_dot2c_f32_bf16 v149, v127, v150
    s_nop 2
    v_mov_b32 v152, v144
    v_mov_b32 v153, v145
    v_mov_b32 v154, v146
    v_mov_b32 v155, v147
    v_mov_b32 v156, v148
    v_mov_b32 v157, v149
    s_nop 1
    v_permlane32_swap_b32 v144, v152
    v_permlane32_swap_b32 v145, v153
    v_permlane32_swap_b32 v146, v154
    v_permlane32_swap_b32 v147, v155
    v_permlane32_swap_b32 v148, v156
    v_permlane32_swap_b32 v149, v157
    s_nop 1
    v_add_f32 v144, v144, v152
    v_add_f32 v145, v145, v153
    v_add_f32 v146, v146, v154
    v_add_f32 v147, v147, v155
    v_add_f32 v148, v148, v156
    v_add_f32 v149, v149, v157
    v_mov_b32 v152, v144
    v_mov_b32 v153, v145
    v_mov_b32 v154, v146
    v_mov_b32 v155, v147
    v_mov_b32 v156, v148
    v_mov_b32 v157, v149
    s_nop 1
    v_permlane16_swap_b32 v144, v152
    v_permlane16_swap_b32 v145, v153
    v_permlane16_swap_b32 v146, v154
    v_permlane16_swap_b32 v147, v155
    v_permlane16_swap_b32 v148, v156
    v_permlane16_swap_b32 v149, v157
    v_cmp_gt_u32 vcc, 16, v0
    s_nop 0
    v_add_f32 v144, v144, v152
    v_add_f32 v145, v145, v153
    v_add_f32 v146, v146, v154
    v_add_f32 v147, v147, v155
    v_add_f32 v148, v148, v156
    v_add_f32 v149, v149, v157
    v_cndmask_b32 v144, v146, v144, vcc
    v_cndmask_b32 v145, v147, v145, vcc
    v_cndmask_b32 v148, v149, v148, vcc
    v_lshlrev_b32 v1, 3, v0
    v_lshlrev_b32 v2, 2, v0
    s_mov_b32 exec_hi, 0
    buffer_store_dwordx2 v[144:145], v1, s[24:27], s38 offen sc1
    buffer_store_dword v148, v2, s[24:27], s39 offen sc1
    s_mov_b64 exec, -1
    s_barrier
    ds_read_b128 v[72:75], v136 offset:0
    ds_read_b64_tr_b16 v[104:105], v140 offset:0
    ds_read_b64_tr_b16 v[106:107], v140 offset:1024
    ds_read_b64_tr_b16 v[108:109], v141 offset:0
    ds_read_b64_tr_b16 v[110:111], v141 offset:1024
    ds_read_b64_tr_b16 v[112:113], v142 offset:0
    ds_read_b64_tr_b16 v[114:115], v142 offset:1024
    ds_read_b64_tr_b16 v[116:117], v143 offset:0
    ds_read_b64_tr_b16 v[118:119], v143 offset:1024
    ds_read_b128 v[76:79], v136 offset:2048
    ds_read_b128 v[80:83], v138 offset:0
    ds_read_b128 v[84:87], v138 offset:2048
    s_branch L_qinv
    .p2align 6
L_qloopv:
    s_waitcnt vmcnt(0) lgkmcnt(0)
    v_mfma_f32_16x16x32_bf16 v[8:11], v[88:91], v[120:123], v[8:11]
    s_barrier
    v_mfma_f32_16x16x32_bf16 v[12:15], v[88:91], v[124:127], v[12:15]
    ds_read_b128 v[72:75], v136 offset:0
    v_mfma_f32_16x16x32_bf16 v[16:19], v[88:91], v[128:131], v[16:19]
    ds_read_b64_tr_b16 v[104:105], v140 offset:0
    v_mfma_f32_16x16x32_bf16 v[20:23], v[88:91], v[132:135], v[20:23]
    ds_read_b64_tr_b16 v[106:107], v140 offset:1024
    v_mfma_f32_16x16x32_bf16 v[24:27], v[92:95], v[120:123], v[24:27]
    ds_read_b64_tr_b16 v[108:109], v141 offset:0
    v_mfma_f32_16x16x32_bf16 v[28:31], v[92:95], v[124:127], v[28:31]
    ds_read_b64_tr_b16 v[110:111], v141 offset:1024
    v_mfma_f32_16x16x32_bf16 v[32:35], v[92:95], v[128:131], v[32:35]
    ds_read_b64_tr_b16 v[112:113], v142 offset:0
    v_mfma_f32_16x16x32_bf16 v[36:39], v[92:95], v[132:135], v[36:39]
    ds_read_b64_tr_b16 v[114:115], v142 offset:1024
    v_mfma_f32_16x16x32_bf16 v[40:43], v[96:99], v[120:123], v[40:43]
    ds_read_b64_tr_b16 v[116:117], v143 offset:0
    v_mfma_f32_16x16x32_bf16 v[44:47], v[96:99], v[124:127], v[44:47]
    ds_read_b64_tr_b16 v[118:119], v143 offset:1024
    v_mfma_f32_16x16x32_bf16 v[48:51], v[96:99], v[128:131], v[48:51]
    ds_read_b128 v[76:79], v136 offset:2048
    v_mfma_f32_16x16x32_bf16 v[52:55], v[96:99], v[132:135], v[52:55]
    ds_read_b128 v[80:83], v138 offset:0
    v_mfma_f32_16x16x32_bf16 v[56:59], v[100:103], v[120:123], v[56:59]
    ds_read_b128 v[84:87], v138 offset:2048
    v_mfma_f32_16x16x32_bf16 v[60:63], v[100:103], v[124:127], v[60:63]
    s_add_u32 s37, s37, 1
    s_cmp_eq_u32 s37, 4
    v_mfma_f32_16x16x32_bf16 v[64:67], v[100:103], v[128:131], v[64:67]
    s_cselect_b32 s40, 4294918144, s41
    s_cselect_b32 s37, 0, s37
    v_mfma_f32_16x16x32_bf16 v[68:71], v[100:103], v[132:135], v[68:71]
L_qinv:
    s_waitcnt lgkmcnt(0)
    v_mfma_f32_16x16x32_bf16 v[8:11], v[72:75], v[104:107], v[8:11]
    ds_read_b128 v[88:91], v137 offset:0
    v_mfma_f32_16x16x32_bf16 v[12:15], v[72:75], v[108:111], v[12:15]
    ds_read_b64_tr_b16 v[120:121], v140 offset:8192
    v_mfma_f32_16x16x32_bf16 v[16:19], v[72:75], v[112:115], v[16:19]
    ds_read_b64_tr_b16 v[122:123], v140 offset:9216
    v_mfma_f32_16x16x32_bf16 v[20:23], v[72:75], v[116:119], v[20:23]
    ds_read_b64_tr_b16 v[124:125], v141 offset:8192
    v_mfma_f32_16x16x32_bf16 v[24:27], v[76:79], v[104:107], v[24:27]
    ds_read_b64_tr_b16 v[126:127], v141 offset:9216
    v_mfma_f32_16x16x32_bf16 v[28:31], v[76:79], v[108:111], v[28:31]
    ds_read_b64_tr_b16 v[128:129], v142 offset:8192
    v_mfma_f32_16x16x32_bf16 v[32:35], v[76:79], v[112:115], v[32:35]
    ds_read_b64_tr_b16 v[130:131], v142 offset:9216
    v_mfma_f32_16x16x32_bf16 v[36:39], v[76:79], v[116:119], v[36:39]
    ds_read_b64_tr_b16 v[132:133], v143 offset:8192
    v_mfma_f32_16x16x32_bf16 v[40:43], v[80:83], v[104:107], v[40:43]
    ds_read_b64_tr_b16 v[134:135], v143 offset:9216
    v_mfma_f32_16x16x32_bf16 v[44:47], v[80:83], v[108:111], v[44:47]
    ds_read_b128 v[92:95], v137 offset:2048
    v_mfma_f32_16x16x32_bf16 v[48:51], v[80:83], v[112:115], v[48:51]
    ds_read_b128 v[96:99], v139 offset:0
    v_mfma_f32_16x16x32_bf16 v[52:55], v[80:83], v[116:119], v[52:55]
    ds_read_b128 v[100:103], v139 offset:2048
    v_mfma_f32_16x16x32_bf16 v[56:59], v[84:87], v[104:107], v[56:59]
    v_add_u32 v136, s40, v136
    v_add_u32 v137, s40, v137
    v_mfma_f32_16x16x32_bf16 v[60:63], v[84:87], v[108:111], v[60:63]
    v_add_u32 v138, s40, v138
    v_add_u32 v139, s40, v139
    v_mfma_f32_16x16x32_bf16 v[64:67], v[84:87], v[112:115], v[64:67]
    v_add_u32 v140, s40, v140
    v_add_u32 v141, s40, v141
    v_mfma_f32_16x16x32_bf16 v[68:71], v[84:87], v[116:119], v[68:71]
    v_add_u32 v142, s40, v142
    v_add_u32 v143, s40, v143
    s_add_u32 s36, s36, 1
    s_cmp_lt_u32 s36, 10
    s_cbranch_scc1 L_qloopv
    s_waitcnt lgkmcnt(0)
    v_mfma_f32_16x16x32_bf16 v[8:11], v[88:91], v[120:123], v[8:11]
    ds_read_b32 v72, v170 offset:0
    v_mfma_f32_16x16x32_bf16 v[12:15], v[88:91], v[124:127], v[12:15]
    ds_read_b32 v73, v170 offset:64
    v_mfma_f32_16x16x32_bf16 v[16:19], v[88:91], v[128:131], v[16:19]
    ds_read_b32 v74, v171 offset:0
    v_mfma_f32_16x16x32_bf16 v[20:23], v[88:91], v[132:135], v[20:23]
    ds_read_b32 v75, v171 offset:64
    v_mfma_f32_16x16x32_bf16 v[24:27], v[92:95], v[120:123], v[24:27]
    ds_read_b128 v[104:107], v168 offset:0
    v_mfma_f32_16x16x32_bf16 v[28:31], v[92:95], v[124:127], v[28:31]
    ds_read_b128 v[108:111], v168 offset:64
    v_mfma_f32_16x16x32_bf16 v[32:35], v[92:95], v[128:131], v[32:35]
    ds_read_b128 v[112:115], v169 offset:0
    v_mfma_f32_16x16x32_bf16 v[36:39], v[92:95], v[132:135], v[36:39]
    ds_read_b128 v[116:119], v169 offset:64
    v_mfma_f32_16x16x32_bf16 v[40:43], v[96:99], v[120:123], v[40:43]
    ds_read_b128 v[172:175], v168 offset:512
    v_mfma_f32_16x16x32_bf16 v[44:47], v[96:99], v[124:127], v[44:47]
    ds_read_b128 v[176:179], v168 offset:576
    v_mfma_f32_16x16x32_bf16 v[48:51], v[96:99], v[128:131], v[48:51]
    ds_read_b128 v[180:183], v169 offset:512
    v_mfma_f32_16x16x32_bf16 v[52:55], v[96:99], v[132:135], v[52:55]
    ds_read_b128 v[184:187], v169 offset:576
    v_mfma_f32_16x16x32_bf16 v[56:59], v[100:103], v[120:123], v[56:59]
    v_mfma_f32_16x16x32_bf16 v[60:63], v[100:103], v[124:127], v[60:63]
    v_mfma_f32_16x16x32_bf16 v[64:67], v[100:103], v[128:131], v[64:67]
    v_mfma_f32_16x16x32_bf16 v[68:71], v[100:103], v[132:135], v[68:71]
    s_waitcnt lgkmcnt(0)
    v_sub_f32 v152, 0, v72
    v_sub_f32 v153, 0, v72
    v_sub_f32 v154, 0, v73
    v_sub_f32 v155, 0, v73
    v_sub_f32 v156, 0, v74
    v_sub_f32 v157, 0, v74
    v_sub_f32 v158, 0, v75
    v_sub_f32 v159, 0, v75
    v_pk_fma_f32 v[8:9], v[104:105], v[152:153], v[8:9]
    v_pk_fma_f32 v[10:11], v[106:107], v[152:153], v[10:11]
    v_pk_fma_f32 v[12:13], v[104:105], v[154:155], v[12:13]
    v_pk_fma_f32 v[14:15], v[106:107], v[154:155], v[14:15]
    v_pk_fma_f32 v[16:17], v[104:105], v[156:157], v[16:17]
    v_pk_fma_f32 v[18:19], v[106:107], v[156:157], v[18:19]
    v_pk_fma_f32 v[20:21], v[104:105], v[158:159], v[20:21]
    v_pk_fma_f32 v[22:23], v[106:107], v[158:159], v[22:23]
    v_pk_mul_f32 v[8:9], v[8:9], v[172:173]
    v_pk_mul_f32 v[10:11], v[10:11], v[174:175]
    v_pk_mul_f32 v[12:13], v[12:13], v[172:173]
    v_pk_mul_f32 v[14:15], v[14:15], v[174:175]
    v_pk_mul_f32 v[16:17], v[16:17], v[172:173]
    v_pk_mul_f32 v[18:19], v[18:19], v[174:175]
    v_pk_mul_f32 v[20:21], v[20:21], v[172:173]
    v_pk_mul_f32 v[22:23], v[22:23], v[174:175]
    v_cvt_pk_bf16_f32 v8, v8, v9
    v_cvt_pk_bf16_f32 v9, v10, v11
    v_cvt_pk_bf16_f32 v10, v12, v13
    v_cvt_pk_bf16_f32 v11, v14, v15
    v_cvt_pk_bf16_f32 v12, v16, v17
    v_cvt_pk_bf16_f32 v13, v18, v19
    v_cvt_pk_bf16_f32 v14, v20, v21
    v_cvt_pk_bf16_f32 v15, v22, v23
    s_nop 1
    v_permlane32_swap_b32 v8, v10
    v_permlane32_swap_b32 v9, v11
    buffer_store_dwordx4 v[8:11], v160, s[28:31], s44 offen sc1
    v_permlane32_swap_b32 v12, v14
    v_permlane32_swap_b32 v13, v15
    buffer_store_dwordx4 v[12:15], v161, s[28:31], s44 offen sc1
    v_pk_fma_f32 v[24:25], v[108:109], v[152:153], v[24:25]
    v_pk_fma_f32 v[26:27], v[110:111], v[152:153], v[26:27]
    v_pk_fma_f32 v[28:29], v[108:109], v[154:155], v[28:29]
    v_pk_fma_f32 v[30:31], v[110:111], v[154:155], v[30:31]
    v_pk_fma_f32 v[32:33], v[108:109], v[156:157], v[32:33]
    v_pk_fma_f32 v[34:35], v[110:111], v[156:157], v[34:35]
    v_pk_fma_f32 v[36:37], v[108:109], v[158:159], v[36:37]
    v_pk_fma_f32 v[38:39], v[110:111], v[158:159], v[38:39]
    v_pk_mul_f32 v[24:25], v[24:25], v[176:177]
    v_pk_mul_f32 v[26:27], v[26:27], v[178:179]
    v_pk_mul_f32 v[28:29], v[28:29], v[176:177]
    v_pk_mul_f32 v[30:31], v[30:31], v[178:179]
    v_pk_mul_f32 v[32:33], v[32:33], v[176:177]
    v_pk_mul_f32 v[34:35], v[34:35], v[178:179]
    v_pk_mul_f32 v[36:37], v[36:37], v[176:177]
    v_pk_mul_f32 v[38:39], v[38:39], v[178:179]
    v_cvt_pk_bf16_f32 v24, v24, v25
    v_cvt_pk_bf16_f32 v25, v26, v27
    v_cvt_pk_bf16_f32 v26, v28, v29
    v_cvt_pk_bf16_f32 v27, v30, v31
    v_cvt_pk_bf16_f32 v28, v32, v33
    v_cvt_pk_bf16_f32 v29, v34, v35
    v_cvt_pk_bf16_f32 v30, v36, v37
    v_cvt_pk_bf16_f32 v31, v38, v39
    s_nop 1
    v_permlane32_swap_b32 v24, v26
    v_permlane32_swap_b32 v25, v27
    buffer_store_dwordx4 v[24:27], v162, s[28:31], s44 offen sc1
    v_permlane32_swap_b32 v28, v30
    v_permlane32_swap_b32 v29, v31
    buffer_store_dwordx4 v[28:31], v163, s[28:31], s44 offen sc1
    v_pk_fma_f32 v[40:41], v[112:113], v[152:153], v[40:41]
    v_pk_fma_f32 v[42:43], v[114:115], v[152:153], v[42:43]
    v_pk_fma_f32 v[44:45], v[112:113], v[154:155], v[44:45]
    v_pk_fma_f32 v[46:47], v[114:115], v[154:155], v[46:47]
    v_pk_fma_f32 v[48:49], v[112:113], v[156:157], v[48:49]
    v_pk_fma_f32 v[50:51], v[114:115], v[156:157], v[50:51]
    v_pk_fma_f32 v[52:53], v[112:113], v[158:159], v[52:53]
    v_pk_fma_f32 v[54:55], v[114:115], v[158:159], v[54:55]
    v_pk_mul_f32 v[40:41], v[40:41], v[180:181]
    v_pk_mul_f32 v[42:43], v[42:43], v[182:183]
    v_pk_mul_f32 v[44:45], v[44:45], v[180:181]
    v_pk_mul_f32 v[46:47], v[46:47], v[182:183]
    v_pk_mul_f32 v[48:49], v[48:49], v[180:181]
    v_pk_mul_f32 v[50:51], v[50:51], v[182:183]
    v_pk_mul_f32 v[52:53], v[52:53], v[180:181]
    v_pk_mul_f32 v[54:55], v[54:55], v[182:183]
    v_cvt_pk_bf16_f32 v40, v40, v41
    v_cvt_pk_bf16_f32 v41, v42, v43
    v_cvt_pk_bf16_f32 v42, v44, v45
    v_cvt_pk_bf16_f32 v43, v46, v47
    v_cvt_pk_bf16_f32 v44, v48, v49
    v_cvt_pk_bf16_f32 v45, v50, v51
    v_cvt_pk_bf16_f32 v46, v52, v53
    v_cvt_pk_bf16_f32 v47, v54, v55
    s_nop 1
    v_permlane32_swap_b32 v40, v42
    v_permlane32_swap_b32 v41, v43
    buffer_store_dwordx4 v[40:43], v160, s[28:31], s45 offen sc1
    v_permlane32_swap_b32 v44, v46
    v_permlane32_swap_b32 v45, v47
    buffer_store_dwordx4 v[44:47], v161, s[28:31], s45 offen sc1
    v_pk_fma_f32 v[56:57], v[116:117], v[152:153], v[56:57]
    v_pk_fma_f32 v[58:59], v[118:119], v[152:153], v[58:59]
    v_pk_fma_f32 v[60:61], v[116:117], v[154:155], v[60:61]
    v_pk_fma_f32 v[62:63], v[118:119], v[154:155], v[62:63]
    v_pk_fma_f32 v[64:65], v[116:117], v[156:157], v[64:65]
    v_pk_fma_f32 v[66:67], v[118:119], v[156:157], v[66:67]
    v_pk_fma_f32 v[68:69], v[116:117], v[158:159], v[68:69]
    v_pk_fma_f32 v[70:71], v[118:119], v[158:159], v[70:71]
    v_pk_mul_f32 v[56:57], v[56:57], v[184:185]
    v_pk_mul_f32 v[58:59], v[58:59], v[186:187]
    v_pk_mul_f32 v[60:61], v[60:61], v[184:185]
    v_pk_mul_f32 v[62:63], v[62:63], v[186:187]
    v_pk_mul_f32 v[64:65], v[64:65], v[184:185]
    v_pk_mul_f32 v[66:67], v[66:67], v[186:187]
    v_pk_mul_f32 v[68:69], v[68:69], v[184:185]
    v_pk_mul_f32 v[70:71], v[70:71], v[186:187]
    v_cvt_pk_bf16_f32 v56, v56, v57
    v_cvt_pk_bf16_f32 v57, v58, v59
    v_cvt_pk_bf16_f32 v58, v60, v61
    v_cvt_pk_bf16_f32 v59, v62, v63
    v_cvt_pk_bf16_f32 v60, v64, v65
    v_cvt_pk_bf16_f32 v61, v66, v67
    v_cvt_pk_bf16_f32 v62, v68, v69
    v_cvt_pk_bf16_f32 v63, v70, v71
    s_nop 1
    v_permlane32_swap_b32 v56, v58
    v_permlane32_swap_b32 v57, v59
    buffer_store_dwordx4 v[56:59], v162, s[28:31], s45 offen sc1
    v_permlane32_swap_b32 v60, v62
    v_permlane32_swap_b32 v61, v63
    buffer_store_dwordx4 v[60:63], v163, s[28:31], s45 offen sc1
L_qdone:
    s_waitcnt lgkmcnt(0) vmcnt(0)
    s_barrier
    s_lshr_b32 s12, s10, 1
    s_lshl_b32 s12, s12, 3
    s_and_b32 s13, s11, 7
    s_add_u32 s12, s12, s13
    s_and_b32 s13, s10, 1
    s_lshl_b32 s13, s13, 2
    s_lshr_b32 s14, s11, 3
    s_add_u32 s13, s13, s14
    s_lshr_b32 s14, s3, 1
    s_and_b32 s15, s3, 1
    s_lshl_b32 s15, s15, 1
    s_add_u32 s15, s15, s14
    s_lshl_b32 s32, s12, 2
    s_add_u32 s15, s15, s32
    v_lshlrev_b32 v2, 4, v0
    s_lshl_b32 s32, s15, 4
    v_and_b32 v1, 15, v0
    v_add_u32 v5, s32, v1
    v_mul_u32_u24 v6, 1280, v5
    v_lshrrev_b32 v5, 4, v0
    v_lshl_add_u32 v6, v5, 3, v6
    s_mul_i32 s33, s13, 160
    v_add_u32 v4, s33, v6
    s_xor_b32 s44, s15, 1
    s_mov_b32 s24, s4
    s_mov_b32 s25, s5
    s_mov_b32 s26, 2621440
    s_mov_b32 s27, 0x00020000
    buffer_load_dwordx2 v[240:241], v4, s[24:27], 0 offen offset:0
    buffer_load_dwordx2 v[242:243], v4, s[24:27], 0 offen offset:32
    buffer_load_dwordx2 v[244:245], v4, s[24:27], 0 offen offset:64
    buffer_load_dwordx2 v[246:247], v4, s[24:27], 0 offen offset:96
    buffer_load_dwordx2 v[248:249], v4, s[24:27], 0 offen offset:128
    s_lshl_b32 s36, s15, 14
    v_add_u32 v230, s36, v2
    s_lshl_b32 s36, s44, 14
    v_add_u32 v231, s36, v2
    v_lshrrev_b32 v6, 1, v5
    v_and_b32 v5, 1, v5
    v_lshlrev_b32 v234, 8, v6
    v_lshl_add_u32 v234, v1, 4, v234
    v_lshl_add_u32 v234, v5, 3, v234
    s_mul_i32 s32, s15, 20480
    s_mul_i32 s33, s13, 2560
    s_add_u32 s32, s32, s33
    s_add_u32 s32, s32, 2621440
    v_add_u32 v234, s32, v234
    v_lshl_add_u32 v7, v6, 2, v5
    v_lshlrev_b32 v3, 7, v7
    v_lshl_add_u32 v3, v1, 3, v3
    s_mov_b32 s32, 2097152
    s_lshl_b32 s36, s15, 12
    s_add_u32 s36, s36, s32
    v_add_u32 v232, s36, v3
    s_lshl_b32 s36, s44, 12
    s_add_u32 s36, s36, s32
    v_add_u32 v233, s36, v3
    v_mul_u32_u24 v7, 20, v7
    v_add_u32 v7, 8, v7
    v_mul_u32_u24 v6, 20, v6
    v_mul_u32_u24 v5, 12, v5
    v_add_u32 v6, v6, v5
    v_bfe_u32 v5, v0, 2, 2
    v_add_u32 v6, v6, v5
    v_add_u32 v7, v7, v5
    v_mul_u32_u24 v6, 160, v6
    v_mul_u32_u24 v7, 160, v7
    v_and_b32 v5, 3, v0
    v_lshl_add_u32 v6, v5, 3, v6
    v_lshl_add_u32 v7, v5, 3, v7
    s_mul_i32 s32, s14, 81920
    s_add_u32 s32, s32, 704
    v_add_u32 v236, s32, v6
    v_add_u32 v237, s32, v7
    s_lshl_b32 s32, s15, 3
    s_add_u32 s32, s32, s13
    s_lshl_b32 s32, s32, 7
    s_add_u32 s32, s32, 11534336
    v_lshlrev_b32 v7, 3, v1
    v_add_u32 v235, s32, v7
    s_mul_i32 s32, s3, 40960
    s_add_u32 s32, s32, 33792
    v_add_u32 v238, s32, v2
    s_xor_b32 s33, s3, 2
    s_mul_i32 s33, s33, 40960
    s_add_u32 s33, s33, 33792
    v_add_u32 v239, s33, v2
    s_lshl_b32 s32, s12, 7
    v_and_b32 v250, 31, v0
    v_lshlrev_b32 v250, 2, v250
    v_add_u32 v250, s32, v250
    s_lshl_b32 s12, s10, 2
    s_lshr_b32 s13, s11, 3
    s_add_u32 s12, s12, s13
    s_and_b32 s13, s11, 7
    s_mul_i32 s20, s12, 81920
    v_lshlrev_b32 v2, 4, v0
    s_and_b32 s15, s3, 1
    s_lshr_b32 s14, s3, 1
    v_lshlrev_b32 v3, 3, v0
    s_lshl_b32 s21, s13, 3
    s_lshl_b32 s22, s15, 2
    s_add_u32 s21, s21, s22
    s_mul_i32 s21, s21, 1280
    s_add_u32 s21, s21, s20
    s_mul_i32 s22, s14, 2560
    s_sub_u32 s25, s21, s22
    s_add_u32 s21, s21, s22
    s_add_u32 s22, s25, 2560
    s_mov_b32 s40, -1
    s_mov_b32 s41, 0
    s_mov_b32 s42, 0x000fffff
    s_mov_b32 s43, 0x000fffff
    s_mov_b32 s46, 0
    s_mov_b32 s27, 2
    v_mov_b32 v124, 0
    v_mov_b32 v125, 0
    v_mov_b32 v130, 0
    v_mov_b32 v131, 0
    v_mov_b32 v136, 0
    v_mov_b32 v137, 0
    v_mov_b32 v142, 0
    v_mov_b32 v143, 0
    s_mov_b32 s16, s8
    s_mov_b32 s17, s9
    s_mov_b32 s18, 7864320
    s_mov_b32 s19, 0x00020000
    s_add_u32 s28, s8, 7864320
    s_addc_u32 s29, s9, 0
    s_mov_b32 s30, 11665408
    s_mov_b32 s31, 0x00020000
    s_add_u32 s92, s8, 19529728
    s_addc_u32 s93, s9, 0
    s_mov_b32 s94, 49152
    s_mov_b32 s95, 0x00020000
    v_and_b32 v5, 31, v0
    v_lshrrev_b32 v1, 2, v5
    v_lshlrev_b32 v1, 2, v1
    v_mov_b32 v7, 0x24130
    v_lshrrev_b32 v7, v1, v7
    v_and_b32 v7, 7, v7
    v_and_b32 v6, 3, v5
    v_lshl_add_u32 v7, v7, 2, v6
    v_lshlrev_b32 v7, 4, v7
    v_lshrrev_b32 v6, 5, v0
    v_mul_u32_u24 v6, 320, v6
    v_add_u32 v4, v7, v6
    s_mul_i32 s23, s14, 40960
    s_add_u32 s24, s23, 81920
    v_mov_b32 v148, 0x3f803f80
    v_mov_b32 v149, 0x3f80
    v_mov_b32 v162, 0x3f803f80
    v_mov_b32 v163, 0x3f80
    v_cmp_eq_u32 vcc, 20, v5
    v_cmp_eq_u32 s[44:45], 24, v5
    s_nop 3
    s_or_b64 vcc, vcc, s[44:45]
    v_mov_b32 v6, 0x3f803f80
    s_nop 1
    v_cndmask_b32 v6, 0, v6, vcc
    v_mov_b32 v150, v6
    v_mov_b32 v151, v6
    v_mov_b32 v152, v6
    v_mov_b32 v153, v6
    v_mov_b32 v154, v6
    v_mov_b32 v155, v6
    v_mov_b32 v156, v6
    v_mov_b32 v157, v6
    v_mov_b32 v164, v6
    v_mov_b32 v165, v6
    v_mov_b32 v166, v6
    v_mov_b32 v167, v6
    v_mov_b32 v168, v6
    v_mov_b32 v169, v6
    v_mov_b32 v170, v6
    v_mov_b32 v171, v6
    s_lshl_b32 s32, s13, 2
    s_lshl_b32 s33, s15, 1
    s_add_u32 s32, s32, s33
    s_add_u32 s32, s32, s14
    s_lshl_b32 s25, s32, 7
    s_lshl_b32 s33, s12, 2
    s_add_u32 s25, s25, s33
    s_lshl_b32 s32, s32, 2
    v_bfe_u32 v7, v0, 4, 1
    v_add_u32 v7, s32, v7
    v_and_b32 v1, 15, v0
    v_lshlrev_b32 v224, 14, v7
    v_lshl_add_u32 v224, v1, 4, v224
    v_lshrrev_b32 v6, 5, v0
    v_lshl_add_u32 v224, v6, 8, v224
    v_lshlrev_b32 v225, 12, v7
    v_lshl_add_u32 v225, v1, 3, v225
    s_mul_i32 s32, s3, 40960
    s_add_u32 s32, s32, 26304
    v_add_u32 v226, s32, v2
    v_add_u32 v227, s32, v3
    s_xor_b32 s33, s3, 2
    s_mul_i32 s33, s33, 40960
    s_add_u32 s33, s33, 26304
    v_add_u32 v228, s33, v2
    v_add_u32 v229, s33, v3
    s_lshl_b32 s32, s12, 9
    s_add_u32 s33, s32, 32768
    s_lshl_b32 s34, s12, 7
    s_add_u32 s34, s34, 2097152
    s_add_u32 s35, s34, 8192
    s_mov_b32 s47, 0x5f800000
    v_add_u32 v180, s23, v2
    v_mov_b32 v1, s23
    v_add_u32 v6, 2304, v3
    v_add_u32 v6, s23, v6
    v_cndmask_b32 v181, v1, v6, s[40:41]
    v_mov_b32 v7, 1280
    v_cndmask_b32 v185, 0, v7, s[40:41]
    v_add_u32 v182, v181, v185
    v_lshlrev_b32 v185, 1, v185
    v_cmp_eq_u32 vcc, 0, v150
    v_add_u32 v6, 1280, v4
    s_nop 0
    v_cndmask_b32 v1, 0, 16, vcc
    v_cndmask_b32 v1, v1, v6, s[42:43]
    v_add_u32 v183, s24, v1
    v_cndmask_b32 v186, 0, v7, s[42:43]
    v_add_u32 v184, v183, v186
    v_lshlrev_b32 v186, 1, v186
    v_lshrrev_b32 v6, 5, v0
    v_mul_u32_u24 v7, 624, v6
    v_lshlrev_b32 v187, 1, v4
    v_sub_u32 v187, v187, v7
    s_add_u32 s36, s20, s23
    s_add_u32 s36, s36, 2621440
    s_mul_i32 s37, s12, 640
    s_mul_i32 s38, s14, 1310720
    s_add_u32 s37, s37, s38
    s_add_u32 s37, s37, 5242880
    s_mov_b32 s26, 0
    v_mov_b32 v8, 0
    v_mov_b32 v9, 0
    v_mov_b32 v10, 0
    v_mov_b32 v11, 0
    v_mov_b32 v12, 0
    v_mov_b32 v13, 0
    v_mov_b32 v14, 0
    v_mov_b32 v15, 0
    v_mov_b32 v16, 0
    v_mov_b32 v17, 0
    v_mov_b32 v18, 0
    v_mov_b32 v19, 0
    v_mov_b32 v20, 0
    v_mov_b32 v21, 0
    v_mov_b32 v22, 0
    v_mov_b32 v23, 0
    v_mov_b32 v24, 0
    v_mov_b32 v25, 0
    v_mov_b32 v26, 0
    v_mov_b32 v27, 0
    v_mov_b32 v28, 0
    v_mov_b32 v29, 0
    v_mov_b32 v30, 0
    v_mov_b32 v31, 0
    v_mov_b32 v32, 0
    v_mov_b32 v33, 0
    v_mov_b32 v34, 0
    v_mov_b32 v35, 0
    v_mov_b32 v36, 0
    v_mov_b32 v37, 0
    v_mov_b32 v38, 0
    v_mov_b32 v39, 0
    v_mov_b32 v40, 0
    v_mov_b32 v41, 0
    v_mov_b32 v42, 0
    v_mov_b32 v43, 0
    v_mov_b32 v44, 0
    v_mov_b32 v45, 0
    v_mov_b32 v46, 0
    v_mov_b32 v47, 0
    v_mov_b32 v48, 0
    v_mov_b32 v49, 0
    v_mov_b32 v50, 0
    v_mov_b32 v51, 0
    v_mov_b32 v52, 0
    v_mov_b32 v53, 0
    v_mov_b32 v54, 0
    v_mov_b32 v55, 0
    v_mov_b32 v56, 0
    v_mov_b32 v57, 0
    v_mov_b32 v58, 0
    v_mov_b32 v59, 0
    v_mov_b32 v60, 0
    v_mov_b32 v61, 0
    v_mov_b32 v62, 0
    v_mov_b32 v63, 0
    v_mov_b32 v64, 0
    v_mov_b32 v65, 0
    v_mov_b32 v66, 0
    v_mov_b32 v67, 0
    v_mov_b32 v68, 0
    v_mov_b32 v69, 0
    v_mov_b32 v70, 0
    v_mov_b32 v71, 0
    v_mov_b32 v112, 0
    v_mov_b32 v113, 0
    v_mov_b32 v114, 0
    v_mov_b32 v115, 0
    v_mov_b32 v116, 0
    v_mov_b32 v117, 0
    v_mov_b32 v118, 0
    v_mov_b32 v119, 0
    s_barrier
    buffer_load_dwordx4 v[120:123], v2, s[16:19], s22 offen offset:0 sc1
    buffer_load_dwordx4 v[126:129], v2, s[16:19], s22 offen offset:1280 sc1
    buffer_load_dwordx4 v[132:135], v2, s[16:19], s21 offen offset:0 sc1
    buffer_load_dwordx4 v[138:141], v2, s[16:19], s21 offen offset:1280 sc1
    buffer_load_dwordx4 v[144:147], v2, s[16:19], s36 offen sc1
    s_mov_b64 exec, s[40:41]
    buffer_load_dwordx2 v[148:149], v3, s[16:19], s36 offen offset:1024 sc1
    buffer_load_dwordx2 v[124:125], v3, s[16:19], s22 offen offset:1024 sc1
    buffer_load_dwordx2 v[130:131], v3, s[16:19], s22 offen offset:2304 sc1
    buffer_load_dwordx2 v[136:137], v3, s[16:19], s21 offen offset:1024 sc1
    buffer_load_dwordx2 v[142:143], v3, s[16:19], s21 offen offset:2304 sc1
    s_mov_b64 exec, s[42:43]
    s_add_u32 s38, s37, 20480
    buffer_load_dwordx4 v[150:153], v187, s[16:19], s37 offen sc1
    buffer_load_dwordx4 v[154:157], v187, s[16:19], s38 offen sc1
    s_mov_b64 exec, -1
    s_waitcnt vmcnt(2)
    v_mfma_f32_32x32x16_bf16 v[72:87], v[144:147], v[120:123], 0
    v_mfma_f32_32x32x8_bf16 v[72:87], v[148:149], v[124:125], v[72:87]
    v_mfma_f32_32x32x16_bf16 v[88:103], v[144:147], v[126:129], 0
    v_mfma_f32_32x32x8_bf16 v[88:103], v[148:149], v[130:131], v[88:103]
    v_mfma_f32_32x32x16_bf16 v[192:207], v[144:147], v[132:135], 0
    v_mfma_f32_32x32x8_bf16 v[192:207], v[148:149], v[136:137], v[192:207]
    v_mfma_f32_32x32x16_bf16 v[208:223], v[144:147], v[138:141], 0
    v_mfma_f32_32x32x8_bf16 v[208:223], v[148:149], v[142:143], v[208:223]
    s_nop 7
    v_max3_f32 v172, v72, v73, v74
    v_max_f32 v172, v172, v87
    v_max3_f32 v172, v172, v75, v76
    v_max3_f32 v172, v172, v77, v78
    v_max3_f32 v172, v172, v79, v80
    v_max3_f32 v172, v172, v81, v82
    v_max3_f32 v172, v172, v83, v84
    v_max3_f32 v172, v172, v85, v86
    v_max3_f32 v173, v88, v89, v90
    v_max_f32 v173, v173, v103
    v_max3_f32 v173, v173, v91, v92
    v_max3_f32 v173, v173, v93, v94
    v_max3_f32 v173, v173, v95, v96
    v_max3_f32 v173, v173, v97, v98
    v_max3_f32 v173, v173, v99, v100
    v_max3_f32 v173, v173, v101, v102
    v_max3_f32 v174, v192, v193, v194
    v_max_f32 v174, v174, v207
    v_max3_f32 v174, v174, v195, v196
    v_max3_f32 v174, v174, v197, v198
    v_max3_f32 v174, v174, v199, v200
    v_max3_f32 v174, v174, v201, v202
    v_max3_f32 v174, v174, v203, v204
    v_max3_f32 v174, v174, v205, v206
    v_max3_f32 v175, v208, v209, v210
    v_max_f32 v175, v175, v223
    v_max3_f32 v175, v175, v211, v212
    v_max3_f32 v175, v175, v213, v214
    v_max3_f32 v175, v175, v215, v216
    v_max3_f32 v175, v175, v217, v218
    v_max3_f32 v175, v175, v219, v220
    v_max3_f32 v175, v175, v221, v222
    v_mov_b32 v176, v172
    v_mov_b32 v177, v173
    v_mov_b32 v178, v174
    v_mov_b32 v179, v175
    s_nop 1
    v_permlane32_swap_b32 v172, v176
    v_permlane32_swap_b32 v173, v177
    v_permlane32_swap_b32 v174, v178
    v_permlane32_swap_b32 v175, v179
    s_nop 1
    v_max_f32 v172, v172, v176
    v_sub_f32 v172, 0, v172
    v_and_b32 v5, 0xffff0000, v172
    v_sub_f32 v6, v172, v5
    v_and_b32 v7, 0xffff0000, v6
    v_sub_f32 v6, v6, v7
    v_lshrrev_b32 v5, 16, v5
    v_or_b32 v5, v5, v7
    v_lshrrev_b32 v6, 16, v6
    v_cndmask_b32 v124, v5, v124, s[40:41]
    v_cndmask_b32 v125, v6, v125, s[40:41]
    v_max_f32 v173, v173, v177
    v_sub_f32 v173, 0, v173
    v_and_b32 v5, 0xffff0000, v173
    v_sub_f32 v6, v173, v5
    v_and_b32 v7, 0xffff0000, v6
    v_sub_f32 v6, v6, v7
    v_lshrrev_b32 v5, 16, v5
    v_or_b32 v5, v5, v7
    v_lshrrev_b32 v6, 16, v6
    v_cndmask_b32 v130, v5, v130, s[40:41]
    v_cndmask_b32 v131, v6, v131, s[40:41]
    v_max_f32 v174, v174, v178
    v_sub_f32 v174, 0, v174
    v_and_b32 v5, 0xffff0000, v174
    v_sub_f32 v6, v174, v5
    v_and_b32 v7, 0xffff0000, v6
    v_sub_f32 v6, v6, v7
    v_lshrrev_b32 v5, 16, v5
    v_or_b32 v5, v5, v7
    v_lshrrev_b32 v6, 16, v6
    v_cndmask_b32 v136, v5, v136, s[40:41]
    v_cndmask_b32 v137, v6, v137, s[40:41]
    v_max_f32 v175, v175, v179
    v_sub_f32 v175, 0, v175
    v_and_b32 v5, 0xffff0000, v175
    v_sub_f32 v6, v175, v5
    v_and_b32 v7, 0xffff0000, v6
    v_sub_f32 v6, v6, v7
    v_lshrrev_b32 v5, 16, v5
    v_or_b32 v5, v5, v7
    v_lshrrev_b32 v6, 16, v6
    v_cndmask_b32 v142, v5, v142, s[40:41]
    v_cndmask_b32 v143, v6, v143, s[40:41]
    v_mfma_f32_32x32x16_bf16 v[72:87], v[144:147], v[120:123], 0
    v_mfma_f32_32x32x8_bf16 v[72:87], v[148:149], v[124:125], v[72:87]
    s_waitcnt vmcnt(0)
    s_barrier
    s_nop 7
    s_nop 3
    s_branch L_loop
    .p2align 6
L_loop:
    v_mfma_f32_32x32x16_bf16 v[88:103], v[144:147], v[126:129], 0
    ds_read_b128 v[158:161], v180 offset:1280
    v_exp_f32 v72, v72
    v_exp_f32 v73, v73
    v_exp_f32 v74, v74
    v_exp_f32 v75, v75
    v_cvt_pk_bf16_f32 v104, v72, v73
    v_mfma_f32_32x32x8_bf16 v[88:103], v[148:149], v[130:131], v[88:103]
    v_exp_f32 v76, v76
    v_exp_f32 v77, v77
    v_exp_f32 v78, v78
    v_exp_f32 v79, v79
    v_cvt_pk_bf16_f32 v105, v74, v75
    v_cvt_pk_bf16_f32 v106, v76, v77
    v_mfma_f32_32x32x16_bf16 v[56:71], v[164:167], v[112:115], v[56:71]
    ds_read_b64 v[162:163], v181
    v_exp_f32 v80, v80
    v_exp_f32 v81, v81
    v_exp_f32 v82, v82
    v_exp_f32 v83, v83
    v_cvt_pk_bf16_f32 v107, v78, v79
    v_cvt_pk_bf16_f32 v108, v80, v81
    v_mfma_f32_32x32x16_bf16 v[56:71], v[168:171], v[116:119], v[56:71]
    v_exp_f32 v84, v84
    v_exp_f32 v85, v85
    v_exp_f32 v86, v86
    v_exp_f32 v87, v87
    v_cvt_pk_bf16_f32 v109, v82, v83
    v_cvt_pk_bf16_f32 v110, v84, v85
    v_cvt_pk_bf16_f32 v111, v86, v87
    v_mfma_f32_32x32x16_bf16 v[72:87], v[144:147], v[132:135], 0
    ds_read_b128 v[164:167], v183
    v_exp_f32 v88, v88
    v_exp_f32 v89, v89
    v_exp_f32 v90, v90
    v_exp_f32 v91, v91
    v_cvt_pk_bf16_f32 v112, v88, v89
    v_mfma_f32_32x32x8_bf16 v[72:87], v[148:149], v[136:137], v[72:87]
    v_exp_f32 v92, v92
    v_exp_f32 v93, v93
    v_exp_f32 v94, v94
    v_exp_f32 v95, v95
    v_cvt_pk_bf16_f32 v113, v90, v91
    v_cvt_pk_bf16_f32 v114, v92, v93
    v_mfma_f32_32x32x16_bf16 v[8:23], v[150:153], v[104:107], v[8:23]
    ds_read_b128 v[168:171], v183 offset:640
    v_exp_f32 v96, v96
    v_exp_f32 v97, v97
    v_exp_f32 v98, v98
    v_exp_f32 v99, v99
    v_cvt_pk_bf16_f32 v115, v94, v95
    v_cvt_pk_bf16_f32 v116, v96, v97
    v_mfma_f32_32x32x16_bf16 v[8:23], v[154:157], v[108:111], v[8:23]
    v_exp_f32 v100, v100
    v_exp_f32 v101, v101
    v_exp_f32 v102, v102
    v_exp_f32 v103, v103
    v_cvt_pk_bf16_f32 v117, v98, v99
    v_cvt_pk_bf16_f32 v118, v100, v101
    v_cvt_pk_bf16_f32 v119, v102, v103
    v_mfma_f32_32x32x16_bf16 v[88:103], v[144:147], v[138:141], 0
    v_exp_f32 v72, v72
    v_exp_f32 v73, v73
    v_exp_f32 v74, v74
    v_exp_f32 v75, v75
    v_cvt_pk_bf16_f32 v104, v72, v73
    v_mfma_f32_32x32x8_bf16 v[88:103], v[148:149], v[142:143], v[88:103]
    v_exp_f32 v76, v76
    v_exp_f32 v77, v77
    v_exp_f32 v78, v78
    v_exp_f32 v79, v79
    v_cvt_pk_bf16_f32 v105, v74, v75
    v_cvt_pk_bf16_f32 v106, v76, v77
    v_mfma_f32_32x32x16_bf16 v[24:39], v[150:153], v[112:115], v[24:39]
    v_exp_f32 v80, v80
    v_exp_f32 v81, v81
    v_exp_f32 v82, v82
    v_exp_f32 v83, v83
    v_cvt_pk_bf16_f32 v107, v78, v79
    v_cvt_pk_bf16_f32 v108, v80, v81
    v_mfma_f32_32x32x16_bf16 v[24:39], v[154:157], v[116:119], v[24:39]
    s_waitcnt lgkmcnt(0)
    v_exp_f32 v84, v84
    v_exp_f32 v85, v85
    v_add_u32 v181, v181, v185
    v_add_u32 v183, v183, v186
    v_exp_f32 v86, v86
    v_exp_f32 v87, v87
    v_cvt_pk_bf16_f32 v109, v82, v83
    v_cvt_pk_bf16_f32 v110, v84, v85
    v_cvt_pk_bf16_f32 v111, v86, v87
    v_mfma_f32_32x32x16_bf16 v[72:87], v[158:161], v[120:123], 0
    v_exp_f32 v88, v88
    v_exp_f32 v89, v89
    v_exp_f32 v90, v90
    v_exp_f32 v91, v91
    v_cvt_pk_bf16_f32 v112, v88, v89
    v_mfma_f32_32x32x8_bf16 v[72:87], v[162:163], v[124:125], v[72:87]
    v_exp_f32 v92, v92
    v_exp_f32 v93, v93
    v_exp_f32 v94, v94
    v_exp_f32 v95, v95
    v_cvt_pk_bf16_f32 v113, v90, v91
    v_cvt_pk_bf16_f32 v114, v92, v93
    v_mfma_f32_32x32x16_bf16 v[40:55], v[150:153], v[104:107], v[40:55]
    v_exp_f32 v96, v96
    v_exp_f32 v97, v97
    v_exp_f32 v98, v98
    v_exp_f32 v99, v99
    v_cvt_pk_bf16_f32 v115, v94, v95
    v_cvt_pk_bf16_f32 v116, v96, v97
    v_mfma_f32_32x32x16_bf16 v[40:55], v[154:157], v[108:111], v[40:55]
    v_exp_f32 v100, v100
    v_exp_f32 v101, v101
    v_exp_f32 v102, v102
    v_exp_f32 v103, v103
    v_cvt_pk_bf16_f32 v117, v98, v99
    v_cvt_pk_bf16_f32 v118, v100, v101
    v_cvt_pk_bf16_f32 v119, v102, v103
    v_mfma_f32_32x32x16_bf16 v[88:103], v[158:161], v[126:129], 0
    ds_read_b128 v[144:147], v180 offset:2560
    v_exp_f32 v72, v72
    v_exp_f32 v73, v73
    v_exp_f32 v74, v74
    v_exp_f32 v75, v75
    v_cvt_pk_bf16_f32 v104, v72, v73
    v_mfma_f32_32x32x8_bf16 v[88:103], v[162:163], v[130:131], v[88:103]
    v_exp_f32 v76, v76
    v_exp_f32 v77, v77
    v_exp_f32 v78, v78
    v_exp_f32 v79, v79
    v_cvt_pk_bf16_f32 v105, v74, v75
    v_cvt_pk_bf16_f32 v106, v76, v77
    v_mfma_f32_32x32x16_bf16 v[56:71], v[150:153], v[112:115], v[56:71]
    ds_read_b64 v[148:149], v182
    v_exp_f32 v80, v80
    v_exp_f32 v81, v81
    v_exp_f32 v82, v82
    v_exp_f32 v83, v83
    v_cvt_pk_bf16_f32 v107, v78, v79
    v_cvt_pk_bf16_f32 v108, v80, v81
    v_mfma_f32_32x32x16_bf16 v[56:71], v[154:157], v[116:119], v[56:71]
    v_exp_f32 v84, v84
    v_exp_f32 v85, v85
    v_exp_f32 v86, v86
    v_exp_f32 v87, v87
    v_cvt_pk_bf16_f32 v109, v82, v83
    v_cvt_pk_bf16_f32 v110, v84, v85
    v_cvt_pk_bf16_f32 v111, v86, v87
    v_mfma_f32_32x32x16_bf16 v[72:87], v[158:161], v[132:135], 0
    ds_read_b128 v[150:153], v184
    v_exp_f32 v88, v88
    v_exp_f32 v89, v89
    v_exp_f32 v90, v90
    v_exp_f32 v91, v91
    v_cvt_pk_bf16_f32 v112, v88, v89
    v_mfma_f32_32x32x8_bf16 v[72:87], v[162:163], v[136:137], v[72:87]
    v_exp_f32 v92, v92
    v_exp_f32 v93, v93
    v_exp_f32 v94, v94
    v_exp_f32 v95, v95
    v_cvt_pk_bf16_f32 v113, v90, v91
    v_cvt_pk_bf16_f32 v114, v92, v93
    v_mfma_f32_32x32x16_bf16 v[8:23], v[164:167], v[104:107], v[8:23]
    ds_read_b128 v[154:157], v184 offset:640
    v_exp_f32 v96, v96
    v_exp_f32 v97, v97
    v_exp_f32 v98, v98
    v_exp_f32 v99, v99
    v_cvt_pk_bf16_f32 v115, v94, v95
    v_cvt_pk_bf16_f32 v116, v96, v97
    v_mfma_f32_32x32x16_bf16 v[8:23], v[168:171], v[108:111], v[8:23]
    v_exp_f32 v100, v100
    v_exp_f32 v101, v101
    v_exp_f32 v102, v102
    v_exp_f32 v103, v103
    v_cvt_pk_bf16_f32 v117, v98, v99
    v_cvt_pk_bf16_f32 v118, v100, v101
    v_cvt_pk_bf16_f32 v119, v102, v103
    v_mfma_f32_32x32x16_bf16 v[88:103], v[158:161], v[138:141], 0
    v_exp_f32 v72, v72
    v_exp_f32 v73, v73
    v_exp_f32 v74, v74
    v_exp_f32 v75, v75
    v_cvt_pk_bf16_f32 v104, v72, v73
    v_mfma_f32_32x32x8_bf16 v[88:103], v[162:163], v[142:143], v[88:103]
    v_exp_f32 v76, v76
    v_exp_f32 v77, v77
    v_exp_f32 v78, v78
    v_exp_f32 v79, v79
    v_cvt_pk_bf16_f32 v105, v74, v75
    v_cvt_pk_bf16_f32 v106, v76, v77
    v_mfma_f32_32x32x16_bf16 v[24:39], v[164:167], v[112:115], v[24:39]
    v_exp_f32 v80, v80
    v_exp_f32 v81, v81
    v_exp_f32 v82, v82
    v_exp_f32 v83, v83
    v_cvt_pk_bf16_f32 v107, v78, v79
    v_cvt_pk_bf16_f32 v108, v80, v81
    v_mfma_f32_32x32x16_bf16 v[24:39], v[168:171], v[116:119], v[24:39]
    s_waitcnt lgkmcnt(0)
    v_exp_f32 v84, v84
    v_exp_f32 v85, v85
    v_add_u32 v182, v182, v185
    v_add_u32 v184, v184, v186
    v_add_u32 v180, 2560, v180
    v_exp_f32 v86, v86
    v_exp_f32 v87, v87
    v_cvt_pk_bf16_f32 v109, v82, v83
    v_cvt_pk_bf16_f32 v110, v84, v85
    v_cvt_pk_bf16_f32 v111, v86, v87
    v_mfma_f32_32x32x16_bf16 v[72:87], v[144:147], v[120:123], 0
    v_exp_f32 v88, v88
    v_exp_f32 v89, v89
    v_exp_f32 v90, v90
    v_exp_f32 v91, v91
    v_cvt_pk_bf16_f32 v112, v88, v89
    v_mfma_f32_32x32x8_bf16 v[72:87], v[148:149], v[124:125], v[72:87]
    v_exp_f32 v92, v92
    v_exp_f32 v93, v93
    v_exp_f32 v94, v94
    v_exp_f32 v95, v95
    v_cvt_pk_bf16_f32 v113, v90, v91
    v_cvt_pk_bf16_f32 v114, v92, v93
    v_mfma_f32_32x32x16_bf16 v[40:55], v[164:167], v[104:107], v[40:55]
    s_add_u32 s26, s26, 1
    v_exp_f32 v96, v96
    v_exp_f32 v97, v97
    v_exp_f32 v98, v98
    v_exp_f32 v99, v99
    v_cvt_pk_bf16_f32 v115, v94, v95
    v_cvt_pk_bf16_f32 v116, v96, v97
    v_mfma_f32_32x32x16_bf16 v[40:55], v[168:171], v[108:111], v[40:55]
    s_cmp_lt_u32 s26, s27
    v_exp_f32 v100, v100
    v_exp_f32 v101, v101
    v_exp_f32 v102, v102
    v_exp_f32 v103, v103
    v_cvt_pk_bf16_f32 v117, v98, v99
    v_cvt_pk_bf16_f32 v118, v100, v101
    v_cvt_pk_bf16_f32 v119, v102, v103
    s_cbranch_scc1 L_loop
    s_cmp_eq_u32 s26, 16
    s_cbranch_scc1 L_loopdone
    s_cmp_eq_u32 s26, 2
    s_cselect_b32 s27, 13, 16
    s_barrier
    s_branch L_loop
L_loopdone:
    v_mfma_f32_32x32x16_bf16 v[56:71], v[164:167], v[112:115], v[56:71]
    v_mfma_f32_32x32x16_bf16 v[56:71], v[168:171], v[116:119], v[56:71]
    v_cndmask_b32 v20, v16, v20, s[40:41]
    v_mov_b32 v21, v172
    v_cndmask_b32 v36, v32, v36, s[40:41]
    v_mov_b32 v37, v173
    ds_write_b128 v226, v[8:11] offset:0
    ds_write_b128 v226, v[12:15] offset:1024
    ds_write_b128 v226, v[16:19] offset:2048
    ds_write_b64 v227, v[20:21] offset:3072
    ds_write_b128 v226, v[24:27] offset:3584
    ds_write_b128 v226, v[28:31] offset:4608
    ds_write_b128 v226, v[32:35] offset:5632
    ds_write_b64 v227, v[36:37] offset:6656
    v_cndmask_b32 v52, v48, v52, s[40:41]
    v_mov_b32 v53, v174
    v_cndmask_b32 v68, v64, v68, s[40:41]
    v_mov_b32 v69, v175
    v_add_f32 v5, v20, v36
    v_add_f32 v6, v52, v68
    v_add_f32 v5, v5, v6
    v_cmp_ngt_f32 vcc, s47, v5
    s_nop 3
    s_cmp_lg_u64 vcc, 0
    s_cbranch_scc1 L_slow
L_merge:
    s_lshr_b32 s36, s10, 1
    s_and_b32 s37, s3, 2
    s_add_u32 s36, s36, s37
    s_add_u32 s37, s36, 2
    s_add_u32 s36, s36, 1
    s_and_b32 s36, s36, 3
    s_and_b32 s37, s37, 3
    s_lshl_b32 s38, s36, 10
    s_lshl_b32 s39, s37, 10
    s_lshl_b32 s36, s36, 12
    s_lshl_b32 s37, s37, 12
    s_waitcnt lgkmcnt(0)
    s_barrier
    ds_read_b64 v[20:21], v229 offset:3072
    ds_read_b128 v[8:11], v228 offset:0
    ds_read_b128 v[12:15], v228 offset:1024
    ds_read_b128 v[16:19], v228 offset:2048
    ds_read_b64 v[36:37], v229 offset:6656
    ds_read_b128 v[24:27], v228 offset:3584
    ds_read_b128 v[28:31], v228 offset:4608
    ds_read_b128 v[32:35], v228 offset:5632
    s_waitcnt lgkmcnt(7)
    v_min_f32 v5, v53, v21
    v_sub_f32 v6, v5, v53
    v_sub_f32 v176, v5, v21
    v_exp_f32 v6, v6
    v_exp_f32 v176, v176
    s_nop 0
    v_mul_f32 v5, v52, v6
    v_fma_f32 v5, v20, v176, v5
    v_rcp_f32 v5, v5
    s_nop 0
    v_mul_f32 v6, v6, v5
    v_mul_f32 v176, v176, v5
    v_mov_b32 v7, v6
    v_mov_b32 v177, v176
    v_pk_mul_f32 v[40:41], v[40:41], v[6:7]
    v_pk_mul_f32 v[42:43], v[42:43], v[6:7]
    v_pk_mul_f32 v[44:45], v[44:45], v[6:7]
    v_pk_mul_f32 v[46:47], v[46:47], v[6:7]
    v_pk_mul_f32 v[48:49], v[48:49], v[6:7]
    v_pk_mul_f32 v[50:51], v[50:51], v[6:7]
    s_waitcnt lgkmcnt(4)
    v_pk_fma_f32 v[40:41], v[8:9], v[176:177], v[40:41]
    v_pk_fma_f32 v[42:43], v[10:11], v[176:177], v[42:43]
    v_pk_fma_f32 v[44:45], v[12:13], v[176:177], v[44:45]
    v_pk_fma_f32 v[46:47], v[14:15], v[176:177], v[46:47]
    v_pk_fma_f32 v[48:49], v[16:17], v[176:177], v[48:49]
    v_pk_fma_f32 v[50:51], v[18:19], v[176:177], v[50:51]
    v_cvt_pk_bf16_f32 v40, v40, v41
    v_cvt_pk_bf16_f32 v41, v42, v43
    v_cvt_pk_bf16_f32 v42, v44, v45
    v_cvt_pk_bf16_f32 v43, v46, v47
    v_cvt_pk_bf16_f32 v44, v48, v49
    v_cvt_pk_bf16_f32 v45, v50, v51
    v_min_u32 v40, -2, v40
    v_min_u32 v41, -2, v41
    v_min_u32 v42, -2, v42
    v_min_u32 v43, -2, v43
    v_min_u32 v44, -2, v44
    v_min_u32 v45, -2, v45
    buffer_store_dwordx4 v[40:43], v224, s[28:31], s32 offen sc1
    s_mov_b64 exec, s[40:41]
    buffer_store_dwordx2 v[44:45], v225, s[28:31], s34 offen sc1
    s_mov_b64 exec, -1
    s_waitcnt lgkmcnt(3)
    v_min_f32 v5, v69, v37
    v_sub_f32 v6, v5, v69
    v_sub_f32 v176, v5, v37
    v_exp_f32 v6, v6
    v_exp_f32 v176, v176
    s_nop 0
    v_mul_f32 v5, v68, v6
    v_fma_f32 v5, v36, v176, v5
    v_rcp_f32 v5, v5
    s_nop 0
    v_mul_f32 v6, v6, v5
    v_mul_f32 v176, v176, v5
    v_mov_b32 v7, v6
    v_mov_b32 v177, v176
    v_pk_mul_f32 v[56:57], v[56:57], v[6:7]
    v_pk_mul_f32 v[58:59], v[58:59], v[6:7]
    v_pk_mul_f32 v[60:61], v[60:61], v[6:7]
    v_pk_mul_f32 v[62:63], v[62:63], v[6:7]
    v_pk_mul_f32 v[64:65], v[64:65], v[6:7]
    v_pk_mul_f32 v[66:67], v[66:67], v[6:7]
    s_waitcnt lgkmcnt(0)
    v_pk_fma_f32 v[56:57], v[24:25], v[176:177], v[56:57]
    v_pk_fma_f32 v[58:59], v[26:27], v[176:177], v[58:59]
    v_pk_fma_f32 v[60:61], v[28:29], v[176:177], v[60:61]
    v_pk_fma_f32 v[62:63], v[30:31], v[176:177], v[62:63]
    v_pk_fma_f32 v[64:65], v[32:33], v[176:177], v[64:65]
    v_pk_fma_f32 v[66:67], v[34:35], v[176:177], v[66:67]
    v_cvt_pk_bf16_f32 v56, v56, v57
    v_cvt_pk_bf16_f32 v57, v58, v59
    v_cvt_pk_bf16_f32 v58, v60, v61
    v_cvt_pk_bf16_f32 v59, v62, v63
    v_cvt_pk_bf16_f32 v60, v64, v65
    v_cvt_pk_bf16_f32 v61, v66, v67
    v_min_u32 v56, -2, v56
    v_min_u32 v57, -2, v57
    v_min_u32 v58, -2, v58
    v_min_u32 v59, -2, v59
    v_min_u32 v60, -2, v60
    v_min_u32 v61, -2, v61
    buffer_store_dwordx4 v[56:59], v224, s[28:31], s33 offen sc1
    s_mov_b64 exec, s[40:41]
    buffer_store_dwordx2 v[60:61], v225, s[28:31], s35 offen sc1
    s_mov_b64 exec, -1
    s_nop 1
    v_lshlrev_b32 v8, 16, v240
    v_and_b32 v9, 0xffff0000, v240
    v_lshlrev_b32 v10, 16, v241
    v_and_b32 v11, 0xffff0000, v241
    v_lshlrev_b32 v12, 16, v242
    v_and_b32 v13, 0xffff0000, v242
    v_lshlrev_b32 v14, 16, v243
    v_and_b32 v15, 0xffff0000, v243
    v_lshlrev_b32 v16, 16, v244
    v_and_b32 v17, 0xffff0000, v244
    v_lshlrev_b32 v18, 16, v245
    v_and_b32 v19, 0xffff0000, v245
    v_lshlrev_b32 v20, 16, v246
    v_and_b32 v21, 0xffff0000, v246
    v_lshlrev_b32 v22, 16, v247
    v_and_b32 v23, 0xffff0000, v247
    v_lshlrev_b32 v24, 16, v248
    v_and_b32 v25, 0xffff0000, v248
    v_lshlrev_b32 v26, 16, v249
    v_and_b32 v27, 0xffff0000, v249
    s_add_u32 s24, s8, 19578880
    s_addc_u32 s25, s9, 0
    s_mov_b32 s26, 393216
    s_mov_b32 s27, 0x00020000
    v_lshrrev_b32 v1, 4, v0
    v_lshrrev_b32 v2, 1, v1
    v_xor_b32 v3, v1, v2
    v_lshlrev_b32 v3, 4, v3
    s_mul_i32 s32, s2, 768
    s_and_b32 s33, s3, 1
    s_mul_i32 s33, s33, 192
    s_add_u32 s32, s32, s33
    s_add_u32 s32, s32, 196608
    buffer_load_dwordx4 v[204:207], v3, s[24:27], s32 offen offset:0
    buffer_load_dwordx4 v[208:211], v3, s[24:27], s32 offen offset:64
    buffer_load_dwordx4 v[212:215], v3, s[24:27], s32 offen offset:128
    buffer_load_dwordx4 v[216:219], v3, s[24:27], s32 offen offset:384
    buffer_load_dwordx4 v[220:223], v3, s[24:27], s32 offen offset:448
    buffer_load_dwordx4 v[224:227], v3, s[24:27], s32 offen offset:512
    s_waitcnt vmcnt(0)
    buffer_load_dwordx4 v[108:111], v230, s[28:31], s36 offen offset:0 sc1
    buffer_load_dwordx4 v[112:115], v231, s[28:31], s36 offen offset:0 sc1
    buffer_load_dwordx4 v[116:119], v230, s[28:31], s36 offen offset:1024 sc1
    buffer_load_dwordx4 v[120:123], v231, s[28:31], s36 offen offset:1024 sc1
    buffer_load_dwordx4 v[124:127], v230, s[28:31], s36 offen offset:2048 sc1
    buffer_load_dwordx4 v[128:131], v231, s[28:31], s36 offen offset:2048 sc1
    buffer_load_dwordx4 v[132:135], v230, s[28:31], s36 offen offset:3072 sc1
    buffer_load_dwordx4 v[136:139], v231, s[28:31], s36 offen offset:3072 sc1
L_wl1:
    buffer_load_dwordx4 v[140:143], v230, s[28:31], s37 offen offset:0 sc1
    buffer_load_dwordx4 v[144:147], v231, s[28:31], s37 offen offset:0 sc1
    buffer_load_dwordx4 v[148:151], v230, s[28:31], s37 offen offset:1024 sc1
    buffer_load_dwordx4 v[152:155], v231, s[28:31], s37 offen offset:1024 sc1
L_wl2:
    s_mov_b32 s46, 0
    ds_read_b64_tr_b16 v[48:49], v236 offset:0
    ds_read_b64_tr_b16 v[50:51], v236 offset:640
    ds_read_b64_tr_b16 v[52:53], v236 offset:32
    ds_read_b64_tr_b16 v[54:55], v236 offset:672
    ds_read_b64_tr_b16 v[56:57], v236 offset:64
    ds_read_b64_tr_b16 v[58:59], v236 offset:704
    ds_read_b64_tr_b16 v[60:61], v236 offset:96
    ds_read_b64_tr_b16 v[62:63], v236 offset:736
    ds_read_b64_tr_b16 v[64:65], v236 offset:128
    ds_read_b64_tr_b16 v[66:67], v236 offset:768
    ds_read_b64_tr_b16 v[68:69], v236 offset:6400
    ds_read_b64_tr_b16 v[70:71], v236 offset:7040
    ds_read_b64_tr_b16 v[72:73], v236 offset:6432
    ds_read_b64_tr_b16 v[74:75], v236 offset:7072
    ds_read_b64_tr_b16 v[76:77], v236 offset:6464
    ds_read_b64_tr_b16 v[78:79], v236 offset:7104
    ds_read_b64_tr_b16 v[80:81], v236 offset:6496
    ds_read_b64_tr_b16 v[82:83], v236 offset:7136
    ds_read_b64_tr_b16 v[84:85], v236 offset:6528
    ds_read_b64_tr_b16 v[86:87], v236 offset:7168
    s_waitcnt vmcnt(10)
    v_max3_u32 v198, v108, v109, v110
    v_max3_u32 v199, v111, v112, v113
    v_max3_u32 v198, v198, v114, v115
    v_max_u32 v198, v198, v199
    v_cmp_eq_u32 vcc, -1, v198
    s_nop 1
    s_cmp_lg_u64 vcc, 0
    s_cbranch_scc1 L_rtw0
L_okw0:
    s_waitcnt vmcnt(8) lgkmcnt(10)
    v_mfma_f32_16x16x32_bf16 v[8:11], v[48:51], v[108:111], v[8:11]
    ds_read_b64_tr_b16 v[88:89], v236 offset:12800
    ds_read_b64_tr_b16 v[90:91], v236 offset:13440
    v_mfma_f32_16x16x32_bf16 v[28:31], v[48:51], v[112:115], 0
    ds_read_b64_tr_b16 v[92:93], v236 offset:12832
    v_max3_u32 v198, v116, v117, v118
    v_mfma_f32_16x16x32_bf16 v[12:15], v[52:55], v[108:111], v[12:15]
    ds_read_b64_tr_b16 v[94:95], v236 offset:13472
    ds_read_b64_tr_b16 v[96:97], v236 offset:12864
    v_mfma_f32_16x16x32_bf16 v[32:35], v[52:55], v[112:115], 0
    ds_read_b64_tr_b16 v[98:99], v236 offset:13504
    v_max3_u32 v199, v119, v120, v121
    v_mfma_f32_16x16x32_bf16 v[16:19], v[56:59], v[108:111], v[16:19]
    buffer_load_dwordx4 v[156:159], v230, s[28:31], s37 offen offset:2048 sc1
    v_mfma_f32_16x16x32_bf16 v[36:39], v[56:59], v[112:115], 0
    ds_read_b64_tr_b16 v[100:101], v236 offset:12896
    ds_read_b64_tr_b16 v[102:103], v236 offset:13536
    v_mfma_f32_16x16x32_bf16 v[20:23], v[60:63], v[108:111], v[20:23]
    ds_read_b64_tr_b16 v[104:105], v236 offset:12928
    v_max3_u32 v198, v198, v122, v123
    v_mfma_f32_16x16x32_bf16 v[40:43], v[60:63], v[112:115], 0
    ds_read_b64_tr_b16 v[106:107], v236 offset:13568
    v_max_u32 v198, v198, v199
    v_mfma_f32_16x16x32_bf16 v[24:27], v[64:67], v[108:111], v[24:27]
    buffer_load_dwordx4 v[160:163], v231, s[28:31], s37 offen offset:2048 sc1
    v_mfma_f32_16x16x32_bf16 v[44:47], v[64:67], v[112:115], 0
    v_cmp_eq_u32 vcc, -1, v198
    s_nop 1
    s_cmp_lg_u64 vcc, 0
    s_cbranch_scc1 L_rtw1
L_okw1:
    s_waitcnt vmcnt(8) lgkmcnt(10)
    v_mfma_f32_16x16x32_bf16 v[8:11], v[68:71], v[116:119], v[8:11]
    ds_read_b64_tr_b16 v[48:49], v236 offset:19200
    ds_read_b64_tr_b16 v[50:51], v236 offset:19840
    v_mfma_f32_16x16x32_bf16 v[28:31], v[68:71], v[120:123], v[28:31]
    ds_read_b64_tr_b16 v[52:53], v236 offset:19232
    v_max3_u32 v198, v124, v125, v126
    v_mfma_f32_16x16x32_bf16 v[12:15], v[72:75], v[116:119], v[12:15]
    ds_read_b64_tr_b16 v[54:55], v236 offset:19872
    ds_read_b64_tr_b16 v[56:57], v236 offset:19264
    v_mfma_f32_16x16x32_bf16 v[32:35], v[72:75], v[120:123], v[32:35]
    ds_read_b64_tr_b16 v[58:59], v236 offset:19904
    v_max3_u32 v199, v127, v128, v129
    v_mfma_f32_16x16x32_bf16 v[16:19], v[76:79], v[116:119], v[16:19]
    buffer_load_dwordx4 v[164:167], v230, s[28:31], s37 offen offset:3072 sc1
    v_mfma_f32_16x16x32_bf16 v[36:39], v[76:79], v[120:123], v[36:39]
    ds_read_b64_tr_b16 v[60:61], v236 offset:19296
    ds_read_b64_tr_b16 v[62:63], v236 offset:19936
    v_mfma_f32_16x16x32_bf16 v[20:23], v[80:83], v[116:119], v[20:23]
    ds_read_b64_tr_b16 v[64:65], v236 offset:19328
    v_max3_u32 v198, v198, v130, v131
    v_mfma_f32_16x16x32_bf16 v[40:43], v[80:83], v[120:123], v[40:43]
    ds_read_b64_tr_b16 v[66:67], v236 offset:19968
    v_max_u32 v198, v198, v199
    v_mfma_f32_16x16x32_bf16 v[24:27], v[84:87], v[116:119], v[24:27]
    buffer_load_dwordx4 v[168:171], v231, s[28:31], s37 offen offset:3072 sc1
    v_mfma_f32_16x16x32_bf16 v[44:47], v[84:87], v[120:123], v[44:47]
    v_cmp_eq_u32 vcc, -1, v198
    s_nop 1
    s_cmp_lg_u64 vcc, 0
    s_cbranch_scc1 L_rtw2
L_okw2:
    s_waitcnt vmcnt(8) lgkmcnt(10)
    v_mfma_f32_16x16x32_bf16 v[8:11], v[88:91], v[124:127], v[8:11]
    ds_read_b64_tr_b16 v[68:69], v236 offset:40960
    ds_read_b64_tr_b16 v[70:71], v236 offset:41600
    v_mfma_f32_16x16x32_bf16 v[28:31], v[88:91], v[128:131], v[28:31]
    ds_read_b64_tr_b16 v[72:73], v236 offset:40992
    v_max3_u32 v198, v132, v133, v134
    v_mfma_f32_16x16x32_bf16 v[12:15], v[92:95], v[124:127], v[12:15]
    ds_read_b64_tr_b16 v[74:75], v236 offset:41632
    ds_read_b64_tr_b16 v[76:77], v236 offset:41024
    v_mfma_f32_16x16x32_bf16 v[32:35], v[92:95], v[128:131], v[32:35]
    ds_read_b64_tr_b16 v[78:79], v236 offset:41664
    v_max3_u32 v199, v135, v136, v137
    v_mfma_f32_16x16x32_bf16 v[16:19], v[96:99], v[124:127], v[16:19]
    buffer_load_dwordx2 v[108:109], v232, s[28:31], s38 offen offset:0 sc1
    v_mfma_f32_16x16x32_bf16 v[36:39], v[96:99], v[128:131], v[36:39]
    ds_read_b64_tr_b16 v[80:81], v236 offset:41056
    ds_read_b64_tr_b16 v[82:83], v236 offset:41696
    v_mfma_f32_16x16x32_bf16 v[20:23], v[100:103], v[124:127], v[20:23]
    ds_read_b64_tr_b16 v[84:85], v236 offset:41088
    v_max3_u32 v198, v198, v138, v139
    v_mfma_f32_16x16x32_bf16 v[40:43], v[100:103], v[128:131], v[40:43]
    ds_read_b64_tr_b16 v[86:87], v236 offset:41728
    v_max_u32 v198, v198, v199
    v_mfma_f32_16x16x32_bf16 v[24:27], v[104:107], v[124:127], v[24:27]
    buffer_load_dwordx2 v[110:111], v232, s[28:31], s38 offen offset:256 sc1
    v_mfma_f32_16x16x32_bf16 v[44:47], v[104:107], v[128:131], v[44:47]
    buffer_load_dwordx2 v[112:113], v233, s[28:31], s38 offen offset:0 sc1
    buffer_load_dwordx2 v[114:115], v233, s[28:31], s38 offen offset:256 sc1
    v_cmp_eq_u32 vcc, -1, v198
    s_nop 1
    s_cmp_lg_u64 vcc, 0
    s_cbranch_scc1 L_rtw3
L_okw3:
    s_waitcnt vmcnt(10) lgkmcnt(10)
    v_mfma_f32_16x16x32_bf16 v[8:11], v[48:51], v[132:135], v[8:11]
    ds_read_b64_tr_b16 v[88:89], v236 offset:47360
    ds_read_b64_tr_b16 v[90:91], v236 offset:48000
    v_mfma_f32_16x16x32_bf16 v[28:31], v[48:51], v[136:139], v[28:31]
    ds_read_b64_tr_b16 v[92:93], v236 offset:47392
    v_max3_u32 v198, v140, v141, v142
    v_mfma_f32_16x16x32_bf16 v[12:15], v[52:55], v[132:135], v[12:15]
    ds_read_b64_tr_b16 v[94:95], v236 offset:48032
    ds_read_b64_tr_b16 v[96:97], v236 offset:47424
    v_mfma_f32_16x16x32_bf16 v[32:35], v[52:55], v[136:139], v[32:35]
    ds_read_b64_tr_b16 v[98:99], v236 offset:48064
    v_max3_u32 v199, v143, v144, v145
    v_mfma_f32_16x16x32_bf16 v[16:19], v[56:59], v[132:135], v[16:19]
    buffer_load_dwordx2 v[116:117], v232, s[28:31], s39 offen offset:0 sc1
    v_mfma_f32_16x16x32_bf16 v[36:39], v[56:59], v[136:139], v[36:39]
    ds_read_b64_tr_b16 v[100:101], v236 offset:47456
    ds_read_b64_tr_b16 v[102:103], v236 offset:48096
    v_mfma_f32_16x16x32_bf16 v[20:23], v[60:63], v[132:135], v[20:23]
    ds_read_b64_tr_b16 v[104:105], v236 offset:47488
    v_max3_u32 v198, v198, v146, v147
    v_mfma_f32_16x16x32_bf16 v[40:43], v[60:63], v[136:139], v[40:43]
    ds_read_b64_tr_b16 v[106:107], v236 offset:48128
    v_max_u32 v198, v198, v199
    v_mfma_f32_16x16x32_bf16 v[24:27], v[64:67], v[132:135], v[24:27]
    buffer_load_dwordx2 v[118:119], v232, s[28:31], s39 offen offset:256 sc1
    v_mfma_f32_16x16x32_bf16 v[44:47], v[64:67], v[136:139], v[44:47]
    buffer_load_dwordx2 v[120:121], v233, s[28:31], s39 offen offset:0 sc1
    buffer_load_dwordx2 v[122:123], v233, s[28:31], s39 offen offset:256 sc1
    v_cmp_eq_u32 vcc, -1, v198
    s_nop 1
    s_cmp_lg_u64 vcc, 0
    s_cbranch_scc1 L_rtw4
L_okw4:
    s_waitcnt vmcnt(12) lgkmcnt(10)
    v_mfma_f32_16x16x32_bf16 v[8:11], v[68:71], v[140:143], v[8:11]
    ds_read_b64_tr_b16 v[48:49], v236 offset:53760
    ds_read_b64_tr_b16 v[50:51], v236 offset:54400
    v_mfma_f32_16x16x32_bf16 v[28:31], v[68:71], v[144:147], v[28:31]
    ds_read_b64_tr_b16 v[52:53], v236 offset:53792
    v_max3_u32 v198, v148, v149, v150
    v_mfma_f32_16x16x32_bf16 v[12:15], v[72:75], v[140:143], v[12:15]
    ds_read_b64_tr_b16 v[54:55], v236 offset:54432
    ds_read_b64_tr_b16 v[56:57], v236 offset:53824
    v_mfma_f32_16x16x32_bf16 v[32:35], v[72:75], v[144:147], v[32:35]
    ds_read_b64_tr_b16 v[58:59], v236 offset:54464
    v_max3_u32 v199, v151, v152, v153
    v_mfma_f32_16x16x32_bf16 v[16:19], v[76:79], v[140:143], v[16:19]
    v_mfma_f32_16x16x32_bf16 v[36:39], v[76:79], v[144:147], v[36:39]
    ds_read_b64_tr_b16 v[60:61], v236 offset:53856
    ds_read_b64_tr_b16 v[62:63], v236 offset:54496
    v_mfma_f32_16x16x32_bf16 v[20:23], v[80:83], v[140:143], v[20:23]
    ds_read_b64_tr_b16 v[64:65], v236 offset:53888
    v_max3_u32 v198, v198, v154, v155
    v_mfma_f32_16x16x32_bf16 v[40:43], v[80:83], v[144:147], v[40:43]
    ds_read_b64_tr_b16 v[66:67], v236 offset:54528
    v_max_u32 v198, v198, v199
    v_mfma_f32_16x16x32_bf16 v[24:27], v[84:87], v[140:143], v[24:27]
    v_mfma_f32_16x16x32_bf16 v[44:47], v[84:87], v[144:147], v[44:47]
    v_cmp_eq_u32 vcc, -1, v198
    s_nop 1
    s_cmp_lg_u64 vcc, 0
    s_cbranch_scc1 L_rtw5
L_okw5:
    s_waitcnt vmcnt(10) lgkmcnt(10)
    v_mfma_f32_16x16x32_bf16 v[8:11], v[88:91], v[148:151], v[8:11]
    ds_read_b64_tr_b16 v[68:69], v236 offset:60160
    ds_read_b64_tr_b16 v[70:71], v236 offset:60800
    v_mfma_f32_16x16x32_bf16 v[28:31], v[88:91], v[152:155], v[28:31]
    ds_read_b64_tr_b16 v[72:73], v236 offset:60192
    v_max3_u32 v198, v156, v157, v158
    v_mfma_f32_16x16x32_bf16 v[12:15], v[92:95], v[148:151], v[12:15]
    ds_read_b64_tr_b16 v[74:75], v236 offset:60832
    ds_read_b64_tr_b16 v[76:77], v236 offset:60224
    v_mfma_f32_16x16x32_bf16 v[32:35], v[92:95], v[152:155], v[32:35]
    ds_read_b64_tr_b16 v[78:79], v236 offset:60864
    v_max3_u32 v199, v159, v160, v161
    v_mfma_f32_16x16x32_bf16 v[16:19], v[96:99], v[148:151], v[16:19]
    v_mfma_f32_16x16x32_bf16 v[36:39], v[96:99], v[152:155], v[36:39]
    ds_read_b64_tr_b16 v[80:81], v236 offset:60256
    ds_read_b64_tr_b16 v[82:83], v236 offset:60896
    v_mfma_f32_16x16x32_bf16 v[20:23], v[100:103], v[148:151], v[20:23]
    ds_read_b64_tr_b16 v[84:85], v236 offset:60288
    v_max3_u32 v198, v198, v162, v163
    v_mfma_f32_16x16x32_bf16 v[40:43], v[100:103], v[152:155], v[40:43]
    ds_read_b64_tr_b16 v[86:87], v236 offset:60928
    v_max_u32 v198, v198, v199
    v_mfma_f32_16x16x32_bf16 v[24:27], v[104:107], v[148:151], v[24:27]
    v_mfma_f32_16x16x32_bf16 v[44:47], v[104:107], v[152:155], v[44:47]
    v_cmp_eq_u32 vcc, -1, v198
    s_nop 1
    s_cmp_lg_u64 vcc, 0
    s_cbranch_scc1 L_rtw6
L_okw6:
    s_waitcnt vmcnt(8) lgkmcnt(10)
    v_mfma_f32_16x16x32_bf16 v[8:11], v[48:51], v[156:159], v[8:11]
    ds_read_b64_tr_b16 v[88:89], v237 offset:0
    ds_read_b64_tr_b16 v[90:91], v237 offset:6400
    v_mfma_f32_16x16x32_bf16 v[28:31], v[48:51], v[160:163], v[28:31]
    ds_read_b64_tr_b16 v[92:93], v237 offset:32
    v_max3_u32 v198, v164, v165, v166
    v_mfma_f32_16x16x32_bf16 v[12:15], v[52:55], v[156:159], v[12:15]
    ds_read_b64_tr_b16 v[94:95], v237 offset:6432
    ds_read_b64_tr_b16 v[96:97], v237 offset:64
    v_mfma_f32_16x16x32_bf16 v[32:35], v[52:55], v[160:163], v[32:35]
    ds_read_b64_tr_b16 v[98:99], v237 offset:6464
    v_max3_u32 v199, v167, v168, v169
    v_mfma_f32_16x16x32_bf16 v[16:19], v[56:59], v[156:159], v[16:19]
    v_mfma_f32_16x16x32_bf16 v[36:39], v[56:59], v[160:163], v[36:39]
    ds_read_b64_tr_b16 v[100:101], v237 offset:96
    ds_read_b64_tr_b16 v[102:103], v237 offset:6496
    v_mfma_f32_16x16x32_bf16 v[20:23], v[60:63], v[156:159], v[20:23]
    ds_read_b64_tr_b16 v[104:105], v237 offset:128
    v_max3_u32 v198, v198, v170, v171
    v_mfma_f32_16x16x32_bf16 v[40:43], v[60:63], v[160:163], v[40:43]
    ds_read_b64_tr_b16 v[106:107], v237 offset:6528
    v_max_u32 v198, v198, v199
    v_mfma_f32_16x16x32_bf16 v[24:27], v[64:67], v[156:159], v[24:27]
    v_mfma_f32_16x16x32_bf16 v[44:47], v[64:67], v[160:163], v[44:47]
    v_cmp_eq_u32 vcc, -1, v198
    s_nop 1
    s_cmp_lg_u64 vcc, 0
    s_cbranch_scc1 L_rtw7
L_okw7:
    s_waitcnt vmcnt(4) lgkmcnt(10)
    v_mfma_f32_16x16x32_bf16 v[8:11], v[68:71], v[164:167], v[8:11]
    ds_read_b64_tr_b16 v[48:49], v237 offset:40960
    ds_read_b64_tr_b16 v[50:51], v237 offset:47360
    v_mfma_f32_16x16x32_bf16 v[28:31], v[68:71], v[168:171], v[28:31]
    ds_read_b64_tr_b16 v[52:53], v237 offset:40992
    v_max3_u32 v198, v108, v109, v110
    v_mfma_f32_16x16x32_bf16 v[12:15], v[72:75], v[164:167], v[12:15]
    ds_read_b64_tr_b16 v[54:55], v237 offset:47392
    ds_read_b64_tr_b16 v[56:57], v237 offset:41024
    v_mfma_f32_16x16x32_bf16 v[32:35], v[72:75], v[168:171], v[32:35]
    ds_read_b64_tr_b16 v[58:59], v237 offset:47424
    v_max3_u32 v199, v111, v112, v113
    v_mfma_f32_16x16x32_bf16 v[16:19], v[76:79], v[164:167], v[16:19]
    v_mfma_f32_16x16x32_bf16 v[36:39], v[76:79], v[168:171], v[36:39]
    ds_read_b64_tr_b16 v[60:61], v237 offset:41056
    ds_read_b64_tr_b16 v[62:63], v237 offset:47456
    v_mfma_f32_16x16x32_bf16 v[20:23], v[80:83], v[164:167], v[20:23]
    ds_read_b64_tr_b16 v[64:65], v237 offset:41088
    v_max3_u32 v198, v198, v114, v115
    v_mfma_f32_16x16x32_bf16 v[40:43], v[80:83], v[168:171], v[40:43]
    ds_read_b64_tr_b16 v[66:67], v237 offset:47488
    v_max_u32 v198, v198, v199
    v_mfma_f32_16x16x32_bf16 v[24:27], v[84:87], v[164:167], v[24:27]
    v_mfma_f32_16x16x32_bf16 v[44:47], v[84:87], v[168:171], v[44:47]
    v_cmp_eq_u32 vcc, -1, v198
    s_nop 1
    s_cmp_lg_u64 vcc, 0
    s_cbranch_scc1 L_rtw8
L_okw8:
    s_waitcnt vmcnt(0) lgkmcnt(10)
    v_mfma_f32_16x16x32_bf16 v[8:11], v[88:91], v[108:111], v[8:11]
    v_mfma_f32_16x16x32_bf16 v[28:31], v[88:91], v[112:115], v[28:31]
    v_max3_u32 v198, v116, v117, v118
    v_mfma_f32_16x16x32_bf16 v[12:15], v[92:95], v[108:111], v[12:15]
    v_mfma_f32_16x16x32_bf16 v[32:35], v[92:95], v[112:115], v[32:35]
    v_max3_u32 v199, v119, v120, v121
    v_mfma_f32_16x16x32_bf16 v[16:19], v[96:99], v[108:111], v[16:19]
    v_mfma_f32_16x16x32_bf16 v[36:39], v[96:99], v[112:115], v[36:39]
    v_mfma_f32_16x16x32_bf16 v[20:23], v[100:103], v[108:111], v[20:23]
    v_max3_u32 v198, v198, v122, v123
    v_mfma_f32_16x16x32_bf16 v[40:43], v[100:103], v[112:115], v[40:43]
    v_max_u32 v198, v198, v199
    v_mfma_f32_16x16x32_bf16 v[24:27], v[104:107], v[108:111], v[24:27]
    v_mfma_f32_16x16x32_bf16 v[44:47], v[104:107], v[112:115], v[44:47]
    v_cmp_eq_u32 vcc, -1, v198
    s_nop 1
    s_cmp_lg_u64 vcc, 0
    s_cbranch_scc1 L_rtw9
L_okw9:
    s_waitcnt vmcnt(0) lgkmcnt(0)
    v_mfma_f32_16x16x32_bf16 v[28:31], v[48:51], v[120:123], v[28:31]
    v_mfma_f32_16x16x32_bf16 v[32:35], v[52:55], v[120:123], v[32:35]
    v_mfma_f32_16x16x32_bf16 v[36:39], v[56:59], v[120:123], v[36:39]
    v_mfma_f32_16x16x32_bf16 v[40:43], v[60:63], v[120:123], v[40:43]
    v_mfma_f32_16x16x32_bf16 v[44:47], v[64:67], v[120:123], v[44:47]
    v_mfma_f32_16x16x32_bf16 v[8:11], v[48:51], v[116:119], v[8:11]
    v_mfma_f32_16x16x32_bf16 v[12:15], v[52:55], v[116:119], v[12:15]
    v_mfma_f32_16x16x32_bf16 v[16:19], v[56:59], v[116:119], v[16:19]
    v_mfma_f32_16x16x32_bf16 v[20:23], v[60:63], v[116:119], v[20:23]
    v_mfma_f32_16x16x32_bf16 v[24:27], v[64:67], v[116:119], v[24:27]
    ds_write_b128 v238, v[28:31] offset:0
    ds_write_b128 v238, v[32:35] offset:1024
    ds_write_b128 v238, v[36:39] offset:2048
    ds_write_b128 v238, v[40:43] offset:3072
    ds_write_b128 v238, v[44:47] offset:4096
    s_waitcnt lgkmcnt(0)
    s_barrier
    ds_read_b128 v[28:31], v239 offset:0
    ds_read_b128 v[32:35], v239 offset:1024
    ds_read_b128 v[36:39], v239 offset:2048
    ds_read_b128 v[40:43], v239 offset:3072
    ds_read_b128 v[44:47], v239 offset:4096
    s_waitcnt lgkmcnt(4)
    v_add_f32 v8, v8, v28
    v_add_f32 v9, v9, v29
    v_add_f32 v10, v10, v30
    v_add_f32 v11, v11, v31
    v_cvt_pk_bf16_f32 v240, v8, v9
    v_cvt_pk_bf16_f32 v241, v10, v11
    v_min_u32 v240, -2, v240
    v_min_u32 v241, -2, v241
    buffer_store_dwordx2 v[240:241], v234, s[28:31], 0 offen offset:0 sc1
    s_waitcnt lgkmcnt(3)
    v_add_f32 v12, v12, v32
    v_add_f32 v13, v13, v33
    v_add_f32 v14, v14, v34
    v_add_f32 v15, v15, v35
    v_cvt_pk_bf16_f32 v242, v12, v13
    v_cvt_pk_bf16_f32 v243, v14, v15
    v_min_u32 v242, -2, v242
    v_min_u32 v243, -2, v243
    buffer_store_dwordx2 v[242:243], v234, s[28:31], 0 offen offset:512 sc1
    s_waitcnt lgkmcnt(2)
    v_add_f32 v16, v16, v36
    v_add_f32 v17, v17, v37
    v_add_f32 v18, v18, v38
    v_add_f32 v19, v19, v39
    v_cvt_pk_bf16_f32 v244, v16, v17
    v_cvt_pk_bf16_f32 v245, v18, v19
    v_min_u32 v244, -2, v244
    v_min_u32 v245, -2, v245
    buffer_store_dwordx2 v[244:245], v234, s[28:31], 0 offen offset:1024 sc1
    s_waitcnt lgkmcnt(1)
    v_add_f32 v20, v20, v40
    v_add_f32 v21, v21, v41
    v_add_f32 v22, v22, v42
    v_add_f32 v23, v23, v43
    v_cvt_pk_bf16_f32 v246, v20, v21
    v_cvt_pk_bf16_f32 v247, v22, v23
    v_min_u32 v246, -2, v246
    v_min_u32 v247, -2, v247
    buffer_store_dwordx2 v[246:247], v234, s[28:31], 0 offen offset:1536 sc1
    s_waitcnt lgkmcnt(0)
    v_add_f32 v24, v24, v44
    v_add_f32 v25, v25, v45
    v_add_f32 v26, v26, v46
    v_add_f32 v27, v27, v47
    v_cvt_pk_bf16_f32 v248, v24, v25
    v_cvt_pk_bf16_f32 v249, v26, v27
    v_min_u32 v248, -2, v248
    v_min_u32 v249, -2, v249
    buffer_store_dwordx2 v[248:249], v234, s[28:31], 0 offen offset:2048 sc1
    s_barrier
    v_mov_b32 v48, 0
    v_mov_b32 v49, 0
    v_mov_b32 v50, 0x3f803f80
    v_dot2c_f32_bf16 v48, v240, v50
    v_dot2c_f32_bf16 v49, v240, v240
    v_dot2c_f32_bf16 v48, v241, v50
    v_dot2c_f32_bf16 v49, v241, v241
    v_dot2c_f32_bf16 v48, v242, v50
    v_dot2c_f32_bf16 v49, v242, v242
    v_dot2c_f32_bf16 v48, v243, v50
    v_dot2c_f32_bf16 v49, v243, v243
    v_dot2c_f32_bf16 v48, v244, v50
    v_dot2c_f32_bf16 v49, v244, v244
    v_dot2c_f32_bf16 v48, v245, v50
    v_dot2c_f32_bf16 v49, v245, v245
    v_dot2c_f32_bf16 v48, v246, v50
    v_dot2c_f32_bf16 v49, v246, v246
    v_dot2c_f32_bf16 v48, v247, v50
    v_dot2c_f32_bf16 v49, v247, v247
    v_dot2c_f32_bf16 v48, v248, v50
    v_dot2c_f32_bf16 v49, v248, v248
    v_dot2c_f32_bf16 v48, v249, v50
    v_dot2c_f32_bf16 v49, v249, v249
    s_nop 2
    v_mov_b32 v5, v48
    v_mov_b32 v6, v49
    s_nop 1
    v_permlane32_swap_b32 v48, v5
    v_permlane32_swap_b32 v49, v6
    s_nop 1
    v_add_f32 v48, v48, v5
    v_add_f32 v49, v49, v6
    v_mov_b32 v5, v48
    v_mov_b32 v6, v49
    s_nop 1
    v_permlane16_swap_b32 v48, v5
    v_permlane16_swap_b32 v49, v6
    s_nop 1
    v_add_f32 v48, v48, v5
    v_add_f32 v49, v49, v6
    v_min_u32 v48, -2, v48
    v_min_u32 v49, -2, v49
    s_mov_b64 exec, 0xffff
    buffer_store_dwordx2 v[48:49], v235, s[28:31], 0 offen sc1
    s_mov_b64 exec, -1
    s_nop 1
    s_lshr_b32 s12, s10, 2
    s_lshl_b32 s12, s12, 3
    s_and_b32 s13, s11, 7
    s_add_u32 s12, s12, s13
    s_and_b32 s13, s10, 3
    s_lshl_b32 s13, s13, 2
    s_lshr_b32 s14, s11, 3
    s_add_u32 s13, s13, s14
    s_lshr_b32 s15, s3, 1
    s_and_b32 s14, s3, 1
    v_lshrrev_b32 v1, 4, v0
    v_lshrrev_b32 v2, 1, v1
    v_lshlrev_b32 v3, 4, v0
    s_lshl_b32 s32, s15, 13
    v_add_u32 v200, s32, v3
    v_bfe_u32 v3, v0, 1, 1
    v_xor_b32 v3, v0, v3
    v_lshlrev_b32 v3, 3, v3
    s_mul_i32 s32, s14, 3072
    s_add_u32 s32, s32, 49152
    v_add_u32 v201, s32, v3
    v_and_b32 v3, 15, v0
    s_lshl_b32 s33, s15, 9
    s_add_u32 s33, s33, 16384
    v_lshlrev_b32 v5, 3, v3
    v_add_u32 v228, s33, v5
    v_and_b32 v6, 1, v1
    v_lshlrev_b32 v1, 8, v2
    v_lshl_add_u32 v1, v3, 4, v1
    s_lshl_b32 s32, s12, 3
    s_lshl_b32 s33, s15, 2
    s_add_u32 s32, s32, s33
    s_mul_i32 s32, s32, 49152
    s_mul_i32 s33, s13, 3072
    s_add_u32 s32, s32, s33
    s_mul_i32 s33, s14, 1536
    s_add_u32 s32, s32, s33
    s_add_u32 s32, s32, 5242880
    v_add_u32 v1, s32, v1
    v_lshl_add_u32 v202, v6, 9, v1
    v_lshl_add_u32 v203, v6, 3, v1
    s_mov_b32 s36, 0
    s_mov_b32 s37, 0
    s_mov_b32 s41, 0
    s_mov_b32 s42, 16384
    s_mov_b32 s43, 24576
    s_mov_b32 s38, 16384
    v_mov_b32 v8, 0
    v_mov_b32 v9, 0
    v_mov_b32 v10, 0
    v_mov_b32 v11, 0
    v_mov_b32 v12, 0
    v_mov_b32 v13, 0
    v_mov_b32 v14, 0
    v_mov_b32 v15, 0
    v_mov_b32 v16, 0
    v_mov_b32 v17, 0
    v_mov_b32 v18, 0
    v_mov_b32 v19, 0
    v_mov_b32 v20, 0
    v_mov_b32 v21, 0
    v_mov_b32 v22, 0
    v_mov_b32 v23, 0
    v_mov_b32 v24, 0
    v_mov_b32 v25, 0
    v_mov_b32 v26, 0
    v_mov_b32 v27, 0
    v_mov_b32 v28, 0
    v_mov_b32 v29, 0
    v_mov_b32 v30, 0
    v_mov_b32 v31, 0
    v_mov_b32 v32, 0
    v_mov_b32 v33, 0
    v_mov_b32 v34, 0
    v_mov_b32 v35, 0
    v_mov_b32 v36, 0
    v_mov_b32 v37, 0
    v_mov_b32 v38, 0
    v_mov_b32 v39, 0
    v_mov_b32 v40, 0
    v_mov_b32 v41, 0
    v_mov_b32 v42, 0
    v_mov_b32 v43, 0
    v_mov_b32 v44, 0
    v_mov_b32 v45, 0
    v_mov_b32 v46, 0
    v_mov_b32 v47, 0
    v_mov_b32 v48, 0
    v_mov_b32 v49, 0
    v_mov_b32 v50, 0
    v_mov_b32 v51, 0
    v_mov_b32 v52, 0
    v_mov_b32 v53, 0
    v_mov_b32 v54, 0
    v_mov_b32 v55, 0
    v_mov_b32 v56, 0
    v_mov_b32 v57, 0
    v_mov_b32 v58, 0
    v_mov_b32 v59, 0
    v_mov_b32 v60, 0
    v_mov_b32 v61, 0
    v_mov_b32 v62, 0
    v_mov_b32 v63, 0
    v_mov_b32 v64, 0
    v_mov_b32 v65, 0
    v_mov_b32 v66, 0
    v_mov_b32 v67, 0
    v_mov_b32 v68, 0
    v_mov_b32 v69, 0
    v_mov_b32 v70, 0
    v_mov_b32 v71, 0
    v_mov_b32 v72, 0
    v_mov_b32 v73, 0
    v_mov_b32 v74, 0
    v_mov_b32 v75, 0
    v_mov_b32 v76, 0
    v_mov_b32 v77, 0
    v_mov_b32 v78, 0
    v_mov_b32 v79, 0
    v_mov_b32 v80, 0
    v_mov_b32 v81, 0
    v_mov_b32 v82, 0
    v_mov_b32 v83, 0
    v_mov_b32 v84, 0
    v_mov_b32 v85, 0
    v_mov_b32 v86, 0
    v_mov_b32 v87, 0
    v_mov_b32 v88, 0
    v_mov_b32 v89, 0
    v_mov_b32 v90, 0
    v_mov_b32 v91, 0
    v_mov_b32 v92, 0
    v_mov_b32 v93, 0
    v_mov_b32 v94, 0
    v_mov_b32 v95, 0
    v_mov_b32 v96, 0
    v_mov_b32 v97, 0
    v_mov_b32 v98, 0
    v_mov_b32 v99, 0
    v_mov_b32 v100, 0
    v_mov_b32 v101, 0
    v_mov_b32 v102, 0
    v_mov_b32 v103, 0
    s_mov_b32 s37, 1
    v_add_u32 v229, 49152, v201
    s_barrier
    ds_read_b128 v[104:107], v200 offset:0
    ds_read_b64_tr_b16 v[136:137], v201 offset:0
    ds_read_b64_tr_b16 v[138:139], v201 offset:512
    ds_read_b64_tr_b16 v[140:141], v201 offset:1024
    ds_read_b64_tr_b16 v[142:143], v201 offset:1536
    ds_read_b64_tr_b16 v[144:145], v201 offset:2048
    ds_read_b64_tr_b16 v[146:147], v201 offset:2560
    ds_read_b64_tr_b16 v[148:149], v201 offset:6144
    ds_read_b64_tr_b16 v[150:151], v201 offset:6656
    ds_read_b64_tr_b16 v[152:153], v201 offset:7168
    ds_read_b64_tr_b16 v[154:155], v201 offset:7680
    ds_read_b64_tr_b16 v[156:157], v201 offset:8192
    ds_read_b64_tr_b16 v[158:159], v201 offset:8704
    ds_read_b128 v[108:111], v200 offset:2048
    ds_read_b128 v[112:115], v200 offset:4096
    ds_read_b128 v[116:119], v200 offset:6144
    s_branch L_gin
    .p2align 6
L_gloop:
    s_waitcnt lgkmcnt(0)
    v_mfma_f32_16x16x32_bf16 v[8:11], v[160:163], v[120:123], v[8:11]
    s_barrier
    v_mfma_f32_16x16x32_bf16 v[12:15], v[164:167], v[120:123], v[12:15]
    ds_read_b128 v[104:107], v200 offset:0
    v_mfma_f32_16x16x32_bf16 v[16:19], v[168:171], v[120:123], v[16:19]
    ds_read_b64_tr_b16 v[136:137], v201 offset:0
    v_mfma_f32_16x16x32_bf16 v[20:23], v[172:175], v[120:123], v[20:23]
    ds_read_b64_tr_b16 v[138:139], v201 offset:512
    v_mfma_f32_16x16x32_bf16 v[24:27], v[176:179], v[120:123], v[24:27]
    ds_read_b64_tr_b16 v[140:141], v201 offset:1024
    v_mfma_f32_16x16x32_bf16 v[28:31], v[180:183], v[120:123], v[28:31]
    ds_read_b64_tr_b16 v[142:143], v201 offset:1536
    v_mfma_f32_16x16x32_bf16 v[32:35], v[160:163], v[124:127], v[32:35]
    ds_read_b64_tr_b16 v[144:145], v201 offset:2048
    v_mfma_f32_16x16x32_bf16 v[36:39], v[164:167], v[124:127], v[36:39]
    ds_read_b64_tr_b16 v[146:147], v201 offset:2560
    v_mfma_f32_16x16x32_bf16 v[40:43], v[168:171], v[124:127], v[40:43]
    ds_read_b64_tr_b16 v[148:149], v201 offset:6144
    v_mfma_f32_16x16x32_bf16 v[44:47], v[172:175], v[124:127], v[44:47]
    ds_read_b64_tr_b16 v[150:151], v201 offset:6656
    v_mfma_f32_16x16x32_bf16 v[48:51], v[176:179], v[124:127], v[48:51]
    ds_read_b64_tr_b16 v[152:153], v201 offset:7168
    v_mfma_f32_16x16x32_bf16 v[52:55], v[180:183], v[124:127], v[52:55]
    ds_read_b64_tr_b16 v[154:155], v201 offset:7680
    v_mfma_f32_16x16x32_bf16 v[56:59], v[160:163], v[128:131], v[56:59]
    ds_read_b64_tr_b16 v[156:157], v201 offset:8192
    v_mfma_f32_16x16x32_bf16 v[60:63], v[164:167], v[128:131], v[60:63]
    ds_read_b64_tr_b16 v[158:159], v201 offset:8704
    v_mfma_f32_16x16x32_bf16 v[64:67], v[168:171], v[128:131], v[64:67]
    ds_read_b128 v[108:111], v200 offset:2048
    v_mfma_f32_16x16x32_bf16 v[68:71], v[172:175], v[128:131], v[68:71]
    ds_read_b128 v[112:115], v200 offset:4096
    v_mfma_f32_16x16x32_bf16 v[72:75], v[176:179], v[128:131], v[72:75]
    ds_read_b128 v[116:119], v200 offset:6144
    v_mfma_f32_16x16x32_bf16 v[76:79], v[180:183], v[128:131], v[76:79]
    s_add_u32 s37, s37, 1
    v_mfma_f32_16x16x32_bf16 v[80:83], v[160:163], v[132:135], v[80:83]
    s_cmp_eq_u32 s37, 3
    v_mfma_f32_16x16x32_bf16 v[84:87], v[164:167], v[132:135], v[84:87]
    s_cselect_b32 s38, 4294934528, s42
    v_mfma_f32_16x16x32_bf16 v[88:91], v[168:171], v[132:135], v[88:91]
    s_cselect_b32 s37, 0, s37
    v_mfma_f32_16x16x32_bf16 v[92:95], v[172:175], v[132:135], v[92:95]
    v_mfma_f32_16x16x32_bf16 v[96:99], v[176:179], v[132:135], v[96:99]
    v_mfma_f32_16x16x32_bf16 v[100:103], v[180:183], v[132:135], v[100:103]
L_gin:
    s_waitcnt lgkmcnt(0)
    v_mfma_f32_16x16x32_bf16 v[8:11], v[136:139], v[104:107], v[8:11]
    ds_read_b128 v[120:123], v200 offset:1024
    v_mfma_f32_16x16x32_bf16 v[12:15], v[140:143], v[104:107], v[12:15]
    ds_read_b64_tr_b16 v[160:161], v201 offset:12288
    v_mfma_f32_16x16x32_bf16 v[16:19], v[144:147], v[104:107], v[16:19]
    ds_read_b64_tr_b16 v[162:163], v201 offset:12800
    v_mfma_f32_16x16x32_bf16 v[20:23], v[148:151], v[104:107], v[20:23]
    ds_read_b64_tr_b16 v[164:165], v201 offset:13312
    v_mfma_f32_16x16x32_bf16 v[24:27], v[152:155], v[104:107], v[24:27]
    ds_read_b64_tr_b16 v[166:167], v201 offset:13824
    v_mfma_f32_16x16x32_bf16 v[28:31], v[156:159], v[104:107], v[28:31]
    ds_read_b64_tr_b16 v[168:169], v201 offset:14336
    v_mfma_f32_16x16x32_bf16 v[32:35], v[136:139], v[108:111], v[32:35]
    ds_read_b64_tr_b16 v[170:171], v201 offset:14848
    v_mfma_f32_16x16x32_bf16 v[36:39], v[140:143], v[108:111], v[36:39]
    ds_read_b64_tr_b16 v[172:173], v201 offset:18432
    v_mfma_f32_16x16x32_bf16 v[40:43], v[144:147], v[108:111], v[40:43]
    ds_read_b64_tr_b16 v[174:175], v201 offset:18944
    v_mfma_f32_16x16x32_bf16 v[44:47], v[148:151], v[108:111], v[44:47]
    ds_read_b64_tr_b16 v[176:177], v201 offset:19456
    v_mfma_f32_16x16x32_bf16 v[48:51], v[152:155], v[108:111], v[48:51]
    ds_read_b64_tr_b16 v[178:179], v201 offset:19968
    v_mfma_f32_16x16x32_bf16 v[52:55], v[156:159], v[108:111], v[52:55]
    ds_read_b64_tr_b16 v[180:181], v201 offset:20480
    v_mfma_f32_16x16x32_bf16 v[56:59], v[136:139], v[112:115], v[56:59]
    ds_read_b64_tr_b16 v[182:183], v201 offset:20992
    v_mfma_f32_16x16x32_bf16 v[60:63], v[140:143], v[112:115], v[60:63]
    ds_read_b128 v[124:127], v200 offset:3072
    v_mfma_f32_16x16x32_bf16 v[64:67], v[144:147], v[112:115], v[64:67]
    ds_read_b128 v[128:131], v200 offset:5120
    v_mfma_f32_16x16x32_bf16 v[68:71], v[148:151], v[112:115], v[68:71]
    ds_read_b128 v[132:135], v200 offset:7168
    v_mfma_f32_16x16x32_bf16 v[72:75], v[152:155], v[112:115], v[72:75]
    s_add_u32 s41, s41, 1
    v_mfma_f32_16x16x32_bf16 v[76:79], v[156:159], v[112:115], v[76:79]
    s_cmp_eq_u32 s41, 3
    v_mfma_f32_16x16x32_bf16 v[80:83], v[136:139], v[116:119], v[80:83]
    s_cselect_b32 s39, 4294918144, s43
    v_mfma_f32_16x16x32_bf16 v[84:87], v[140:143], v[116:119], v[84:87]
    s_cselect_b32 s41, 0, s41
    v_mfma_f32_16x16x32_bf16 v[88:91], v[144:147], v[116:119], v[88:91]
    v_add_u32 v200, s38, v200
    v_mfma_f32_16x16x32_bf16 v[92:95], v[148:151], v[116:119], v[92:95]
    v_add_u32 v201, s39, v201
    v_mfma_f32_16x16x32_bf16 v[96:99], v[152:155], v[116:119], v[96:99]
    s_add_u32 s36, s36, 1
    v_mfma_f32_16x16x32_bf16 v[100:103], v[156:159], v[116:119], v[100:103]
    s_cmp_lt_u32 s36, 10
    s_cbranch_scc1 L_gloop
    ds_read_b64 v[184:185], v228 offset:0
    ds_read_b64 v[186:187], v228 offset:128
    ds_read_b64 v[188:189], v228 offset:256
    ds_read_b64 v[190:191], v228 offset:384
    s_waitcnt lgkmcnt(0) vmcnt(0)
    v_sub_f32 v192, 0, v190
    v_sub_f32 v193, 0, v184
    v_mfma_f32_16x16x32_bf16 v[8:11], v[160:163], v[120:123], v[8:11]
    s_barrier
    v_mfma_f32_16x16x32_bf16 v[12:15], v[164:167], v[120:123], v[12:15]
    v_fma_f32 v80, v204, v192, v80
    v_fma_f32 v81, v205, v192, v81
    v_mfma_f32_16x16x32_bf16 v[16:19], v[168:171], v[120:123], v[16:19]
    v_fma_f32 v82, v206, v192, v82
    v_fma_f32 v83, v207, v192, v83
    v_mfma_f32_16x16x32_bf16 v[20:23], v[172:175], v[120:123], v[20:23]
    v_fma_f32 v84, v208, v192, v84
    v_fma_f32 v85, v209, v192, v85
    v_mfma_f32_16x16x32_bf16 v[24:27], v[176:179], v[120:123], v[24:27]
    v_fma_f32 v86, v210, v192, v86
    v_fma_f32 v87, v211, v192, v87
    v_mfma_f32_16x16x32_bf16 v[28:31], v[180:183], v[120:123], v[28:31]
    v_fma_f32 v88, v212, v192, v88
    v_fma_f32 v89, v213, v192, v89
    v_mfma_f32_16x16x32_bf16 v[32:35], v[160:163], v[124:127], v[32:35]
    v_fma_f32 v90, v214, v192, v90
    v_fma_f32 v91, v215, v192, v91
    v_mfma_f32_16x16x32_bf16 v[36:39], v[164:167], v[124:127], v[36:39]
    v_fma_f32 v92, v216, v192, v92
    v_fma_f32 v93, v217, v192, v93
    v_mfma_f32_16x16x32_bf16 v[40:43], v[168:171], v[124:127], v[40:43]
    v_fma_f32 v94, v218, v192, v94
    v_fma_f32 v95, v219, v192, v95
    v_mfma_f32_16x16x32_bf16 v[44:47], v[172:175], v[124:127], v[44:47]
    v_fma_f32 v96, v220, v192, v96
    v_fma_f32 v97, v221, v192, v97
    v_mfma_f32_16x16x32_bf16 v[48:51], v[176:179], v[124:127], v[48:51]
    v_fma_f32 v98, v222, v192, v98
    v_fma_f32 v99, v223, v192, v99
    v_mfma_f32_16x16x32_bf16 v[52:55], v[180:183], v[124:127], v[52:55]
    v_fma_f32 v100, v224, v192, v100
    v_fma_f32 v101, v225, v192, v101
    v_mfma_f32_16x16x32_bf16 v[56:59], v[160:163], v[128:131], v[56:59]
    v_fma_f32 v102, v226, v192, v102
    v_fma_f32 v103, v227, v192, v103
    v_mfma_f32_16x16x32_bf16 v[60:63], v[164:167], v[128:131], v[60:63]
    v_fma_f32 v8, v204, v193, v8
    v_fma_f32 v9, v205, v193, v9
    v_mfma_f32_16x16x32_bf16 v[64:67], v[168:171], v[128:131], v[64:67]
    v_fma_f32 v10, v206, v193, v10
    v_fma_f32 v11, v207, v193, v11
    v_mfma_f32_16x16x32_bf16 v[68:71], v[172:175], v[128:131], v[68:71]
    v_fma_f32 v12, v208, v193, v12
    v_fma_f32 v13, v209, v193, v13
    v_mfma_f32_16x16x32_bf16 v[72:75], v[176:179], v[128:131], v[72:75]
    v_fma_f32 v14, v210, v193, v14
    v_fma_f32 v15, v211, v193, v15
    v_mfma_f32_16x16x32_bf16 v[76:79], v[180:183], v[128:131], v[76:79]
    v_fma_f32 v16, v212, v193, v16
    v_fma_f32 v17, v213, v193, v17
    v_mfma_f32_16x16x32_bf16 v[80:83], v[160:163], v[132:135], v[80:83]
    v_fma_f32 v18, v214, v193, v18
    v_fma_f32 v19, v215, v193, v19
    v_mfma_f32_16x16x32_bf16 v[84:87], v[164:167], v[132:135], v[84:87]
    v_fma_f32 v20, v216, v193, v20
    v_fma_f32 v21, v217, v193, v21
    v_mfma_f32_16x16x32_bf16 v[88:91], v[168:171], v[132:135], v[88:91]
    v_fma_f32 v22, v218, v193, v22
    v_fma_f32 v23, v219, v193, v23
    v_mfma_f32_16x16x32_bf16 v[92:95], v[172:175], v[132:135], v[92:95]
    v_fma_f32 v24, v220, v193, v24
    v_fma_f32 v25, v221, v193, v25
    v_mfma_f32_16x16x32_bf16 v[96:99], v[176:179], v[132:135], v[96:99]
    v_fma_f32 v26, v222, v193, v26
    v_fma_f32 v27, v223, v193, v27
    v_mfma_f32_16x16x32_bf16 v[100:103], v[180:183], v[132:135], v[100:103]
    v_fma_f32 v28, v224, v193, v28
    v_fma_f32 v29, v225, v193, v29
    v_fma_f32 v30, v226, v193, v30
    v_fma_f32 v31, v227, v193, v31
    v_sub_f32 v192, 0, v184
    v_mul_f32 v194, 0xbfb8aa3b, v185
    v_rcp_f32 v196, v185
    v_mov_b32 v193, v192
    v_mov_b32 v195, v194
    v_mov_b32 v197, v196
    v_pk_mul_f32 v[8:9], v[8:9], v[194:195]
    v_pk_mul_f32 v[10:11], v[10:11], v[194:195]
    v_pk_mul_f32 v[12:13], v[12:13], v[194:195]
    v_pk_mul_f32 v[14:15], v[14:15], v[194:195]
    v_pk_mul_f32 v[16:17], v[16:17], v[194:195]
    v_pk_mul_f32 v[18:19], v[18:19], v[194:195]
    v_exp_f32 v8, v8
    v_exp_f32 v9, v9
    v_exp_f32 v10, v10
    v_exp_f32 v11, v11
    v_exp_f32 v12, v12
    v_exp_f32 v13, v13
    v_exp_f32 v14, v14
    v_exp_f32 v15, v15
    v_exp_f32 v16, v16
    v_exp_f32 v17, v17
    v_exp_f32 v18, v18
    v_exp_f32 v19, v19
    v_pk_fma_f32 v[8:9], v[8:9], v[196:197], v[196:197]
    v_pk_fma_f32 v[10:11], v[10:11], v[196:197], v[196:197]
    v_pk_fma_f32 v[12:13], v[12:13], v[196:197], v[196:197]
    v_pk_fma_f32 v[14:15], v[14:15], v[196:197], v[196:197]
    v_pk_fma_f32 v[16:17], v[16:17], v[196:197], v[196:197]
    v_pk_fma_f32 v[18:19], v[18:19], v[196:197], v[196:197]
    v_rcp_f32 v8, v8
    v_rcp_f32 v9, v9
    v_rcp_f32 v10, v10
    v_rcp_f32 v11, v11
    v_rcp_f32 v12, v12
    v_rcp_f32 v13, v13
    v_rcp_f32 v14, v14
    v_rcp_f32 v15, v15
    v_rcp_f32 v16, v16
    v_rcp_f32 v17, v17
    v_rcp_f32 v18, v18
    v_rcp_f32 v19, v19
    v_pk_mul_f32 v[8:9], v[8:9], v[20:21]
    v_pk_mul_f32 v[10:11], v[10:11], v[22:23]
    v_pk_mul_f32 v[12:13], v[12:13], v[24:25]
    v_pk_mul_f32 v[14:15], v[14:15], v[26:27]
    v_pk_mul_f32 v[16:17], v[16:17], v[28:29]
    v_pk_mul_f32 v[18:19], v[18:19], v[30:31]
    v_cvt_pk_bf16_f32 v20, v8, v9
    v_cvt_pk_bf16_f32 v21, v10, v11
    v_cvt_pk_bf16_f32 v22, v12, v13
    v_cvt_pk_bf16_f32 v23, v14, v15
    v_cvt_pk_bf16_f32 v24, v16, v17
    v_cvt_pk_bf16_f32 v25, v18, v19
    s_mov_b32 s32, 0
    v_permlane16_swap_b32 v20, v22
    v_permlane16_swap_b32 v21, v23
    buffer_store_dwordx2 v[24:25], v203, s[28:31], s32 offen offset:1024 sc1
    buffer_store_dwordx4 v[20:23], v202, s[28:31], s32 offen sc1
    v_sub_f32 v192, 0, v186
    v_mul_f32 v194, 0xbfb8aa3b, v187
    v_rcp_f32 v196, v187
    v_mov_b32 v193, v192
    v_mov_b32 v195, v194
    v_mov_b32 v197, v196
    v_pk_fma_f32 v[32:33], v[204:205], v[192:193], v[32:33]
    v_pk_fma_f32 v[34:35], v[206:207], v[192:193], v[34:35]
    v_pk_fma_f32 v[36:37], v[208:209], v[192:193], v[36:37]
    v_pk_fma_f32 v[38:39], v[210:211], v[192:193], v[38:39]
    v_pk_fma_f32 v[40:41], v[212:213], v[192:193], v[40:41]
    v_pk_fma_f32 v[42:43], v[214:215], v[192:193], v[42:43]
    v_pk_fma_f32 v[44:45], v[216:217], v[192:193], v[44:45]
    v_pk_fma_f32 v[46:47], v[218:219], v[192:193], v[46:47]
    v_pk_fma_f32 v[48:49], v[220:221], v[192:193], v[48:49]
    v_pk_fma_f32 v[50:51], v[222:223], v[192:193], v[50:51]
    v_pk_fma_f32 v[52:53], v[224:225], v[192:193], v[52:53]
    v_pk_fma_f32 v[54:55], v[226:227], v[192:193], v[54:55]
    v_pk_mul_f32 v[32:33], v[32:33], v[194:195]
    v_pk_mul_f32 v[34:35], v[34:35], v[194:195]
    v_pk_mul_f32 v[36:37], v[36:37], v[194:195]
    v_pk_mul_f32 v[38:39], v[38:39], v[194:195]
    v_pk_mul_f32 v[40:41], v[40:41], v[194:195]
    v_pk_mul_f32 v[42:43], v[42:43], v[194:195]
    v_exp_f32 v32, v32
    v_exp_f32 v33, v33
    v_exp_f32 v34, v34
    v_exp_f32 v35, v35
    v_exp_f32 v36, v36
    v_exp_f32 v37, v37
    v_exp_f32 v38, v38
    v_exp_f32 v39, v39
    v_exp_f32 v40, v40
    v_exp_f32 v41, v41
    v_exp_f32 v42, v42
    v_exp_f32 v43, v43
    v_pk_fma_f32 v[32:33], v[32:33], v[196:197], v[196:197]
    v_pk_fma_f32 v[34:35], v[34:35], v[196:197], v[196:197]
    v_pk_fma_f32 v[36:37], v[36:37], v[196:197], v[196:197]
    v_pk_fma_f32 v[38:39], v[38:39], v[196:197], v[196:197]
    v_pk_fma_f32 v[40:41], v[40:41], v[196:197], v[196:197]
    v_pk_fma_f32 v[42:43], v[42:43], v[196:197], v[196:197]
    v_rcp_f32 v32, v32
    v_rcp_f32 v33, v33
    v_rcp_f32 v34, v34
    v_rcp_f32 v35, v35
    v_rcp_f32 v36, v36
    v_rcp_f32 v37, v37
    v_rcp_f32 v38, v38
    v_rcp_f32 v39, v39
    v_rcp_f32 v40, v40
    v_rcp_f32 v41, v41
    v_rcp_f32 v42, v42
    v_rcp_f32 v43, v43
    v_pk_mul_f32 v[32:33], v[32:33], v[44:45]
    v_pk_mul_f32 v[34:35], v[34:35], v[46:47]
    v_pk_mul_f32 v[36:37], v[36:37], v[48:49]
    v_pk_mul_f32 v[38:39], v[38:39], v[50:51]
    v_pk_mul_f32 v[40:41], v[40:41], v[52:53]
    v_pk_mul_f32 v[42:43], v[42:43], v[54:55]
    v_cvt_pk_bf16_f32 v44, v32, v33
    v_cvt_pk_bf16_f32 v45, v34, v35
    v_cvt_pk_bf16_f32 v46, v36, v37
    v_cvt_pk_bf16_f32 v47, v38, v39
    v_cvt_pk_bf16_f32 v48, v40, v41
    v_cvt_pk_bf16_f32 v49, v42, v43
    s_mov_b32 s32, 49152
    v_permlane16_swap_b32 v44, v46
    v_permlane16_swap_b32 v45, v47
    buffer_store_dwordx2 v[48:49], v203, s[28:31], s32 offen offset:1024 sc1
    buffer_store_dwordx4 v[44:47], v202, s[28:31], s32 offen sc1
    v_sub_f32 v192, 0, v188
    v_mul_f32 v194, 0xbfb8aa3b, v189
    v_rcp_f32 v196, v189
    v_mov_b32 v193, v192
    v_mov_b32 v195, v194
    v_mov_b32 v197, v196
    v_pk_fma_f32 v[56:57], v[204:205], v[192:193], v[56:57]
    v_pk_fma_f32 v[58:59], v[206:207], v[192:193], v[58:59]
    v_pk_fma_f32 v[60:61], v[208:209], v[192:193], v[60:61]
    v_pk_fma_f32 v[62:63], v[210:211], v[192:193], v[62:63]
    v_pk_fma_f32 v[64:65], v[212:213], v[192:193], v[64:65]
    v_pk_fma_f32 v[66:67], v[214:215], v[192:193], v[66:67]
    v_pk_fma_f32 v[68:69], v[216:217], v[192:193], v[68:69]
    v_pk_fma_f32 v[70:71], v[218:219], v[192:193], v[70:71]
    v_pk_fma_f32 v[72:73], v[220:221], v[192:193], v[72:73]
    v_pk_fma_f32 v[74:75], v[222:223], v[192:193], v[74:75]
    v_pk_fma_f32 v[76:77], v[224:225], v[192:193], v[76:77]
    v_pk_fma_f32 v[78:79], v[226:227], v[192:193], v[78:79]
    v_pk_mul_f32 v[56:57], v[56:57], v[194:195]
    v_pk_mul_f32 v[58:59], v[58:59], v[194:195]
    v_pk_mul_f32 v[60:61], v[60:61], v[194:195]
    v_pk_mul_f32 v[62:63], v[62:63], v[194:195]
    v_pk_mul_f32 v[64:65], v[64:65], v[194:195]
    v_pk_mul_f32 v[66:67], v[66:67], v[194:195]
    v_exp_f32 v56, v56
    v_exp_f32 v57, v57
    v_exp_f32 v58, v58
    v_exp_f32 v59, v59
    v_exp_f32 v60, v60
    v_exp_f32 v61, v61
    v_exp_f32 v62, v62
    v_exp_f32 v63, v63
    v_exp_f32 v64, v64
    v_exp_f32 v65, v65
    v_exp_f32 v66, v66
    v_exp_f32 v67, v67
    v_pk_fma_f32 v[56:57], v[56:57], v[196:197], v[196:197]
    v_pk_fma_f32 v[58:59], v[58:59], v[196:197], v[196:197]
    v_pk_fma_f32 v[60:61], v[60:61], v[196:197], v[196:197]
    v_pk_fma_f32 v[62:63], v[62:63], v[196:197], v[196:197]
    v_pk_fma_f32 v[64:65], v[64:65], v[196:197], v[196:197]
    v_pk_fma_f32 v[66:67], v[66:67], v[196:197], v[196:197]
    v_rcp_f32 v56, v56
    v_rcp_f32 v57, v57
    v_rcp_f32 v58, v58
    v_rcp_f32 v59, v59
    v_rcp_f32 v60, v60
    v_rcp_f32 v61, v61
    v_rcp_f32 v62, v62
    v_rcp_f32 v63, v63
    v_rcp_f32 v64, v64
    v_rcp_f32 v65, v65
    v_rcp_f32 v66, v66
    v_rcp_f32 v67, v67
    v_pk_mul_f32 v[56:57], v[56:57], v[68:69]
    v_pk_mul_f32 v[58:59], v[58:59], v[70:71]
    v_pk_mul_f32 v[60:61], v[60:61], v[72:73]
    v_pk_mul_f32 v[62:63], v[62:63], v[74:75]
    v_pk_mul_f32 v[64:65], v[64:65], v[76:77]
    v_pk_mul_f32 v[66:67], v[66:67], v[78:79]
    v_cvt_pk_bf16_f32 v68, v56, v57
    v_cvt_pk_bf16_f32 v69, v58, v59
    v_cvt_pk_bf16_f32 v70, v60, v61
    v_cvt_pk_bf16_f32 v71, v62, v63
    v_cvt_pk_bf16_f32 v72, v64, v65
    v_cvt_pk_bf16_f32 v73, v66, v67
    s_mov_b32 s32, 98304
    v_permlane16_swap_b32 v68, v70
    v_permlane16_swap_b32 v69, v71
    buffer_store_dwordx2 v[72:73], v203, s[28:31], s32 offen offset:1024 sc1
    buffer_store_dwordx4 v[68:71], v202, s[28:31], s32 offen sc1
    v_sub_f32 v192, 0, v190
    v_mul_f32 v194, 0xbfb8aa3b, v191
    v_rcp_f32 v196, v191
    v_mov_b32 v193, v192
    v_mov_b32 v195, v194
    v_mov_b32 v197, v196
    v_pk_mul_f32 v[80:81], v[80:81], v[194:195]
    v_pk_mul_f32 v[82:83], v[82:83], v[194:195]
    v_pk_mul_f32 v[84:85], v[84:85], v[194:195]
    v_pk_mul_f32 v[86:87], v[86:87], v[194:195]
    v_pk_mul_f32 v[88:89], v[88:89], v[194:195]
    v_pk_mul_f32 v[90:91], v[90:91], v[194:195]
    v_exp_f32 v80, v80
    v_exp_f32 v81, v81
    v_exp_f32 v82, v82
    v_exp_f32 v83, v83
    v_exp_f32 v84, v84
    v_exp_f32 v85, v85
    v_exp_f32 v86, v86
    v_exp_f32 v87, v87
    v_exp_f32 v88, v88
    v_exp_f32 v89, v89
    v_exp_f32 v90, v90
    v_exp_f32 v91, v91
    v_pk_fma_f32 v[80:81], v[80:81], v[196:197], v[196:197]
    v_pk_fma_f32 v[82:83], v[82:83], v[196:197], v[196:197]
    v_pk_fma_f32 v[84:85], v[84:85], v[196:197], v[196:197]
    v_pk_fma_f32 v[86:87], v[86:87], v[196:197], v[196:197]
    v_pk_fma_f32 v[88:89], v[88:89], v[196:197], v[196:197]
    v_pk_fma_f32 v[90:91], v[90:91], v[196:197], v[196:197]
    v_rcp_f32 v80, v80
    v_rcp_f32 v81, v81
    v_rcp_f32 v82, v82
    v_rcp_f32 v83, v83
    v_rcp_f32 v84, v84
    v_rcp_f32 v85, v85
    v_rcp_f32 v86, v86
    v_rcp_f32 v87, v87
    v_rcp_f32 v88, v88
    v_rcp_f32 v89, v89
    v_rcp_f32 v90, v90
    v_rcp_f32 v91, v91
    v_pk_mul_f32 v[80:81], v[80:81], v[92:93]
    v_pk_mul_f32 v[82:83], v[82:83], v[94:95]
    v_pk_mul_f32 v[84:85], v[84:85], v[96:97]
    v_pk_mul_f32 v[86:87], v[86:87], v[98:99]
    v_pk_mul_f32 v[88:89], v[88:89], v[100:101]
    v_pk_mul_f32 v[90:91], v[90:91], v[102:103]
    v_cvt_pk_bf16_f32 v92, v80, v81
    v_cvt_pk_bf16_f32 v93, v82, v83
    v_cvt_pk_bf16_f32 v94, v84, v85
    v_cvt_pk_bf16_f32 v95, v86, v87
    v_cvt_pk_bf16_f32 v96, v88, v89
    v_cvt_pk_bf16_f32 v97, v90, v91
    s_mov_b32 s32, 147456
    v_permlane16_swap_b32 v92, v94
    v_permlane16_swap_b32 v93, v95
    buffer_store_dwordx2 v[96:97], v203, s[28:31], s32 offen offset:1024 sc1
    buffer_store_dwordx4 v[92:95], v202, s[28:31], s32 offen sc1
    s_lshl_b32 s38, s12, 1
    s_add_u32 s38, s38, s15
    s_lshl_b32 s38, s38, 7
    s_lshl_b32 s39, s13, 1
    s_add_u32 s39, s39, s14
    s_lshl_b32 s39, s39, 2
    s_add_u32 s38, s38, s39
    s_add_u32 s38, s38, 8192
    s_lshr_b32 s12, s10, 1
    s_lshl_b32 s12, s12, 3
    s_and_b32 s13, s11, 7
    s_add_u32 s12, s12, s13
    s_and_b32 s13, s10, 1
    s_lshl_b32 s13, s13, 2
    s_lshr_b32 s14, s11, 3
    s_add_u32 s13, s13, s14
    s_lshr_b32 s14, s3, 1
    s_and_b32 s15, s3, 1
    s_lshl_b32 s15, s15, 1
    s_add_u32 s15, s15, s14
    s_lshl_b32 s32, s12, 2
    s_add_u32 s15, s15, s32
    v_lshlrev_b32 v2, 4, v0
    s_lshl_b32 s32, s15, 4
    v_and_b32 v1, 15, v0
    v_add_u32 v5, s32, v1
    v_mul_u32_u24 v6, 1280, v5
    v_lshrrev_b32 v5, 4, v0
    v_lshl_add_u32 v6, v5, 3, v6
    s_mul_i32 s33, s13, 160
    v_add_u32 v4, s33, v6
    s_xor_b32 s44, s15, 1
    s_add_u32 s16, s8, 13107200
    s_addc_u32 s17, s9, 0
    s_mov_b32 s18, 6291456
    s_mov_b32 s19, 0x00020000
    s_mov_b32 s28, s54
    s_mov_b32 s29, s55
    s_mov_b32 s30, 2621440
    s_mov_b32 s31, 0x00020000
    s_mul_i32 s32, s15, 49152
    s_mul_i32 s33, s44, 49152
    s_lshl_b32 s34, s14, 11
    s_add_u32 s32, s32, s34
    s_add_u32 s33, s33, s34
    v_add_u32 v195, s32, v2
    v_add_u32 v196, s33, v2
    v_lshrrev_b32 v1, 4, v0
    v_bfe_u32 v5, v0, 2, 2
    v_lshl_add_u32 v5, v1, 3, v5
    v_and_b32 v1, 1, v1
    v_lshlrev_b32 v1, 2, v1
    v_xor_b32 v5, v5, v1
    v_xor_b32 v6, 4, v5
    v_mul_u32_u24 v5, 160, v5
    v_mul_u32_u24 v6, 160, v6
    v_and_b32 v1, 3, v0
    v_lshl_add_u32 v5, v1, 3, v5
    v_lshl_add_u32 v6, v1, 3, v6
    s_mul_i32 s32, s14, 10240
    v_add_u32 v3, s32, v5
    v_add_u32 v7, s32, v6
    v_add_u32 v190, 61440, v3
    v_add_u32 v191, 61440, v7
    v_add_u32 v192, 122880, v3
    v_add_u32 v193, 122880, v7
    s_mul_i32 s32, s3, 5120
    s_add_u32 s32, s32, 143360
    v_add_u32 v188, s32, v2
    s_xor_b32 s33, s3, 2
    s_mul_i32 s33, s33, 5120
    s_add_u32 s33, s33, 143360
    v_add_u32 v189, s33, v2
    v_bfe_u32 v1, v0, 4, 1
    v_mul_u32_u24 v1, 24, v1
    v_add_u32 v197, v4, v1
    s_nop 1
    v_lshlrev_b32 v8, 16, v240
    v_and_b32 v9, 0xffff0000, v240
    v_lshlrev_b32 v10, 16, v241
    v_and_b32 v11, 0xffff0000, v241
    v_lshlrev_b32 v12, 16, v242
    v_and_b32 v13, 0xffff0000, v242
    v_lshlrev_b32 v14, 16, v243
    v_and_b32 v15, 0xffff0000, v243
    v_lshlrev_b32 v16, 16, v244
    v_and_b32 v17, 0xffff0000, v244
    v_lshlrev_b32 v18, 16, v245
    v_and_b32 v19, 0xffff0000, v245
    v_lshlrev_b32 v20, 16, v246
    v_and_b32 v21, 0xffff0000, v246
    v_lshlrev_b32 v22, 16, v247
    v_and_b32 v23, 0xffff0000, v247
    v_lshlrev_b32 v24, 16, v248
    v_and_b32 v25, 0xffff0000, v248
    v_lshlrev_b32 v26, 16, v249
    v_and_b32 v27, 0xffff0000, v249
    s_waitcnt vmcnt(0)
    v_mov_b32 v1, 1
    s_mov_b64 exec, 1
    buffer_store_dword v1, off, s[92:95], s38 sc1
    s_mov_b64 exec, -1
    s_barrier
    s_barrier
    s_mov_b32 s36, 0
    buffer_load_dwordx4 v[108:111], v195, s[16:19], s36 offen sc1
    buffer_load_dwordx4 v[112:115], v196, s[16:19], s36 offen sc1
    s_mov_b32 s36, 1024
    buffer_load_dwordx4 v[116:119], v195, s[16:19], s36 offen sc1
    buffer_load_dwordx4 v[120:123], v196, s[16:19], s36 offen sc1
    s_mov_b32 s36, 4096
    buffer_load_dwordx4 v[124:127], v195, s[16:19], s36 offen sc1
    buffer_load_dwordx4 v[128:131], v196, s[16:19], s36 offen sc1
    s_mov_b32 s36, 5120
    buffer_load_dwordx4 v[132:135], v195, s[16:19], s36 offen sc1
    buffer_load_dwordx4 v[136:139], v196, s[16:19], s36 offen sc1
    s_mov_b32 s36, 8192
    buffer_load_dwordx4 v[140:143], v195, s[16:19], s36 offen sc1
    buffer_load_dwordx4 v[144:147], v196, s[16:19], s36 offen sc1
    s_mov_b32 s36, 9216
    buffer_load_dwordx4 v[148:151], v195, s[16:19], s36 offen sc1
    buffer_load_dwordx4 v[152:155], v196, s[16:19], s36 offen sc1
    s_mov_b32 s46, 0
    ds_read_b64_tr_b16 v[48:49], v3 offset:0
    ds_read_b64_tr_b16 v[50:51], v7 offset:0
    ds_read_b64_tr_b16 v[52:53], v3 offset:32
    ds_read_b64_tr_b16 v[54:55], v7 offset:32
    ds_read_b64_tr_b16 v[56:57], v3 offset:64
    ds_read_b64_tr_b16 v[58:59], v7 offset:64
    ds_read_b64_tr_b16 v[60:61], v3 offset:96
    ds_read_b64_tr_b16 v[62:63], v7 offset:96
    ds_read_b64_tr_b16 v[64:65], v3 offset:128
    ds_read_b64_tr_b16 v[66:67], v7 offset:128
    ds_read_b64_tr_b16 v[68:69], v3 offset:5120
    ds_read_b64_tr_b16 v[70:71], v7 offset:5120
    ds_read_b64_tr_b16 v[72:73], v3 offset:5152
    ds_read_b64_tr_b16 v[74:75], v7 offset:5152
    ds_read_b64_tr_b16 v[76:77], v3 offset:5184
    ds_read_b64_tr_b16 v[78:79], v7 offset:5184
    ds_read_b64_tr_b16 v[80:81], v3 offset:5216
    ds_read_b64_tr_b16 v[82:83], v7 offset:5216
    ds_read_b64_tr_b16 v[84:85], v3 offset:5248
    ds_read_b64_tr_b16 v[86:87], v7 offset:5248
    s_waitcnt vmcnt(10) lgkmcnt(10)
    v_mfma_f32_16x16x32_bf16 v[8:11], v[48:51], v[108:111], v[8:11]
    ds_read_b64_tr_b16 v[88:89], v3 offset:20480
    ds_read_b64_tr_b16 v[90:91], v7 offset:20480
    v_mfma_f32_16x16x32_bf16 v[28:31], v[48:51], v[112:115], 0
    ds_read_b64_tr_b16 v[92:93], v3 offset:20512
    v_mfma_f32_16x16x32_bf16 v[12:15], v[52:55], v[108:111], v[12:15]
    ds_read_b64_tr_b16 v[94:95], v7 offset:20512
    ds_read_b64_tr_b16 v[96:97], v3 offset:20544
    v_mfma_f32_16x16x32_bf16 v[32:35], v[52:55], v[112:115], 0
    ds_read_b64_tr_b16 v[98:99], v7 offset:20544
    s_mov_b32 s36, 12288
    v_mfma_f32_16x16x32_bf16 v[16:19], v[56:59], v[108:111], v[16:19]
    buffer_load_dwordx4 v[156:159], v195, s[16:19], s36 offen sc1
    v_mfma_f32_16x16x32_bf16 v[36:39], v[56:59], v[112:115], 0
    ds_read_b64_tr_b16 v[100:101], v3 offset:20576
    ds_read_b64_tr_b16 v[102:103], v7 offset:20576
    v_mfma_f32_16x16x32_bf16 v[20:23], v[60:63], v[108:111], v[20:23]
    ds_read_b64_tr_b16 v[104:105], v3 offset:20608
    v_mfma_f32_16x16x32_bf16 v[40:43], v[60:63], v[112:115], 0
    ds_read_b64_tr_b16 v[106:107], v7 offset:20608
    v_mfma_f32_16x16x32_bf16 v[24:27], v[64:67], v[108:111], v[24:27]
    buffer_load_dwordx4 v[160:163], v196, s[16:19], s36 offen sc1
    v_mfma_f32_16x16x32_bf16 v[44:47], v[64:67], v[112:115], 0
    s_waitcnt vmcnt(10) lgkmcnt(10)
    v_mfma_f32_16x16x32_bf16 v[8:11], v[68:71], v[116:119], v[8:11]
    ds_read_b64_tr_b16 v[48:49], v3 offset:25600
    ds_read_b64_tr_b16 v[50:51], v7 offset:25600
    v_mfma_f32_16x16x32_bf16 v[28:31], v[68:71], v[120:123], v[28:31]
    ds_read_b64_tr_b16 v[52:53], v3 offset:25632
    v_mfma_f32_16x16x32_bf16 v[12:15], v[72:75], v[116:119], v[12:15]
    ds_read_b64_tr_b16 v[54:55], v7 offset:25632
    ds_read_b64_tr_b16 v[56:57], v3 offset:25664
    v_mfma_f32_16x16x32_bf16 v[32:35], v[72:75], v[120:123], v[32:35]
    ds_read_b64_tr_b16 v[58:59], v7 offset:25664
    s_mov_b32 s36, 13312
    v_mfma_f32_16x16x32_bf16 v[16:19], v[76:79], v[116:119], v[16:19]
    buffer_load_dwordx4 v[164:167], v195, s[16:19], s36 offen sc1
    v_mfma_f32_16x16x32_bf16 v[36:39], v[76:79], v[120:123], v[36:39]
    ds_read_b64_tr_b16 v[60:61], v3 offset:25696
    ds_read_b64_tr_b16 v[62:63], v7 offset:25696
    v_mfma_f32_16x16x32_bf16 v[20:23], v[80:83], v[116:119], v[20:23]
    ds_read_b64_tr_b16 v[64:65], v3 offset:25728
    v_mfma_f32_16x16x32_bf16 v[40:43], v[80:83], v[120:123], v[40:43]
    ds_read_b64_tr_b16 v[66:67], v7 offset:25728
    v_mfma_f32_16x16x32_bf16 v[24:27], v[84:87], v[116:119], v[24:27]
    buffer_load_dwordx4 v[168:171], v196, s[16:19], s36 offen sc1
    v_mfma_f32_16x16x32_bf16 v[44:47], v[84:87], v[120:123], v[44:47]
    s_waitcnt vmcnt(10) lgkmcnt(10)
    v_mfma_f32_16x16x32_bf16 v[8:11], v[88:91], v[124:127], v[8:11]
    ds_read_b64_tr_b16 v[68:69], v3 offset:40960
    ds_read_b64_tr_b16 v[70:71], v7 offset:40960
    v_mfma_f32_16x16x32_bf16 v[28:31], v[88:91], v[128:131], v[28:31]
    ds_read_b64_tr_b16 v[72:73], v3 offset:40992
    v_mfma_f32_16x16x32_bf16 v[12:15], v[92:95], v[124:127], v[12:15]
    ds_read_b64_tr_b16 v[74:75], v7 offset:40992
    ds_read_b64_tr_b16 v[76:77], v3 offset:41024
    v_mfma_f32_16x16x32_bf16 v[32:35], v[92:95], v[128:131], v[32:35]
    ds_read_b64_tr_b16 v[78:79], v7 offset:41024
    s_mov_b32 s36, 16384
    v_mfma_f32_16x16x32_bf16 v[16:19], v[96:99], v[124:127], v[16:19]
    buffer_load_dwordx4 v[108:111], v195, s[16:19], s36 offen sc1
    v_mfma_f32_16x16x32_bf16 v[36:39], v[96:99], v[128:131], v[36:39]
    ds_read_b64_tr_b16 v[80:81], v3 offset:41056
    ds_read_b64_tr_b16 v[82:83], v7 offset:41056
    v_mfma_f32_16x16x32_bf16 v[20:23], v[100:103], v[124:127], v[20:23]
    ds_read_b64_tr_b16 v[84:85], v3 offset:41088
    v_mfma_f32_16x16x32_bf16 v[40:43], v[100:103], v[128:131], v[40:43]
    ds_read_b64_tr_b16 v[86:87], v7 offset:41088
    v_mfma_f32_16x16x32_bf16 v[24:27], v[104:107], v[124:127], v[24:27]
    buffer_load_dwordx4 v[112:115], v196, s[16:19], s36 offen sc1
    v_mfma_f32_16x16x32_bf16 v[44:47], v[104:107], v[128:131], v[44:47]
    s_waitcnt vmcnt(10) lgkmcnt(10)
    v_mfma_f32_16x16x32_bf16 v[8:11], v[48:51], v[132:135], v[8:11]
    ds_read_b64_tr_b16 v[88:89], v3 offset:46080
    ds_read_b64_tr_b16 v[90:91], v7 offset:46080
    v_mfma_f32_16x16x32_bf16 v[28:31], v[48:51], v[136:139], v[28:31]
    ds_read_b64_tr_b16 v[92:93], v3 offset:46112
    v_mfma_f32_16x16x32_bf16 v[12:15], v[52:55], v[132:135], v[12:15]
    ds_read_b64_tr_b16 v[94:95], v7 offset:46112
    ds_read_b64_tr_b16 v[96:97], v3 offset:46144
    v_mfma_f32_16x16x32_bf16 v[32:35], v[52:55], v[136:139], v[32:35]
    ds_read_b64_tr_b16 v[98:99], v7 offset:46144
    s_mov_b32 s36, 17408
    v_mfma_f32_16x16x32_bf16 v[16:19], v[56:59], v[132:135], v[16:19]
    buffer_load_dwordx4 v[116:119], v195, s[16:19], s36 offen sc1
    v_mfma_f32_16x16x32_bf16 v[36:39], v[56:59], v[136:139], v[36:39]
    ds_read_b64_tr_b16 v[100:101], v3 offset:46176
    ds_read_b64_tr_b16 v[102:103], v7 offset:46176
    v_mfma_f32_16x16x32_bf16 v[20:23], v[60:63], v[132:135], v[20:23]
    ds_read_b64_tr_b16 v[104:105], v3 offset:46208
    v_mfma_f32_16x16x32_bf16 v[40:43], v[60:63], v[136:139], v[40:43]
    ds_read_b64_tr_b16 v[106:107], v7 offset:46208
    v_mfma_f32_16x16x32_bf16 v[24:27], v[64:67], v[132:135], v[24:27]
    buffer_load_dwordx4 v[120:123], v196, s[16:19], s36 offen sc1
    v_mfma_f32_16x16x32_bf16 v[44:47], v[64:67], v[136:139], v[44:47]
    s_waitcnt vmcnt(10) lgkmcnt(10)
    v_mfma_f32_16x16x32_bf16 v[8:11], v[68:71], v[140:143], v[8:11]
    ds_read_b64_tr_b16 v[48:49], v190 offset:0
    ds_read_b64_tr_b16 v[50:51], v191 offset:0
    v_mfma_f32_16x16x32_bf16 v[28:31], v[68:71], v[144:147], v[28:31]
    ds_read_b64_tr_b16 v[52:53], v190 offset:32
    v_mfma_f32_16x16x32_bf16 v[12:15], v[72:75], v[140:143], v[12:15]
    ds_read_b64_tr_b16 v[54:55], v191 offset:32
    ds_read_b64_tr_b16 v[56:57], v190 offset:64
    v_mfma_f32_16x16x32_bf16 v[32:35], v[72:75], v[144:147], v[32:35]
    ds_read_b64_tr_b16 v[58:59], v191 offset:64
    s_mov_b32 s36, 20480
    v_mfma_f32_16x16x32_bf16 v[16:19], v[76:79], v[140:143], v[16:19]
    buffer_load_dwordx4 v[124:127], v195, s[16:19], s36 offen sc1
    v_mfma_f32_16x16x32_bf16 v[36:39], v[76:79], v[144:147], v[36:39]
    ds_read_b64_tr_b16 v[60:61], v190 offset:96
    ds_read_b64_tr_b16 v[62:63], v191 offset:96
    v_mfma_f32_16x16x32_bf16 v[20:23], v[80:83], v[140:143], v[20:23]
    ds_read_b64_tr_b16 v[64:65], v190 offset:128
    v_mfma_f32_16x16x32_bf16 v[40:43], v[80:83], v[144:147], v[40:43]
    ds_read_b64_tr_b16 v[66:67], v191 offset:128
    v_mfma_f32_16x16x32_bf16 v[24:27], v[84:87], v[140:143], v[24:27]
    buffer_load_dwordx4 v[128:131], v196, s[16:19], s36 offen sc1
    v_mfma_f32_16x16x32_bf16 v[44:47], v[84:87], v[144:147], v[44:47]
    s_waitcnt vmcnt(10) lgkmcnt(10)
    v_mfma_f32_16x16x32_bf16 v[8:11], v[88:91], v[148:151], v[8:11]
    ds_read_b64_tr_b16 v[68:69], v190 offset:5120
    ds_read_b64_tr_b16 v[70:71], v191 offset:5120
    v_mfma_f32_16x16x32_bf16 v[28:31], v[88:91], v[152:155], v[28:31]
    ds_read_b64_tr_b16 v[72:73], v190 offset:5152
    v_mfma_f32_16x16x32_bf16 v[12:15], v[92:95], v[148:151], v[12:15]
    ds_read_b64_tr_b16 v[74:75], v191 offset:5152
    ds_read_b64_tr_b16 v[76:77], v190 offset:5184
    v_mfma_f32_16x16x32_bf16 v[32:35], v[92:95], v[152:155], v[32:35]
    ds_read_b64_tr_b16 v[78:79], v191 offset:5184
    s_mov_b32 s36, 21504
    v_mfma_f32_16x16x32_bf16 v[16:19], v[96:99], v[148:151], v[16:19]
    buffer_load_dwordx4 v[132:135], v195, s[16:19], s36 offen sc1
    v_mfma_f32_16x16x32_bf16 v[36:39], v[96:99], v[152:155], v[36:39]
    ds_read_b64_tr_b16 v[80:81], v190 offset:5216
    ds_read_b64_tr_b16 v[82:83], v191 offset:5216
    v_mfma_f32_16x16x32_bf16 v[20:23], v[100:103], v[148:151], v[20:23]
    ds_read_b64_tr_b16 v[84:85], v190 offset:5248
    v_mfma_f32_16x16x32_bf16 v[40:43], v[100:103], v[152:155], v[40:43]
    ds_read_b64_tr_b16 v[86:87], v191 offset:5248
    v_mfma_f32_16x16x32_bf16 v[24:27], v[104:107], v[148:151], v[24:27]
    buffer_load_dwordx4 v[136:139], v196, s[16:19], s36 offen sc1
    v_mfma_f32_16x16x32_bf16 v[44:47], v[104:107], v[152:155], v[44:47]
    s_waitcnt vmcnt(10) lgkmcnt(10)
    v_mfma_f32_16x16x32_bf16 v[8:11], v[48:51], v[156:159], v[8:11]
    ds_read_b64_tr_b16 v[88:89], v190 offset:20480
    ds_read_b64_tr_b16 v[90:91], v191 offset:20480
    v_mfma_f32_16x16x32_bf16 v[28:31], v[48:51], v[160:163], v[28:31]
    ds_read_b64_tr_b16 v[92:93], v190 offset:20512
    v_mfma_f32_16x16x32_bf16 v[12:15], v[52:55], v[156:159], v[12:15]
    ds_read_b64_tr_b16 v[94:95], v191 offset:20512
    ds_read_b64_tr_b16 v[96:97], v190 offset:20544
    v_mfma_f32_16x16x32_bf16 v[32:35], v[52:55], v[160:163], v[32:35]
    ds_read_b64_tr_b16 v[98:99], v191 offset:20544
    s_mov_b32 s36, 24576
    v_mfma_f32_16x16x32_bf16 v[16:19], v[56:59], v[156:159], v[16:19]
    buffer_load_dwordx4 v[140:143], v195, s[16:19], s36 offen sc1
    v_mfma_f32_16x16x32_bf16 v[36:39], v[56:59], v[160:163], v[36:39]
    ds_read_b64_tr_b16 v[100:101], v190 offset:20576
    ds_read_b64_tr_b16 v[102:103], v191 offset:20576
    v_mfma_f32_16x16x32_bf16 v[20:23], v[60:63], v[156:159], v[20:23]
    ds_read_b64_tr_b16 v[104:105], v190 offset:20608
    v_mfma_f32_16x16x32_bf16 v[40:43], v[60:63], v[160:163], v[40:43]
    ds_read_b64_tr_b16 v[106:107], v191 offset:20608
    v_mfma_f32_16x16x32_bf16 v[24:27], v[64:67], v[156:159], v[24:27]
    buffer_load_dwordx4 v[144:147], v196, s[16:19], s36 offen sc1
    v_mfma_f32_16x16x32_bf16 v[44:47], v[64:67], v[160:163], v[44:47]
    s_waitcnt vmcnt(10) lgkmcnt(10)
    v_mfma_f32_16x16x32_bf16 v[8:11], v[68:71], v[164:167], v[8:11]
    s_barrier
    ds_read_b64_tr_b16 v[48:49], v190 offset:25600
    ds_read_b64_tr_b16 v[50:51], v191 offset:25600
    v_mfma_f32_16x16x32_bf16 v[28:31], v[68:71], v[168:171], v[28:31]
    ds_read_b64_tr_b16 v[52:53], v190 offset:25632
    v_mfma_f32_16x16x32_bf16 v[12:15], v[72:75], v[164:167], v[12:15]
    ds_read_b64_tr_b16 v[54:55], v191 offset:25632
    ds_read_b64_tr_b16 v[56:57], v190 offset:25664
    v_mfma_f32_16x16x32_bf16 v[32:35], v[72:75], v[168:171], v[32:35]
    ds_read_b64_tr_b16 v[58:59], v191 offset:25664
    s_mov_b32 s36, 25600
    v_mfma_f32_16x16x32_bf16 v[16:19], v[76:79], v[164:167], v[16:19]
    buffer_load_dwordx4 v[148:151], v195, s[16:19], s36 offen sc1
    v_mfma_f32_16x16x32_bf16 v[36:39], v[76:79], v[168:171], v[36:39]
    ds_read_b64_tr_b16 v[60:61], v190 offset:25696
    ds_read_b64_tr_b16 v[62:63], v191 offset:25696
    v_mfma_f32_16x16x32_bf16 v[20:23], v[80:83], v[164:167], v[20:23]
    ds_read_b64_tr_b16 v[64:65], v190 offset:25728
    v_mfma_f32_16x16x32_bf16 v[40:43], v[80:83], v[168:171], v[40:43]
    ds_read_b64_tr_b16 v[66:67], v191 offset:25728
    v_mfma_f32_16x16x32_bf16 v[24:27], v[84:87], v[164:167], v[24:27]
    buffer_load_dwordx4 v[152:155], v196, s[16:19], s36 offen sc1
    v_mfma_f32_16x16x32_bf16 v[44:47], v[84:87], v[168:171], v[44:47]
    s_waitcnt vmcnt(10) lgkmcnt(10)
    v_mfma_f32_16x16x32_bf16 v[8:11], v[88:91], v[108:111], v[8:11]
    ds_read_b64_tr_b16 v[68:69], v190 offset:40960
    ds_read_b64_tr_b16 v[70:71], v191 offset:40960
    v_mfma_f32_16x16x32_bf16 v[28:31], v[88:91], v[112:115], v[28:31]
    ds_read_b64_tr_b16 v[72:73], v190 offset:40992
    v_mfma_f32_16x16x32_bf16 v[12:15], v[92:95], v[108:111], v[12:15]
    ds_read_b64_tr_b16 v[74:75], v191 offset:40992
    ds_read_b64_tr_b16 v[76:77], v190 offset:41024
    v_mfma_f32_16x16x32_bf16 v[32:35], v[92:95], v[112:115], v[32:35]
    ds_read_b64_tr_b16 v[78:79], v191 offset:41024
    s_mov_b32 s36, 28672
    v_mfma_f32_16x16x32_bf16 v[16:19], v[96:99], v[108:111], v[16:19]
    buffer_load_dwordx4 v[156:159], v195, s[16:19], s36 offen sc1
    v_mfma_f32_16x16x32_bf16 v[36:39], v[96:99], v[112:115], v[36:39]
    ds_read_b64_tr_b16 v[80:81], v190 offset:41056
    ds_read_b64_tr_b16 v[82:83], v191 offset:41056
    v_mfma_f32_16x16x32_bf16 v[20:23], v[100:103], v[108:111], v[20:23]
    ds_read_b64_tr_b16 v[84:85], v190 offset:41088
    v_mfma_f32_16x16x32_bf16 v[40:43], v[100:103], v[112:115], v[40:43]
    ds_read_b64_tr_b16 v[86:87], v191 offset:41088
    v_mfma_f32_16x16x32_bf16 v[24:27], v[104:107], v[108:111], v[24:27]
    buffer_load_dwordx4 v[160:163], v196, s[16:19], s36 offen sc1
    v_mfma_f32_16x16x32_bf16 v[44:47], v[104:107], v[112:115], v[44:47]
    s_waitcnt vmcnt(10) lgkmcnt(10)
    v_mfma_f32_16x16x32_bf16 v[8:11], v[48:51], v[116:119], v[8:11]
    ds_read_b64_tr_b16 v[88:89], v190 offset:46080
    ds_read_b64_tr_b16 v[90:91], v191 offset:46080
    v_mfma_f32_16x16x32_bf16 v[28:31], v[48:51], v[120:123], v[28:31]
    ds_read_b64_tr_b16 v[92:93], v190 offset:46112
    v_mfma_f32_16x16x32_bf16 v[12:15], v[52:55], v[116:119], v[12:15]
    ds_read_b64_tr_b16 v[94:95], v191 offset:46112
    ds_read_b64_tr_b16 v[96:97], v190 offset:46144
    v_mfma_f32_16x16x32_bf16 v[32:35], v[52:55], v[120:123], v[32:35]
    ds_read_b64_tr_b16 v[98:99], v191 offset:46144
    s_mov_b32 s36, 29696
    v_mfma_f32_16x16x32_bf16 v[16:19], v[56:59], v[116:119], v[16:19]
    buffer_load_dwordx4 v[164:167], v195, s[16:19], s36 offen sc1
    v_mfma_f32_16x16x32_bf16 v[36:39], v[56:59], v[120:123], v[36:39]
    ds_read_b64_tr_b16 v[100:101], v190 offset:46176
    ds_read_b64_tr_b16 v[102:103], v191 offset:46176
    v_mfma_f32_16x16x32_bf16 v[20:23], v[60:63], v[116:119], v[20:23]
    ds_read_b64_tr_b16 v[104:105], v190 offset:46208
    v_mfma_f32_16x16x32_bf16 v[40:43], v[60:63], v[120:123], v[40:43]
    ds_read_b64_tr_b16 v[106:107], v191 offset:46208
    v_mfma_f32_16x16x32_bf16 v[24:27], v[64:67], v[116:119], v[24:27]
    buffer_load_dwordx4 v[168:171], v196, s[16:19], s36 offen sc1
    v_mfma_f32_16x16x32_bf16 v[44:47], v[64:67], v[120:123], v[44:47]
    s_waitcnt vmcnt(10) lgkmcnt(10)
    v_mfma_f32_16x16x32_bf16 v[8:11], v[68:71], v[124:127], v[8:11]
    ds_read_b64_tr_b16 v[48:49], v192 offset:0
    ds_read_b64_tr_b16 v[50:51], v193 offset:0
    v_mfma_f32_16x16x32_bf16 v[28:31], v[68:71], v[128:131], v[28:31]
    ds_read_b64_tr_b16 v[52:53], v192 offset:32
    v_mfma_f32_16x16x32_bf16 v[12:15], v[72:75], v[124:127], v[12:15]
    ds_read_b64_tr_b16 v[54:55], v193 offset:32
    ds_read_b64_tr_b16 v[56:57], v192 offset:64
    v_mfma_f32_16x16x32_bf16 v[32:35], v[72:75], v[128:131], v[32:35]
    ds_read_b64_tr_b16 v[58:59], v193 offset:64
    s_mov_b32 s36, 32768
    v_mfma_f32_16x16x32_bf16 v[16:19], v[76:79], v[124:127], v[16:19]
    buffer_load_dwordx4 v[108:111], v195, s[16:19], s36 offen sc1
    v_mfma_f32_16x16x32_bf16 v[36:39], v[76:79], v[128:131], v[36:39]
    ds_read_b64_tr_b16 v[60:61], v192 offset:96
    ds_read_b64_tr_b16 v[62:63], v193 offset:96
    v_mfma_f32_16x16x32_bf16 v[20:23], v[80:83], v[124:127], v[20:23]
    ds_read_b64_tr_b16 v[64:65], v192 offset:128
    v_mfma_f32_16x16x32_bf16 v[40:43], v[80:83], v[128:131], v[40:43]
    ds_read_b64_tr_b16 v[66:67], v193 offset:128
    v_mfma_f32_16x16x32_bf16 v[24:27], v[84:87], v[124:127], v[24:27]
    buffer_load_dwordx4 v[112:115], v196, s[16:19], s36 offen sc1
    v_mfma_f32_16x16x32_bf16 v[44:47], v[84:87], v[128:131], v[44:47]
    s_waitcnt vmcnt(10) lgkmcnt(10)
    v_mfma_f32_16x16x32_bf16 v[8:11], v[88:91], v[132:135], v[8:11]
    ds_read_b64_tr_b16 v[68:69], v192 offset:5120
    ds_read_b64_tr_b16 v[70:71], v193 offset:5120
    v_mfma_f32_16x16x32_bf16 v[28:31], v[88:91], v[136:139], v[28:31]
    ds_read_b64_tr_b16 v[72:73], v192 offset:5152
    v_mfma_f32_16x16x32_bf16 v[12:15], v[92:95], v[132:135], v[12:15]
    ds_read_b64_tr_b16 v[74:75], v193 offset:5152
    ds_read_b64_tr_b16 v[76:77], v192 offset:5184
    v_mfma_f32_16x16x32_bf16 v[32:35], v[92:95], v[136:139], v[32:35]
    ds_read_b64_tr_b16 v[78:79], v193 offset:5184
    s_mov_b32 s36, 33792
    v_mfma_f32_16x16x32_bf16 v[16:19], v[96:99], v[132:135], v[16:19]
    buffer_load_dwordx4 v[116:119], v195, s[16:19], s36 offen sc1
    v_mfma_f32_16x16x32_bf16 v[36:39], v[96:99], v[136:139], v[36:39]
    ds_read_b64_tr_b16 v[80:81], v192 offset:5216
    ds_read_b64_tr_b16 v[82:83], v193 offset:5216
    v_mfma_f32_16x16x32_bf16 v[20:23], v[100:103], v[132:135], v[20:23]
    ds_read_b64_tr_b16 v[84:85], v192 offset:5248
    v_mfma_f32_16x16x32_bf16 v[40:43], v[100:103], v[136:139], v[40:43]
    ds_read_b64_tr_b16 v[86:87], v193 offset:5248
    v_mfma_f32_16x16x32_bf16 v[24:27], v[104:107], v[132:135], v[24:27]
    buffer_load_dwordx4 v[120:123], v196, s[16:19], s36 offen sc1
    v_mfma_f32_16x16x32_bf16 v[44:47], v[104:107], v[136:139], v[44:47]
    s_waitcnt vmcnt(10) lgkmcnt(10)
    v_mfma_f32_16x16x32_bf16 v[8:11], v[48:51], v[140:143], v[8:11]
    ds_read_b64_tr_b16 v[88:89], v192 offset:20480
    ds_read_b64_tr_b16 v[90:91], v193 offset:20480
    v_mfma_f32_16x16x32_bf16 v[28:31], v[48:51], v[144:147], v[28:31]
    ds_read_b64_tr_b16 v[92:93], v192 offset:20512
    v_mfma_f32_16x16x32_bf16 v[12:15], v[52:55], v[140:143], v[12:15]
    ds_read_b64_tr_b16 v[94:95], v193 offset:20512
    ds_read_b64_tr_b16 v[96:97], v192 offset:20544
    v_mfma_f32_16x16x32_bf16 v[32:35], v[52:55], v[144:147], v[32:35]
    ds_read_b64_tr_b16 v[98:99], v193 offset:20544
    s_mov_b32 s36, 36864
    v_mfma_f32_16x16x32_bf16 v[16:19], v[56:59], v[140:143], v[16:19]
    buffer_load_dwordx4 v[124:127], v195, s[16:19], s36 offen sc1
    v_mfma_f32_16x16x32_bf16 v[36:39], v[56:59], v[144:147], v[36:39]
    ds_read_b64_tr_b16 v[100:101], v192 offset:20576
    ds_read_b64_tr_b16 v[102:103], v193 offset:20576
    v_mfma_f32_16x16x32_bf16 v[20:23], v[60:63], v[140:143], v[20:23]
    ds_read_b64_tr_b16 v[104:105], v192 offset:20608
    v_mfma_f32_16x16x32_bf16 v[40:43], v[60:63], v[144:147], v[40:43]
    ds_read_b64_tr_b16 v[106:107], v193 offset:20608
    v_mfma_f32_16x16x32_bf16 v[24:27], v[64:67], v[140:143], v[24:27]
    buffer_load_dwordx4 v[128:131], v196, s[16:19], s36 offen sc1
    v_mfma_f32_16x16x32_bf16 v[44:47], v[64:67], v[144:147], v[44:47]
    s_waitcnt vmcnt(10) lgkmcnt(10)
    v_mfma_f32_16x16x32_bf16 v[8:11], v[68:71], v[148:151], v[8:11]
    ds_read_b64_tr_b16 v[48:49], v192 offset:25600
    ds_read_b64_tr_b16 v[50:51], v193 offset:25600
    v_mfma_f32_16x16x32_bf16 v[28:31], v[68:71], v[152:155], v[28:31]
    ds_read_b64_tr_b16 v[52:53], v192 offset:25632
    v_mfma_f32_16x16x32_bf16 v[12:15], v[72:75], v[148:151], v[12:15]
    ds_read_b64_tr_b16 v[54:55], v193 offset:25632
    ds_read_b64_tr_b16 v[56:57], v192 offset:25664
    v_mfma_f32_16x16x32_bf16 v[32:35], v[72:75], v[152:155], v[32:35]
    ds_read_b64_tr_b16 v[58:59], v193 offset:25664
    s_mov_b32 s36, 37888
    v_mfma_f32_16x16x32_bf16 v[16:19], v[76:79], v[148:151], v[16:19]
    buffer_load_dwordx4 v[132:135], v195, s[16:19], s36 offen sc1
    v_mfma_f32_16x16x32_bf16 v[36:39], v[76:79], v[152:155], v[36:39]
    ds_read_b64_tr_b16 v[60:61], v192 offset:25696
    ds_read_b64_tr_b16 v[62:63], v193 offset:25696
    v_mfma_f32_16x16x32_bf16 v[20:23], v[80:83], v[148:151], v[20:23]
    ds_read_b64_tr_b16 v[64:65], v192 offset:25728
    v_mfma_f32_16x16x32_bf16 v[40:43], v[80:83], v[152:155], v[40:43]
    ds_read_b64_tr_b16 v[66:67], v193 offset:25728
    v_mfma_f32_16x16x32_bf16 v[24:27], v[84:87], v[148:151], v[24:27]
    buffer_load_dwordx4 v[136:139], v196, s[16:19], s36 offen sc1
    v_mfma_f32_16x16x32_bf16 v[44:47], v[84:87], v[152:155], v[44:47]
    s_waitcnt vmcnt(10) lgkmcnt(10)
    v_mfma_f32_16x16x32_bf16 v[8:11], v[88:91], v[156:159], v[8:11]
    s_barrier
    ds_read_b64_tr_b16 v[68:69], v3 offset:0
    ds_read_b64_tr_b16 v[70:71], v7 offset:0
    v_mfma_f32_16x16x32_bf16 v[28:31], v[88:91], v[160:163], v[28:31]
    ds_read_b64_tr_b16 v[72:73], v3 offset:32
    v_mfma_f32_16x16x32_bf16 v[12:15], v[92:95], v[156:159], v[12:15]
    ds_read_b64_tr_b16 v[74:75], v7 offset:32
    ds_read_b64_tr_b16 v[76:77], v3 offset:64
    v_mfma_f32_16x16x32_bf16 v[32:35], v[92:95], v[160:163], v[32:35]
    ds_read_b64_tr_b16 v[78:79], v7 offset:64
    s_mov_b32 s36, 40960
    v_mfma_f32_16x16x32_bf16 v[16:19], v[96:99], v[156:159], v[16:19]
    buffer_load_dwordx4 v[140:143], v195, s[16:19], s36 offen sc1
    v_mfma_f32_16x16x32_bf16 v[36:39], v[96:99], v[160:163], v[36:39]
    ds_read_b64_tr_b16 v[80:81], v3 offset:96
    ds_read_b64_tr_b16 v[82:83], v7 offset:96
    v_mfma_f32_16x16x32_bf16 v[20:23], v[100:103], v[156:159], v[20:23]
    ds_read_b64_tr_b16 v[84:85], v3 offset:128
    v_mfma_f32_16x16x32_bf16 v[40:43], v[100:103], v[160:163], v[40:43]
    ds_read_b64_tr_b16 v[86:87], v7 offset:128
    v_mfma_f32_16x16x32_bf16 v[24:27], v[104:107], v[156:159], v[24:27]
    buffer_load_dwordx4 v[144:147], v196, s[16:19], s36 offen sc1
    v_mfma_f32_16x16x32_bf16 v[44:47], v[104:107], v[160:163], v[44:47]
    s_waitcnt vmcnt(10) lgkmcnt(10)
    v_mfma_f32_16x16x32_bf16 v[8:11], v[48:51], v[164:167], v[8:11]
    ds_read_b64_tr_b16 v[88:89], v3 offset:5120
    ds_read_b64_tr_b16 v[90:91], v7 offset:5120
    v_mfma_f32_16x16x32_bf16 v[28:31], v[48:51], v[168:171], v[28:31]
    ds_read_b64_tr_b16 v[92:93], v3 offset:5152
    v_mfma_f32_16x16x32_bf16 v[12:15], v[52:55], v[164:167], v[12:15]
    ds_read_b64_tr_b16 v[94:95], v7 offset:5152
    ds_read_b64_tr_b16 v[96:97], v3 offset:5184
    v_mfma_f32_16x16x32_bf16 v[32:35], v[52:55], v[168:171], v[32:35]
    ds_read_b64_tr_b16 v[98:99], v7 offset:5184
    s_mov_b32 s36, 41984
    v_mfma_f32_16x16x32_bf16 v[16:19], v[56:59], v[164:167], v[16:19]
    buffer_load_dwordx4 v[148:151], v195, s[16:19], s36 offen sc1
    v_mfma_f32_16x16x32_bf16 v[36:39], v[56:59], v[168:171], v[36:39]
    ds_read_b64_tr_b16 v[100:101], v3 offset:5216
    ds_read_b64_tr_b16 v[102:103], v7 offset:5216
    v_mfma_f32_16x16x32_bf16 v[20:23], v[60:63], v[164:167], v[20:23]
    ds_read_b64_tr_b16 v[104:105], v3 offset:5248
    v_mfma_f32_16x16x32_bf16 v[40:43], v[60:63], v[168:171], v[40:43]
    ds_read_b64_tr_b16 v[106:107], v7 offset:5248
    v_mfma_f32_16x16x32_bf16 v[24:27], v[64:67], v[164:167], v[24:27]
    buffer_load_dwordx4 v[152:155], v196, s[16:19], s36 offen sc1
    v_mfma_f32_16x16x32_bf16 v[44:47], v[64:67], v[168:171], v[44:47]
    s_waitcnt vmcnt(10) lgkmcnt(10)
    v_mfma_f32_16x16x32_bf16 v[8:11], v[68:71], v[108:111], v[8:11]
    ds_read_b64_tr_b16 v[48:49], v3 offset:20480
    ds_read_b64_tr_b16 v[50:51], v7 offset:20480
    v_mfma_f32_16x16x32_bf16 v[28:31], v[68:71], v[112:115], v[28:31]
    ds_read_b64_tr_b16 v[52:53], v3 offset:20512
    v_mfma_f32_16x16x32_bf16 v[12:15], v[72:75], v[108:111], v[12:15]
    ds_read_b64_tr_b16 v[54:55], v7 offset:20512
    ds_read_b64_tr_b16 v[56:57], v3 offset:20544
    v_mfma_f32_16x16x32_bf16 v[32:35], v[72:75], v[112:115], v[32:35]
    ds_read_b64_tr_b16 v[58:59], v7 offset:20544
    s_mov_b32 s36, 45056
    v_mfma_f32_16x16x32_bf16 v[16:19], v[76:79], v[108:111], v[16:19]
    buffer_load_dwordx4 v[156:159], v195, s[16:19], s36 offen sc1
    v_mfma_f32_16x16x32_bf16 v[36:39], v[76:79], v[112:115], v[36:39]
    ds_read_b64_tr_b16 v[60:61], v3 offset:20576
    ds_read_b64_tr_b16 v[62:63], v7 offset:20576
    v_mfma_f32_16x16x32_bf16 v[20:23], v[80:83], v[108:111], v[20:23]
    ds_read_b64_tr_b16 v[64:65], v3 offset:20608
    v_mfma_f32_16x16x32_bf16 v[40:43], v[80:83], v[112:115], v[40:43]
    ds_read_b64_tr_b16 v[66:67], v7 offset:20608
    v_mfma_f32_16x16x32_bf16 v[24:27], v[84:87], v[108:111], v[24:27]
    buffer_load_dwordx4 v[160:163], v196, s[16:19], s36 offen sc1
    v_mfma_f32_16x16x32_bf16 v[44:47], v[84:87], v[112:115], v[44:47]
    s_waitcnt vmcnt(10) lgkmcnt(10)
    v_mfma_f32_16x16x32_bf16 v[8:11], v[88:91], v[116:119], v[8:11]
    ds_read_b64_tr_b16 v[68:69], v3 offset:25600
    ds_read_b64_tr_b16 v[70:71], v7 offset:25600
    v_mfma_f32_16x16x32_bf16 v[28:31], v[88:91], v[120:123], v[28:31]
    ds_read_b64_tr_b16 v[72:73], v3 offset:25632
    v_mfma_f32_16x16x32_bf16 v[12:15], v[92:95], v[116:119], v[12:15]
    ds_read_b64_tr_b16 v[74:75], v7 offset:25632
    ds_read_b64_tr_b16 v[76:77], v3 offset:25664
    v_mfma_f32_16x16x32_bf16 v[32:35], v[92:95], v[120:123], v[32:35]
    ds_read_b64_tr_b16 v[78:79], v7 offset:25664
    s_mov_b32 s36, 46080
    v_mfma_f32_16x16x32_bf16 v[16:19], v[96:99], v[116:119], v[16:19]
    buffer_load_dwordx4 v[164:167], v195, s[16:19], s36 offen sc1
    v_mfma_f32_16x16x32_bf16 v[36:39], v[96:99], v[120:123], v[36:39]
    ds_read_b64_tr_b16 v[80:81], v3 offset:25696
    ds_read_b64_tr_b16 v[82:83], v7 offset:25696
    v_mfma_f32_16x16x32_bf16 v[20:23], v[100:103], v[116:119], v[20:23]
    ds_read_b64_tr_b16 v[84:85], v3 offset:25728
    v_mfma_f32_16x16x32_bf16 v[40:43], v[100:103], v[120:123], v[40:43]
    ds_read_b64_tr_b16 v[86:87], v7 offset:25728
    v_mfma_f32_16x16x32_bf16 v[24:27], v[104:107], v[116:119], v[24:27]
    buffer_load_dwordx4 v[168:171], v196, s[16:19], s36 offen sc1
    v_mfma_f32_16x16x32_bf16 v[44:47], v[104:107], v[120:123], v[44:47]
    s_waitcnt vmcnt(10) lgkmcnt(10)
    v_mfma_f32_16x16x32_bf16 v[8:11], v[48:51], v[124:127], v[8:11]
    ds_read_b64_tr_b16 v[88:89], v3 offset:40960
    ds_read_b64_tr_b16 v[90:91], v7 offset:40960
    v_mfma_f32_16x16x32_bf16 v[28:31], v[48:51], v[128:131], v[28:31]
    ds_read_b64_tr_b16 v[92:93], v3 offset:40992
    v_mfma_f32_16x16x32_bf16 v[12:15], v[52:55], v[124:127], v[12:15]
    ds_read_b64_tr_b16 v[94:95], v7 offset:40992
    ds_read_b64_tr_b16 v[96:97], v3 offset:41024
    v_mfma_f32_16x16x32_bf16 v[32:35], v[52:55], v[128:131], v[32:35]
    ds_read_b64_tr_b16 v[98:99], v7 offset:41024
    v_mfma_f32_16x16x32_bf16 v[16:19], v[56:59], v[124:127], v[16:19]
    v_mfma_f32_16x16x32_bf16 v[36:39], v[56:59], v[128:131], v[36:39]
    ds_read_b64_tr_b16 v[100:101], v3 offset:41056
    ds_read_b64_tr_b16 v[102:103], v7 offset:41056
    v_mfma_f32_16x16x32_bf16 v[20:23], v[60:63], v[124:127], v[20:23]
    ds_read_b64_tr_b16 v[104:105], v3 offset:41088
    v_mfma_f32_16x16x32_bf16 v[40:43], v[60:63], v[128:131], v[40:43]
    ds_read_b64_tr_b16 v[106:107], v7 offset:41088
    v_mfma_f32_16x16x32_bf16 v[24:27], v[64:67], v[124:127], v[24:27]
    v_mfma_f32_16x16x32_bf16 v[44:47], v[64:67], v[128:131], v[44:47]
    s_waitcnt vmcnt(8) lgkmcnt(10)
    v_mfma_f32_16x16x32_bf16 v[8:11], v[68:71], v[132:135], v[8:11]
    ds_read_b64_tr_b16 v[48:49], v3 offset:46080
    ds_read_b64_tr_b16 v[50:51], v7 offset:46080
    v_mfma_f32_16x16x32_bf16 v[28:31], v[68:71], v[136:139], v[28:31]
    ds_read_b64_tr_b16 v[52:53], v3 offset:46112
    v_mfma_f32_16x16x32_bf16 v[12:15], v[72:75], v[132:135], v[12:15]
    ds_read_b64_tr_b16 v[54:55], v7 offset:46112
    ds_read_b64_tr_b16 v[56:57], v3 offset:46144
    v_mfma_f32_16x16x32_bf16 v[32:35], v[72:75], v[136:139], v[32:35]
    ds_read_b64_tr_b16 v[58:59], v7 offset:46144
    v_mfma_f32_16x16x32_bf16 v[16:19], v[76:79], v[132:135], v[16:19]
    v_mfma_f32_16x16x32_bf16 v[36:39], v[76:79], v[136:139], v[36:39]
    ds_read_b64_tr_b16 v[60:61], v3 offset:46176
    ds_read_b64_tr_b16 v[62:63], v7 offset:46176
    v_mfma_f32_16x16x32_bf16 v[20:23], v[80:83], v[132:135], v[20:23]
    ds_read_b64_tr_b16 v[64:65], v3 offset:46208
    v_mfma_f32_16x16x32_bf16 v[40:43], v[80:83], v[136:139], v[40:43]
    ds_read_b64_tr_b16 v[66:67], v7 offset:46208
    v_mfma_f32_16x16x32_bf16 v[24:27], v[84:87], v[132:135], v[24:27]
    v_mfma_f32_16x16x32_bf16 v[44:47], v[84:87], v[136:139], v[44:47]
    s_waitcnt vmcnt(6) lgkmcnt(10)
    v_mfma_f32_16x16x32_bf16 v[8:11], v[88:91], v[140:143], v[8:11]
    ds_read_b64_tr_b16 v[68:69], v190 offset:0
    ds_read_b64_tr_b16 v[70:71], v191 offset:0
    v_mfma_f32_16x16x32_bf16 v[28:31], v[88:91], v[144:147], v[28:31]
    ds_read_b64_tr_b16 v[72:73], v190 offset:32
    v_mfma_f32_16x16x32_bf16 v[12:15], v[92:95], v[140:143], v[12:15]
    ds_read_b64_tr_b16 v[74:75], v191 offset:32
    ds_read_b64_tr_b16 v[76:77], v190 offset:64
    v_mfma_f32_16x16x32_bf16 v[32:35], v[92:95], v[144:147], v[32:35]
    ds_read_b64_tr_b16 v[78:79], v191 offset:64
    v_mfma_f32_16x16x32_bf16 v[16:19], v[96:99], v[140:143], v[16:19]
    v_mfma_f32_16x16x32_bf16 v[36:39], v[96:99], v[144:147], v[36:39]
    ds_read_b64_tr_b16 v[80:81], v190 offset:96
    ds_read_b64_tr_b16 v[82:83], v191 offset:96
    v_mfma_f32_16x16x32_bf16 v[20:23], v[100:103], v[140:143], v[20:23]
    ds_read_b64_tr_b16 v[84:85], v190 offset:128
    v_mfma_f32_16x16x32_bf16 v[40:43], v[100:103], v[144:147], v[40:43]
    ds_read_b64_tr_b16 v[86:87], v191 offset:128
    v_mfma_f32_16x16x32_bf16 v[24:27], v[104:107], v[140:143], v[24:27]
    v_mfma_f32_16x16x32_bf16 v[44:47], v[104:107], v[144:147], v[44:47]
    s_waitcnt vmcnt(4) lgkmcnt(10)
    v_mfma_f32_16x16x32_bf16 v[8:11], v[48:51], v[148:151], v[8:11]
    ds_read_b64_tr_b16 v[88:89], v190 offset:5120
    ds_read_b64_tr_b16 v[90:91], v191 offset:5120
    v_mfma_f32_16x16x32_bf16 v[28:31], v[48:51], v[152:155], v[28:31]
    ds_read_b64_tr_b16 v[92:93], v190 offset:5152
    v_mfma_f32_16x16x32_bf16 v[12:15], v[52:55], v[148:151], v[12:15]
    ds_read_b64_tr_b16 v[94:95], v191 offset:5152
    ds_read_b64_tr_b16 v[96:97], v190 offset:5184
    v_mfma_f32_16x16x32_bf16 v[32:35], v[52:55], v[152:155], v[32:35]
    ds_read_b64_tr_b16 v[98:99], v191 offset:5184
    v_mfma_f32_16x16x32_bf16 v[16:19], v[56:59], v[148:151], v[16:19]
    v_mfma_f32_16x16x32_bf16 v[36:39], v[56:59], v[152:155], v[36:39]
    ds_read_b64_tr_b16 v[100:101], v190 offset:5216
    ds_read_b64_tr_b16 v[102:103], v191 offset:5216
    v_mfma_f32_16x16x32_bf16 v[20:23], v[60:63], v[148:151], v[20:23]
    ds_read_b64_tr_b16 v[104:105], v190 offset:5248
    v_mfma_f32_16x16x32_bf16 v[40:43], v[60:63], v[152:155], v[40:43]
    ds_read_b64_tr_b16 v[106:107], v191 offset:5248
    v_mfma_f32_16x16x32_bf16 v[24:27], v[64:67], v[148:151], v[24:27]
    v_mfma_f32_16x16x32_bf16 v[44:47], v[64:67], v[152:155], v[44:47]
    s_waitcnt vmcnt(2) lgkmcnt(10)
    v_mfma_f32_16x16x32_bf16 v[8:11], v[68:71], v[156:159], v[8:11]
    v_mfma_f32_16x16x32_bf16 v[28:31], v[68:71], v[160:163], v[28:31]
    v_mfma_f32_16x16x32_bf16 v[12:15], v[72:75], v[156:159], v[12:15]
    v_mfma_f32_16x16x32_bf16 v[32:35], v[72:75], v[160:163], v[32:35]
    v_mfma_f32_16x16x32_bf16 v[16:19], v[76:79], v[156:159], v[16:19]
    v_mfma_f32_16x16x32_bf16 v[36:39], v[76:79], v[160:163], v[36:39]
    v_mfma_f32_16x16x32_bf16 v[20:23], v[80:83], v[156:159], v[20:23]
    v_mfma_f32_16x16x32_bf16 v[40:43], v[80:83], v[160:163], v[40:43]
    v_mfma_f32_16x16x32_bf16 v[24:27], v[84:87], v[156:159], v[24:27]
    v_mfma_f32_16x16x32_bf16 v[44:47], v[84:87], v[160:163], v[44:47]
    s_waitcnt vmcnt(0) lgkmcnt(0)
    v_mfma_f32_16x16x32_bf16 v[28:31], v[88:91], v[168:171], v[28:31]
    v_mfma_f32_16x16x32_bf16 v[32:35], v[92:95], v[168:171], v[32:35]
    v_mfma_f32_16x16x32_bf16 v[36:39], v[96:99], v[168:171], v[36:39]
    v_mfma_f32_16x16x32_bf16 v[40:43], v[100:103], v[168:171], v[40:43]
    v_mfma_f32_16x16x32_bf16 v[44:47], v[104:107], v[168:171], v[44:47]
    v_mfma_f32_16x16x32_bf16 v[8:11], v[88:91], v[164:167], v[8:11]
    v_mfma_f32_16x16x32_bf16 v[12:15], v[92:95], v[164:167], v[12:15]
    v_mfma_f32_16x16x32_bf16 v[16:19], v[96:99], v[164:167], v[16:19]
    v_mfma_f32_16x16x32_bf16 v[20:23], v[100:103], v[164:167], v[20:23]
    v_mfma_f32_16x16x32_bf16 v[24:27], v[104:107], v[164:167], v[24:27]
    ds_write_b128 v188, v[28:31] offset:0
    ds_write_b128 v188, v[32:35] offset:1024
    ds_write_b128 v188, v[36:39] offset:2048
    ds_write_b128 v188, v[40:43] offset:3072
    ds_write_b128 v188, v[44:47] offset:4096
    s_waitcnt lgkmcnt(0)
    s_barrier
    ds_read_b128 v[28:31], v189 offset:0
    ds_read_b128 v[32:35], v189 offset:1024
    ds_read_b128 v[36:39], v189 offset:2048
    ds_read_b128 v[40:43], v189 offset:3072
    ds_read_b128 v[44:47], v189 offset:4096
    s_waitcnt lgkmcnt(4)
    v_add_f32 v8, v8, v28
    v_add_f32 v9, v9, v29
    v_add_f32 v10, v10, v30
    v_add_f32 v11, v11, v31
    v_cvt_pk_bf16_f32 v240, v8, v9
    v_cvt_pk_bf16_f32 v241, v10, v11
    s_waitcnt lgkmcnt(3)
    v_add_f32 v12, v12, v32
    v_add_f32 v13, v13, v33
    v_add_f32 v14, v14, v34
    v_add_f32 v15, v15, v35
    v_cvt_pk_bf16_f32 v242, v12, v13
    v_cvt_pk_bf16_f32 v243, v14, v15
    s_nop 1
    v_permlane16_swap_b32 v240, v242
    v_permlane16_swap_b32 v241, v243
    buffer_store_dwordx4 v[240:243], v197, s[28:31], 0 offen offset:0
    s_waitcnt lgkmcnt(2)
    v_add_f32 v16, v16, v36
    v_add_f32 v17, v17, v37
    v_add_f32 v18, v18, v38
    v_add_f32 v19, v19, v39
    v_cvt_pk_bf16_f32 v244, v16, v17
    v_cvt_pk_bf16_f32 v245, v18, v19
    s_waitcnt lgkmcnt(1)
    v_add_f32 v20, v20, v40
    v_add_f32 v21, v21, v41
    v_add_f32 v22, v22, v42
    v_add_f32 v23, v23, v43
    v_cvt_pk_bf16_f32 v246, v20, v21
    v_cvt_pk_bf16_f32 v247, v22, v23
    s_nop 1
    v_permlane16_swap_b32 v244, v246
    v_permlane16_swap_b32 v245, v247
    buffer_store_dwordx4 v[244:247], v197, s[28:31], 0 offen offset:64
    s_waitcnt lgkmcnt(0)
    v_add_f32 v24, v24, v44
    v_add_f32 v25, v25, v45
    v_add_f32 v26, v26, v46
    v_add_f32 v27, v27, v47
    v_cvt_pk_bf16_f32 v248, v24, v25
    v_cvt_pk_bf16_f32 v249, v26, v27
    buffer_store_dwordx2 v[248:249], v4, s[28:31], 0 offen offset:128
    s_endpgm
L_gr0:
    s_add_u32 s46, s46, 1
    s_cmp_gt_u32 s46, 0x40000
    s_cbranch_scc1 L_go0
    s_sleep 2
    s_add_u32 m0, s33, 0
    s_movk_i32 s35, 0
    buffer_load_dwordx4 v4, s[16:19], s35 offen offset:0 sc1 lds
    buffer_load_dwordx4 v4, s[16:19], s35 offen offset:1024 sc1 lds
    buffer_load_dwordx4 v5, s[16:19], s35 offen offset:2048 sc1 lds
    buffer_load_dwordx4 v5, s[16:19], s35 offen offset:3072 sc1 lds
    s_waitcnt vmcnt(0)
    s_branch L_gv0
L_gr1:
    s_add_u32 s46, s46, 1
    s_cmp_gt_u32 s46, 0x40000
    s_cbranch_scc1 L_go1
    s_sleep 2
    s_add_u32 m0, s33, 16384
    s_movk_i32 s35, 2048
    buffer_load_dwordx4 v4, s[16:19], s35 offen offset:0 sc1 lds
    buffer_load_dwordx4 v4, s[16:19], s35 offen offset:1024 sc1 lds
    buffer_load_dwordx4 v5, s[16:19], s35 offen offset:2048 sc1 lds
    buffer_load_dwordx4 v5, s[16:19], s35 offen offset:3072 sc1 lds
    s_waitcnt vmcnt(0)
    s_branch L_gv1
L_gr2:
    s_add_u32 s46, s46, 1
    s_cmp_gt_u32 s46, 0x40000
    s_cbranch_scc1 L_go2
    s_sleep 2
    s_add_u32 m0, s33, 32768
    s_movk_i32 s35, 4096
    buffer_load_dwordx4 v4, s[16:19], s35 offen offset:0 sc1 lds
    buffer_load_dwordx4 v4, s[16:19], s35 offen offset:1024 sc1 lds
    buffer_load_dwordx4 v5, s[16:19], s35 offen offset:2048 sc1 lds
    buffer_load_dwordx4 v5, s[16:19], s35 offen offset:3072 sc1 lds
    s_waitcnt vmcnt(0)
    s_branch L_gv2
L_gr3:
    s_add_u32 s46, s46, 1
    s_cmp_gt_u32 s46, 0x40000
    s_cbranch_scc1 L_go3
    s_sleep 2
    s_add_u32 m0, s33, 0
    s_movk_i32 s35, 6144
    buffer_load_dwordx4 v4, s[16:19], s35 offen offset:0 sc1 lds
    buffer_load_dwordx4 v4, s[16:19], s35 offen offset:1024 sc1 lds
    buffer_load_dwordx4 v5, s[16:19], s35 offen offset:2048 sc1 lds
    buffer_load_dwordx4 v5, s[16:19], s35 offen offset:3072 sc1 lds
    s_waitcnt vmcnt(0)
    s_branch L_gv3
L_gr4:
    s_add_u32 s46, s46, 1
    s_cmp_gt_u32 s46, 0x40000
    s_cbranch_scc1 L_go4
    s_sleep 2
    s_add_u32 m0, s33, 16384
    s_movk_i32 s35, 8192
    buffer_load_dwordx4 v4, s[16:19], s35 offen offset:0 sc1 lds
    buffer_load_dwordx4 v4, s[16:19], s35 offen offset:1024 sc1 lds
    buffer_load_dwordx4 v5, s[16:19], s35 offen offset:2048 sc1 lds
    buffer_load_dwordx4 v5, s[16:19], s35 offen offset:3072 sc1 lds
    s_waitcnt vmcnt(0)
    s_branch L_gv4
L_gr5:
    s_add_u32 s46, s46, 1
    s_cmp_gt_u32 s46, 0x40000
    s_cbranch_scc1 L_go5
    s_sleep 2
    s_add_u32 m0, s33, 32768
    s_movk_i32 s35, 10240
    buffer_load_dwordx4 v4, s[16:19], s35 offen offset:0 sc1 lds
    buffer_load_dwordx4 v4, s[16:19], s35 offen offset:1024 sc1 lds
    buffer_load_dwordx4 v5, s[16:19], s35 offen offset:2048 sc1 lds
    buffer_load_dwordx4 v5, s[16:19], s35 offen offset:3072 sc1 lds
    s_waitcnt vmcnt(0)
    s_branch L_gv5
L_gr6:
    s_add_u32 s46, s46, 1
    s_cmp_gt_u32 s46, 0x40000
    s_cbranch_scc1 L_go6
    s_sleep 2
    s_add_u32 m0, s33, 0
    s_movk_i32 s35, 12288
    buffer_load_dwordx4 v4, s[16:19], s35 offen offset:0 sc1 lds
    buffer_load_dwordx4 v4, s[16:19], s35 offen offset:1024 sc1 lds
    buffer_load_dwordx4 v5, s[16:19], s35 offen offset:2048 sc1 lds
    buffer_load_dwordx4 v5, s[16:19], s35 offen offset:3072 sc1 lds
    s_waitcnt vmcnt(0)
    s_branch L_gv6
L_gr7:
    s_add_u32 s46, s46, 1
    s_cmp_gt_u32 s46, 0x40000
    s_cbranch_scc1 L_go7
    s_sleep 2
    s_add_u32 m0, s33, 16384
    s_movk_i32 s35, 14336
    buffer_load_dwordx4 v4, s[16:19], s35 offen offset:0 sc1 lds
    buffer_load_dwordx4 v4, s[16:19], s35 offen offset:1024 sc1 lds
    buffer_load_dwordx4 v5, s[16:19], s35 offen offset:2048 sc1 lds
    buffer_load_dwordx4 v5, s[16:19], s35 offen offset:3072 sc1 lds
    s_waitcnt vmcnt(0)
    s_branch L_gv7
L_gr8:
    s_add_u32 s46, s46, 1
    s_cmp_gt_u32 s46, 0x40000
    s_cbranch_scc1 L_go8
    s_sleep 2
    s_add_u32 m0, s33, 32768
    s_movk_i32 s35, 16384
    buffer_load_dwordx4 v4, s[16:19], s35 offen offset:0 sc1 lds
    buffer_load_dwordx4 v4, s[16:19], s35 offen offset:1024 sc1 lds
    buffer_load_dwordx4 v5, s[16:19], s35 offen offset:2048 sc1 lds
    buffer_load_dwordx4 v5, s[16:19], s35 offen offset:3072 sc1 lds
    s_waitcnt vmcnt(0)
    s_branch L_gv8
L_gsr:
    s_add_u32 s46, s46, 1
    s_cmp_gt_u32 s46, 0x40000
    s_cbranch_scc1 L_gso
    buffer_load_dwordx2 v[240:241], v6, s[24:27], s41 offen offset:0 sc1
    buffer_load_dwordx2 v[242:243], v6, s[24:27], s41 offen offset:128 sc1
    buffer_load_dwordx2 v[244:245], v6, s[24:27], s41 offen offset:256 sc1
    buffer_load_dwordx2 v[246:247], v6, s[24:27], s41 offen offset:384 sc1
    s_waitcnt vmcnt(0)
    s_branch L_gsv
L_gr9:
    s_add_u32 s46, s46, 1
    s_cmp_gt_u32 s46, 0x40000
    s_cbranch_scc1 L_go9
    s_sleep 2
    s_add_u32 m0, s33, 0
    s_movk_i32 s35, 18432
    buffer_load_dwordx4 v4, s[16:19], s35 offen offset:0 sc1 lds
    buffer_load_dwordx4 v4, s[16:19], s35 offen offset:1024 sc1 lds
    buffer_load_dwordx4 v5, s[16:19], s35 offen offset:2048 sc1 lds
    buffer_load_dwordx4 v5, s[16:19], s35 offen offset:3072 sc1 lds
    s_waitcnt vmcnt(0)
    s_branch L_gv9
L_slow:
    s_waitcnt lgkmcnt(0)
    v_cndmask_b32 v124, 0, v124, s[40:41]
    v_cndmask_b32 v125, 0, v125, s[40:41]
    v_mov_b32 v172, 0xff800000
    v_cndmask_b32 v130, 0, v130, s[40:41]
    v_cndmask_b32 v131, 0, v131, s[40:41]
    v_mov_b32 v173, 0xff800000
    v_cndmask_b32 v136, 0, v136, s[40:41]
    v_cndmask_b32 v137, 0, v137, s[40:41]
    v_mov_b32 v174, 0xff800000
    v_cndmask_b32 v142, 0, v142, s[40:41]
    v_cndmask_b32 v143, 0, v143, s[40:41]
    v_mov_b32 v175, 0xff800000
    s_add_u32 s36, s20, s23
    s_add_u32 s36, s36, 2621440
    s_mul_i32 s37, s12, 640
    s_mul_i32 s38, s14, 1310720
    s_add_u32 s37, s37, s38
    s_add_u32 s37, s37, 5242880
    s_mov_b32 s26, 0
L_slowmax:
    buffer_load_dwordx4 v[144:147], v2, s[16:19], s36 offen sc1
    s_mov_b64 exec, s[40:41]
    buffer_load_dwordx2 v[148:149], v3, s[16:19], s36 offen offset:1024 sc1
    s_mov_b64 exec, -1
    s_waitcnt vmcnt(0)
    v_mfma_f32_32x32x16_bf16 v[72:87], v[144:147], v[120:123], 0
    v_mfma_f32_32x32x8_bf16 v[72:87], v[148:149], v[124:125], v[72:87]
    v_mfma_f32_32x32x16_bf16 v[88:103], v[144:147], v[126:129], 0
    v_mfma_f32_32x32x8_bf16 v[88:103], v[148:149], v[130:131], v[88:103]
    v_mfma_f32_32x32x16_bf16 v[192:207], v[144:147], v[132:135], 0
    v_mfma_f32_32x32x8_bf16 v[192:207], v[148:149], v[136:137], v[192:207]
    v_mfma_f32_32x32x16_bf16 v[208:223], v[144:147], v[138:141], 0
    v_mfma_f32_32x32x8_bf16 v[208:223], v[148:149], v[142:143], v[208:223]
    s_nop 15
    v_max3_f32 v172, v172, v72, v73
    v_max3_f32 v172, v172, v74, v75
    v_max3_f32 v172, v172, v76, v77
    v_max3_f32 v172, v172, v78, v79
    v_max3_f32 v172, v172, v80, v81
    v_max3_f32 v172, v172, v82, v83
    v_max3_f32 v172, v172, v84, v85
    v_max3_f32 v172, v172, v86, v87
    v_max3_f32 v173, v173, v88, v89
    v_max3_f32 v173, v173, v90, v91
    v_max3_f32 v173, v173, v92, v93
    v_max3_f32 v173, v173, v94, v95
    v_max3_f32 v173, v173, v96, v97
    v_max3_f32 v173, v173, v98, v99
    v_max3_f32 v173, v173, v100, v101
    v_max3_f32 v173, v173, v102, v103
    v_max3_f32 v174, v174, v192, v193
    v_max3_f32 v174, v174, v194, v195
    v_max3_f32 v174, v174, v196, v197
    v_max3_f32 v174, v174, v198, v199
    v_max3_f32 v174, v174, v200, v201
    v_max3_f32 v174, v174, v202, v203
    v_max3_f32 v174, v174, v204, v205
    v_max3_f32 v174, v174, v206, v207
    v_max3_f32 v175, v175, v208, v209
    v_max3_f32 v175, v175, v210, v211
    v_max3_f32 v175, v175, v212, v213
    v_max3_f32 v175, v175, v214, v215
    v_max3_f32 v175, v175, v216, v217
    v_max3_f32 v175, v175, v218, v219
    v_max3_f32 v175, v175, v220, v221
    v_max3_f32 v175, v175, v222, v223
    s_add_u32 s36, s36, 1280
    s_add_u32 s26, s26, 1
    s_cmp_lt_u32 s26, 32
    s_cbranch_scc1 L_slowmax
    v_mov_b32 v176, v172
    v_mov_b32 v177, v173
    v_mov_b32 v178, v174
    v_mov_b32 v179, v175
    s_nop 1
    v_permlane32_swap_b32 v172, v176
    v_permlane32_swap_b32 v173, v177
    v_permlane32_swap_b32 v174, v178
    v_permlane32_swap_b32 v175, v179
    s_nop 1
    v_max_f32 v172, v172, v176
    v_sub_f32 v172, 0, v172
    v_and_b32 v5, 0xffff0000, v172
    v_sub_f32 v6, v172, v5
    v_and_b32 v7, 0xffff0000, v6
    v_sub_f32 v6, v6, v7
    v_lshrrev_b32 v5, 16, v5
    v_or_b32 v5, v5, v7
    v_lshrrev_b32 v6, 16, v6
    v_cndmask_b32 v124, v5, v124, s[40:41]
    v_cndmask_b32 v125, v6, v125, s[40:41]
    v_max_f32 v173, v173, v177
    v_sub_f32 v173, 0, v173
    v_and_b32 v5, 0xffff0000, v173
    v_sub_f32 v6, v173, v5
    v_and_b32 v7, 0xffff0000, v6
    v_sub_f32 v6, v6, v7
    v_lshrrev_b32 v5, 16, v5
    v_or_b32 v5, v5, v7
    v_lshrrev_b32 v6, 16, v6
    v_cndmask_b32 v130, v5, v130, s[40:41]
    v_cndmask_b32 v131, v6, v131, s[40:41]
    v_max_f32 v174, v174, v178
    v_sub_f32 v174, 0, v174
    v_and_b32 v5, 0xffff0000, v174
    v_sub_f32 v6, v174, v5
    v_and_b32 v7, 0xffff0000, v6
    v_sub_f32 v6, v6, v7
    v_lshrrev_b32 v5, 16, v5
    v_or_b32 v5, v5, v7
    v_lshrrev_b32 v6, 16, v6
    v_cndmask_b32 v136, v5, v136, s[40:41]
    v_cndmask_b32 v137, v6, v137, s[40:41]
    v_max_f32 v175, v175, v179
    v_sub_f32 v175, 0, v175
    v_and_b32 v5, 0xffff0000, v175
    v_sub_f32 v6, v175, v5
    v_and_b32 v7, 0xffff0000, v6
    v_sub_f32 v6, v6, v7
    v_lshrrev_b32 v5, 16, v5
    v_or_b32 v5, v5, v7
    v_lshrrev_b32 v6, 16, v6
    v_cndmask_b32 v142, v5, v142, s[40:41]
    v_cndmask_b32 v143, v6, v143, s[40:41]
    v_mov_b32 v8, 0
    v_mov_b32 v9, 0
    v_mov_b32 v10, 0
    v_mov_b32 v11, 0
    v_mov_b32 v12, 0
    v_mov_b32 v13, 0
    v_mov_b32 v14, 0
    v_mov_b32 v15, 0
    v_mov_b32 v16, 0
    v_mov_b32 v17, 0
    v_mov_b32 v18, 0
    v_mov_b32 v19, 0
    v_mov_b32 v20, 0
    v_mov_b32 v21, 0
    v_mov_b32 v22, 0
    v_mov_b32 v23, 0
    v_mov_b32 v24, 0
    v_mov_b32 v25, 0
    v_mov_b32 v26, 0
    v_mov_b32 v27, 0
    v_mov_b32 v28, 0
    v_mov_b32 v29, 0
    v_mov_b32 v30, 0
    v_mov_b32 v31, 0
    v_mov_b32 v32, 0
    v_mov_b32 v33, 0
    v_mov_b32 v34, 0
    v_mov_b32 v35, 0
    v_mov_b32 v36, 0
    v_mov_b32 v37, 0
    v_mov_b32 v38, 0
    v_mov_b32 v39, 0
    v_mov_b32 v40, 0
    v_mov_b32 v41, 0
    v_mov_b32 v42, 0
    v_mov_b32 v43, 0
    v_mov_b32 v44, 0
    v_mov_b32 v45, 0
    v_mov_b32 v46, 0
    v_mov_b32 v47, 0
    v_mov_b32 v48, 0
    v_mov_b32 v49, 0
    v_mov_b32 v50, 0
    v_mov_b32 v51, 0
    v_mov_b32 v52, 0
    v_mov_b32 v53, 0
    v_mov_b32 v54, 0
    v_mov_b32 v55, 0
    v_mov_b32 v56, 0
    v_mov_b32 v57, 0
    v_mov_b32 v58, 0
    v_mov_b32 v59, 0
    v_mov_b32 v60, 0
    v_mov_b32 v61, 0
    v_mov_b32 v62, 0
    v_mov_b32 v63, 0
    v_mov_b32 v64, 0
    v_mov_b32 v65, 0
    v_mov_b32 v66, 0
    v_mov_b32 v67, 0
    v_mov_b32 v68, 0
    v_mov_b32 v69, 0
    v_mov_b32 v70, 0
    v_mov_b32 v71, 0
    v_mov_b32 v112, 0
    v_mov_b32 v113, 0
    v_mov_b32 v114, 0
    v_mov_b32 v115, 0
    v_mov_b32 v116, 0
    v_mov_b32 v117, 0
    v_mov_b32 v118, 0
    v_mov_b32 v119, 0
    s_add_u32 s36, s20, s23
    s_add_u32 s36, s36, 2621440
    s_mul_i32 s37, s12, 640
    s_mul_i32 s38, s14, 1310720
    s_add_u32 s37, s37, s38
    s_add_u32 s37, s37, 5242880
    s_mov_b32 s26, 0
L_slowsm:
    buffer_load_dwordx4 v[144:147], v2, s[16:19], s36 offen sc1
    s_mov_b64 exec, s[40:41]
    buffer_load_dwordx2 v[148:149], v3, s[16:19], s36 offen offset:1024 sc1
    s_mov_b64 exec, s[42:43]
    s_add_u32 s38, s37, 20480
    buffer_load_dwordx4 v[150:153], v187, s[16:19], s37 offen sc1
    buffer_load_dwordx4 v[154:157], v187, s[16:19], s38 offen sc1
    s_mov_b64 exec, -1
    s_waitcnt vmcnt(0)
    v_mfma_f32_32x32x16_bf16 v[72:87], v[144:147], v[120:123], 0
    v_mfma_f32_32x32x8_bf16 v[72:87], v[148:149], v[124:125], v[72:87]
    v_mfma_f32_32x32x16_bf16 v[88:103], v[144:147], v[126:129], 0
    v_mfma_f32_32x32x8_bf16 v[88:103], v[148:149], v[130:131], v[88:103]
    v_mfma_f32_32x32x16_bf16 v[192:207], v[144:147], v[132:135], 0
    v_mfma_f32_32x32x8_bf16 v[192:207], v[148:149], v[136:137], v[192:207]
    v_mfma_f32_32x32x16_bf16 v[208:223], v[144:147], v[138:141], 0
    v_mfma_f32_32x32x8_bf16 v[208:223], v[148:149], v[142:143], v[208:223]
    s_nop 15
    v_exp_f32 v72, v72
    v_exp_f32 v73, v73
    v_exp_f32 v74, v74
    v_exp_f32 v75, v75
    v_exp_f32 v76, v76
    v_exp_f32 v77, v77
    v_exp_f32 v78, v78
    v_exp_f32 v79, v79
    v_exp_f32 v80, v80
    v_exp_f32 v81, v81
    v_exp_f32 v82, v82
    v_exp_f32 v83, v83
    v_exp_f32 v84, v84
    v_exp_f32 v85, v85
    v_exp_f32 v86, v86
    v_exp_f32 v87, v87
    s_nop 0
    v_cvt_pk_bf16_f32 v72, v72, v73
    v_cvt_pk_bf16_f32 v73, v74, v75
    v_cvt_pk_bf16_f32 v74, v76, v77
    v_cvt_pk_bf16_f32 v75, v78, v79
    v_cvt_pk_bf16_f32 v76, v80, v81
    v_cvt_pk_bf16_f32 v77, v82, v83
    v_cvt_pk_bf16_f32 v78, v84, v85
    v_cvt_pk_bf16_f32 v79, v86, v87
    s_nop 1
    v_mfma_f32_32x32x16_bf16 v[8:23], v[150:153], v[72:75], v[8:23]
    v_mfma_f32_32x32x16_bf16 v[8:23], v[154:157], v[76:79], v[8:23]
    v_exp_f32 v88, v88
    v_exp_f32 v89, v89
    v_exp_f32 v90, v90
    v_exp_f32 v91, v91
    v_exp_f32 v92, v92
    v_exp_f32 v93, v93
    v_exp_f32 v94, v94
    v_exp_f32 v95, v95
    v_exp_f32 v96, v96
    v_exp_f32 v97, v97
    v_exp_f32 v98, v98
    v_exp_f32 v99, v99
    v_exp_f32 v100, v100
    v_exp_f32 v101, v101
    v_exp_f32 v102, v102
    v_exp_f32 v103, v103
    s_nop 0
    v_cvt_pk_bf16_f32 v88, v88, v89
    v_cvt_pk_bf16_f32 v89, v90, v91
    v_cvt_pk_bf16_f32 v90, v92, v93
    v_cvt_pk_bf16_f32 v91, v94, v95
    v_cvt_pk_bf16_f32 v92, v96, v97
    v_cvt_pk_bf16_f32 v93, v98, v99
    v_cvt_pk_bf16_f32 v94, v100, v101
    v_cvt_pk_bf16_f32 v95, v102, v103
    s_nop 1
    v_mfma_f32_32x32x16_bf16 v[24:39], v[150:153], v[88:91], v[24:39]
    v_mfma_f32_32x32x16_bf16 v[24:39], v[154:157], v[92:95], v[24:39]
    v_exp_f32 v192, v192
    v_exp_f32 v193, v193
    v_exp_f32 v194, v194
    v_exp_f32 v195, v195
    v_exp_f32 v196, v196
    v_exp_f32 v197, v197
    v_exp_f32 v198, v198
    v_exp_f32 v199, v199
    v_exp_f32 v200, v200
    v_exp_f32 v201, v201
    v_exp_f32 v202, v202
    v_exp_f32 v203, v203
    v_exp_f32 v204, v204
    v_exp_f32 v205, v205
    v_exp_f32 v206, v206
    v_exp_f32 v207, v207
    s_nop 0
    v_cvt_pk_bf16_f32 v192, v192, v193
    v_cvt_pk_bf16_f32 v193, v194, v195
    v_cvt_pk_bf16_f32 v194, v196, v197
    v_cvt_pk_bf16_f32 v195, v198, v199
    v_cvt_pk_bf16_f32 v196, v200, v201
    v_cvt_pk_bf16_f32 v197, v202, v203
    v_cvt_pk_bf16_f32 v198, v204, v205
    v_cvt_pk_bf16_f32 v199, v206, v207
    s_nop 1
    v_mfma_f32_32x32x16_bf16 v[40:55], v[150:153], v[192:195], v[40:55]
    v_mfma_f32_32x32x16_bf16 v[40:55], v[154:157], v[196:199], v[40:55]
    v_exp_f32 v208, v208
    v_exp_f32 v209, v209
    v_exp_f32 v210, v210
    v_exp_f32 v211, v211
    v_exp_f32 v212, v212
    v_exp_f32 v213, v213
    v_exp_f32 v214, v214
    v_exp_f32 v215, v215
    v_exp_f32 v216, v216
    v_exp_f32 v217, v217
    v_exp_f32 v218, v218
    v_exp_f32 v219, v219
    v_exp_f32 v220, v220
    v_exp_f32 v221, v221
    v_exp_f32 v222, v222
    v_exp_f32 v223, v223
    s_nop 0
    v_cvt_pk_bf16_f32 v208, v208, v209
    v_cvt_pk_bf16_f32 v209, v210, v211
    v_cvt_pk_bf16_f32 v210, v212, v213
    v_cvt_pk_bf16_f32 v211, v214, v215
    v_cvt_pk_bf16_f32 v212, v216, v217
    v_cvt_pk_bf16_f32 v213, v218, v219
    v_cvt_pk_bf16_f32 v214, v220, v221
    v_cvt_pk_bf16_f32 v215, v222, v223
    s_nop 1
    v_mfma_f32_32x32x16_bf16 v[56:71], v[150:153], v[208:211], v[56:71]
    v_mfma_f32_32x32x16_bf16 v[56:71], v[154:157], v[212:215], v[56:71]
    s_add_u32 s36, s36, 1280
    s_add_u32 s37, s37, 40960
    s_add_u32 s26, s26, 1
    s_cmp_lt_u32 s26, 32
    s_cbranch_scc1 L_slowsm
    s_nop 15
    v_cndmask_b32 v20, v16, v20, s[40:41]
    v_mov_b32 v21, v172
    v_cndmask_b32 v36, v32, v36, s[40:41]
    v_mov_b32 v37, v173
    v_cndmask_b32 v52, v48, v52, s[40:41]
    v_mov_b32 v53, v174
    v_cndmask_b32 v68, v64, v68, s[40:41]
    v_mov_b32 v69, v175
    ds_write_b128 v226, v[8:11] offset:0
    ds_write_b128 v226, v[12:15] offset:1024
    ds_write_b128 v226, v[16:19] offset:2048
    ds_write_b64 v227, v[20:21] offset:3072
    ds_write_b128 v226, v[24:27] offset:3584
    ds_write_b128 v226, v[28:31] offset:4608
    ds_write_b128 v226, v[32:35] offset:5632
    ds_write_b64 v227, v[36:37] offset:6656
    s_branch L_merge
L_rtw0:
    s_sleep 2
    buffer_load_dwordx4 v[108:111], v230, s[28:31], s36 offen offset:0 sc1
    buffer_load_dwordx4 v[112:115], v231, s[28:31], s36 offen offset:0 sc1
    s_add_u32 s46, s46, 1
    s_waitcnt vmcnt(0)
    v_max3_u32 v198, v108, v109, v110
    v_max3_u32 v199, v111, v112, v113
    v_max3_u32 v198, v198, v114, v115
    v_max_u32 v198, v198, v199
    v_cmp_eq_u32 vcc, -1, v198
    s_cmp_gt_u32 s46, 0x40000
    s_cbranch_scc1 L_rtw0x
    s_cmp_lg_u64 vcc, 0
    s_cbranch_scc1 L_rtw0
L_rtw0x:
    v_max3_u32 v198, v116, v117, v118
    v_max3_u32 v199, v119, v120, v121
    v_max3_u32 v198, v198, v122, v123
    v_max_u32 v198, v198, v199
    v_cmp_eq_u32 vcc, -1, v198
    s_nop 1
    s_cmp_eq_u64 vcc, 0
    s_cbranch_scc1 L_rtw0y1
    buffer_load_dwordx4 v[116:119], v230, s[28:31], s36 offen offset:1024 sc1
    buffer_load_dwordx4 v[120:123], v231, s[28:31], s36 offen offset:1024 sc1
L_rtw0y1:
    v_max3_u32 v198, v124, v125, v126
    v_max3_u32 v199, v127, v128, v129
    v_max3_u32 v198, v198, v130, v131
    v_max_u32 v198, v198, v199
    v_cmp_eq_u32 vcc, -1, v198
    s_nop 1
    s_cmp_eq_u64 vcc, 0
    s_cbranch_scc1 L_rtw0y2
    buffer_load_dwordx4 v[124:127], v230, s[28:31], s36 offen offset:2048 sc1
    buffer_load_dwordx4 v[128:131], v231, s[28:31], s36 offen offset:2048 sc1
L_rtw0y2:
    v_max3_u32 v198, v132, v133, v134
    v_max3_u32 v199, v135, v136, v137
    v_max3_u32 v198, v198, v138, v139
    v_max_u32 v198, v198, v199
    v_cmp_eq_u32 vcc, -1, v198
    s_nop 1
    s_cmp_eq_u64 vcc, 0
    s_cbranch_scc1 L_rtw0y3
    buffer_load_dwordx4 v[132:135], v230, s[28:31], s36 offen offset:3072 sc1
    buffer_load_dwordx4 v[136:139], v231, s[28:31], s36 offen offset:3072 sc1
L_rtw0y3:
    v_max3_u32 v198, v140, v141, v142
    v_max3_u32 v199, v143, v144, v145
    v_max3_u32 v198, v198, v146, v147
    v_max_u32 v198, v198, v199
    v_cmp_eq_u32 vcc, -1, v198
    s_nop 1
    s_cmp_eq_u64 vcc, 0
    s_cbranch_scc1 L_rtw0y4
    buffer_load_dwordx4 v[140:143], v230, s[28:31], s37 offen offset:0 sc1
    buffer_load_dwordx4 v[144:147], v231, s[28:31], s37 offen offset:0 sc1
L_rtw0y4:
    v_max3_u32 v198, v148, v149, v150
    v_max3_u32 v199, v151, v152, v153
    v_max3_u32 v198, v198, v154, v155
    v_max_u32 v198, v198, v199
    v_cmp_eq_u32 vcc, -1, v198
    s_nop 1
    s_cmp_eq_u64 vcc, 0
    s_cbranch_scc1 L_rtw0y5
    buffer_load_dwordx4 v[148:151], v230, s[28:31], s37 offen offset:1024 sc1
    buffer_load_dwordx4 v[152:155], v231, s[28:31], s37 offen offset:1024 sc1
L_rtw0y5:
    s_branch L_okw0
L_rtw1:
    s_sleep 2
    buffer_load_dwordx4 v[116:119], v230, s[28:31], s36 offen offset:1024 sc1
    buffer_load_dwordx4 v[120:123], v231, s[28:31], s36 offen offset:1024 sc1
    s_add_u32 s46, s46, 1
    s_waitcnt vmcnt(0)
    v_max3_u32 v198, v116, v117, v118
    v_max3_u32 v199, v119, v120, v121
    v_max3_u32 v198, v198, v122, v123
    v_max_u32 v198, v198, v199
    v_cmp_eq_u32 vcc, -1, v198
    s_cmp_gt_u32 s46, 0x40000
    s_cbranch_scc1 L_rtw1x
    s_cmp_lg_u64 vcc, 0
    s_cbranch_scc1 L_rtw1
L_rtw1x:
    v_max3_u32 v198, v124, v125, v126
    v_max3_u32 v199, v127, v128, v129
    v_max3_u32 v198, v198, v130, v131
    v_max_u32 v198, v198, v199
    v_cmp_eq_u32 vcc, -1, v198
    s_nop 1
    s_cmp_eq_u64 vcc, 0
    s_cbranch_scc1 L_rtw1y2
    buffer_load_dwordx4 v[124:127], v230, s[28:31], s36 offen offset:2048 sc1
    buffer_load_dwordx4 v[128:131], v231, s[28:31], s36 offen offset:2048 sc1
L_rtw1y2:
    v_max3_u32 v198, v132, v133, v134
    v_max3_u32 v199, v135, v136, v137
    v_max3_u32 v198, v198, v138, v139
    v_max_u32 v198, v198, v199
    v_cmp_eq_u32 vcc, -1, v198
    s_nop 1
    s_cmp_eq_u64 vcc, 0
    s_cbranch_scc1 L_rtw1y3
    buffer_load_dwordx4 v[132:135], v230, s[28:31], s36 offen offset:3072 sc1
    buffer_load_dwordx4 v[136:139], v231, s[28:31], s36 offen offset:3072 sc1
L_rtw1y3:
    v_max3_u32 v198, v140, v141, v142
    v_max3_u32 v199, v143, v144, v145
    v_max3_u32 v198, v198, v146, v147
    v_max_u32 v198, v198, v199
    v_cmp_eq_u32 vcc, -1, v198
    s_nop 1
    s_cmp_eq_u64 vcc, 0
    s_cbranch_scc1 L_rtw1y4
    buffer_load_dwordx4 v[140:143], v230, s[28:31], s37 offen offset:0 sc1
    buffer_load_dwordx4 v[144:147], v231, s[28:31], s37 offen offset:0 sc1
L_rtw1y4:
    v_max3_u32 v198, v148, v149, v150
    v_max3_u32 v199, v151, v152, v153
    v_max3_u32 v198, v198, v154, v155
    v_max_u32 v198, v198, v199
    v_cmp_eq_u32 vcc, -1, v198
    s_nop 1
    s_cmp_eq_u64 vcc, 0
    s_cbranch_scc1 L_rtw1y5
    buffer_load_dwordx4 v[148:151], v230, s[28:31], s37 offen offset:1024 sc1
    buffer_load_dwordx4 v[152:155], v231, s[28:31], s37 offen offset:1024 sc1
L_rtw1y5:
    v_max3_u32 v198, v156, v157, v158
    v_max3_u32 v199, v159, v160, v161
    v_max3_u32 v198, v198, v162, v163
    v_max_u32 v198, v198, v199
    v_cmp_eq_u32 vcc, -1, v198
    s_nop 1
    s_cmp_eq_u64 vcc, 0
    s_cbranch_scc1 L_rtw1y6
    buffer_load_dwordx4 v[156:159], v230, s[28:31], s37 offen offset:2048 sc1
    buffer_load_dwordx4 v[160:163], v231, s[28:31], s37 offen offset:2048 sc1
L_rtw1y6:
    s_branch L_okw1
L_rtw2:
    s_sleep 2
    buffer_load_dwordx4 v[124:127], v230, s[28:31], s36 offen offset:2048 sc1
    buffer_load_dwordx4 v[128:131], v231, s[28:31], s36 offen offset:2048 sc1
    s_add_u32 s46, s46, 1
    s_waitcnt vmcnt(0)
    v_max3_u32 v198, v124, v125, v126
    v_max3_u32 v199, v127, v128, v129
    v_max3_u32 v198, v198, v130, v131
    v_max_u32 v198, v198, v199
    v_cmp_eq_u32 vcc, -1, v198
    s_cmp_gt_u32 s46, 0x40000
    s_cbranch_scc1 L_rtw2x
    s_cmp_lg_u64 vcc, 0
    s_cbranch_scc1 L_rtw2
L_rtw2x:
    v_max3_u32 v198, v132, v133, v134
    v_max3_u32 v199, v135, v136, v137
    v_max3_u32 v198, v198, v138, v139
    v_max_u32 v198, v198, v199
    v_cmp_eq_u32 vcc, -1, v198
    s_nop 1
    s_cmp_eq_u64 vcc, 0
    s_cbranch_scc1 L_rtw2y3
    buffer_load_dwordx4 v[132:135], v230, s[28:31], s36 offen offset:3072 sc1
    buffer_load_dwordx4 v[136:139], v231, s[28:31], s36 offen offset:3072 sc1
L_rtw2y3:
    v_max3_u32 v198, v140, v141, v142
    v_max3_u32 v199, v143, v144, v145
    v_max3_u32 v198, v198, v146, v147
    v_max_u32 v198, v198, v199
    v_cmp_eq_u32 vcc, -1, v198
    s_nop 1
    s_cmp_eq_u64 vcc, 0
    s_cbranch_scc1 L_rtw2y4
    buffer_load_dwordx4 v[140:143], v230, s[28:31], s37 offen offset:0 sc1
    buffer_load_dwordx4 v[144:147], v231, s[28:31], s37 offen offset:0 sc1
L_rtw2y4:
    v_max3_u32 v198, v148, v149, v150
    v_max3_u32 v199, v151, v152, v153
    v_max3_u32 v198, v198, v154, v155
    v_max_u32 v198, v198, v199
    v_cmp_eq_u32 vcc, -1, v198
    s_nop 1
    s_cmp_eq_u64 vcc, 0
    s_cbranch_scc1 L_rtw2y5
    buffer_load_dwordx4 v[148:151], v230, s[28:31], s37 offen offset:1024 sc1
    buffer_load_dwordx4 v[152:155], v231, s[28:31], s37 offen offset:1024 sc1
L_rtw2y5:
    v_max3_u32 v198, v156, v157, v158
    v_max3_u32 v199, v159, v160, v161
    v_max3_u32 v198, v198, v162, v163
    v_max_u32 v198, v198, v199
    v_cmp_eq_u32 vcc, -1, v198
    s_nop 1
    s_cmp_eq_u64 vcc, 0
    s_cbranch_scc1 L_rtw2y6
    buffer_load_dwordx4 v[156:159], v230, s[28:31], s37 offen offset:2048 sc1
    buffer_load_dwordx4 v[160:163], v231, s[28:31], s37 offen offset:2048 sc1
L_rtw2y6:
    v_max3_u32 v198, v164, v165, v166
    v_max3_u32 v199, v167, v168, v169
    v_max3_u32 v198, v198, v170, v171
    v_max_u32 v198, v198, v199
    v_cmp_eq_u32 vcc, -1, v198
    s_nop 1
    s_cmp_eq_u64 vcc, 0
    s_cbranch_scc1 L_rtw2y7
    buffer_load_dwordx4 v[164:167], v230, s[28:31], s37 offen offset:3072 sc1
    buffer_load_dwordx4 v[168:171], v231, s[28:31], s37 offen offset:3072 sc1
L_rtw2y7:
    s_branch L_okw2
L_rtw3:
    s_sleep 2
    buffer_load_dwordx4 v[132:135], v230, s[28:31], s36 offen offset:3072 sc1
    buffer_load_dwordx4 v[136:139], v231, s[28:31], s36 offen offset:3072 sc1
    s_add_u32 s46, s46, 1
    s_waitcnt vmcnt(0)
    v_max3_u32 v198, v132, v133, v134
    v_max3_u32 v199, v135, v136, v137
    v_max3_u32 v198, v198, v138, v139
    v_max_u32 v198, v198, v199
    v_cmp_eq_u32 vcc, -1, v198
    s_cmp_gt_u32 s46, 0x40000
    s_cbranch_scc1 L_rtw3x
    s_cmp_lg_u64 vcc, 0
    s_cbranch_scc1 L_rtw3
L_rtw3x:
    v_max3_u32 v198, v140, v141, v142
    v_max3_u32 v199, v143, v144, v145
    v_max3_u32 v198, v198, v146, v147
    v_max_u32 v198, v198, v199
    v_cmp_eq_u32 vcc, -1, v198
    s_nop 1
    s_cmp_eq_u64 vcc, 0
    s_cbranch_scc1 L_rtw3y4
    buffer_load_dwordx4 v[140:143], v230, s[28:31], s37 offen offset:0 sc1
    buffer_load_dwordx4 v[144:147], v231, s[28:31], s37 offen offset:0 sc1
L_rtw3y4:
    v_max3_u32 v198, v148, v149, v150
    v_max3_u32 v199, v151, v152, v153
    v_max3_u32 v198, v198, v154, v155
    v_max_u32 v198, v198, v199
    v_cmp_eq_u32 vcc, -1, v198
    s_nop 1
    s_cmp_eq_u64 vcc, 0
    s_cbranch_scc1 L_rtw3y5
    buffer_load_dwordx4 v[148:151], v230, s[28:31], s37 offen offset:1024 sc1
    buffer_load_dwordx4 v[152:155], v231, s[28:31], s37 offen offset:1024 sc1
L_rtw3y5:
    v_max3_u32 v198, v156, v157, v158
    v_max3_u32 v199, v159, v160, v161
    v_max3_u32 v198, v198, v162, v163
    v_max_u32 v198, v198, v199
    v_cmp_eq_u32 vcc, -1, v198
    s_nop 1
    s_cmp_eq_u64 vcc, 0
    s_cbranch_scc1 L_rtw3y6
    buffer_load_dwordx4 v[156:159], v230, s[28:31], s37 offen offset:2048 sc1
    buffer_load_dwordx4 v[160:163], v231, s[28:31], s37 offen offset:2048 sc1
L_rtw3y6:
    v_max3_u32 v198, v164, v165, v166
    v_max3_u32 v199, v167, v168, v169
    v_max3_u32 v198, v198, v170, v171
    v_max_u32 v198, v198, v199
    v_cmp_eq_u32 vcc, -1, v198
    s_nop 1
    s_cmp_eq_u64 vcc, 0
    s_cbranch_scc1 L_rtw3y7
    buffer_load_dwordx4 v[164:167], v230, s[28:31], s37 offen offset:3072 sc1
    buffer_load_dwordx4 v[168:171], v231, s[28:31], s37 offen offset:3072 sc1
L_rtw3y7:
    v_max3_u32 v198, v108, v109, v110
    v_max3_u32 v199, v111, v112, v113
    v_max3_u32 v198, v198, v114, v115
    v_max_u32 v198, v198, v199
    v_cmp_eq_u32 vcc, -1, v198
    s_nop 1
    s_cmp_eq_u64 vcc, 0
    s_cbranch_scc1 L_rtw3y8
    buffer_load_dwordx2 v[108:109], v232, s[28:31], s38 offen offset:0 sc1
    buffer_load_dwordx2 v[110:111], v232, s[28:31], s38 offen offset:256 sc1
    buffer_load_dwordx2 v[112:113], v233, s[28:31], s38 offen offset:0 sc1
    buffer_load_dwordx2 v[114:115], v233, s[28:31], s38 offen offset:256 sc1
L_rtw3y8:
    s_branch L_okw3
L_rtw4:
    s_sleep 2
    buffer_load_dwordx4 v[140:143], v230, s[28:31], s37 offen offset:0 sc1
    buffer_load_dwordx4 v[144:147], v231, s[28:31], s37 offen offset:0 sc1
    s_add_u32 s46, s46, 1
    s_waitcnt vmcnt(0)
    v_max3_u32 v198, v140, v141, v142
    v_max3_u32 v199, v143, v144, v145
    v_max3_u32 v198, v198, v146, v147
    v_max_u32 v198, v198, v199
    v_cmp_eq_u32 vcc, -1, v198
    s_cmp_gt_u32 s46, 0x40000
    s_cbranch_scc1 L_rtw4x
    s_cmp_lg_u64 vcc, 0
    s_cbranch_scc1 L_rtw4
L_rtw4x:
    v_max3_u32 v198, v148, v149, v150
    v_max3_u32 v199, v151, v152, v153
    v_max3_u32 v198, v198, v154, v155
    v_max_u32 v198, v198, v199
    v_cmp_eq_u32 vcc, -1, v198
    s_nop 1
    s_cmp_eq_u64 vcc, 0
    s_cbranch_scc1 L_rtw4y5
    buffer_load_dwordx4 v[148:151], v230, s[28:31], s37 offen offset:1024 sc1
    buffer_load_dwordx4 v[152:155], v231, s[28:31], s37 offen offset:1024 sc1
L_rtw4y5:
    v_max3_u32 v198, v156, v157, v158
    v_max3_u32 v199, v159, v160, v161
    v_max3_u32 v198, v198, v162, v163
    v_max_u32 v198, v198, v199
    v_cmp_eq_u32 vcc, -1, v198
    s_nop 1
    s_cmp_eq_u64 vcc, 0
    s_cbranch_scc1 L_rtw4y6
    buffer_load_dwordx4 v[156:159], v230, s[28:31], s37 offen offset:2048 sc1
    buffer_load_dwordx4 v[160:163], v231, s[28:31], s37 offen offset:2048 sc1
L_rtw4y6:
    v_max3_u32 v198, v164, v165, v166
    v_max3_u32 v199, v167, v168, v169
    v_max3_u32 v198, v198, v170, v171
    v_max_u32 v198, v198, v199
    v_cmp_eq_u32 vcc, -1, v198
    s_nop 1
    s_cmp_eq_u64 vcc, 0
    s_cbranch_scc1 L_rtw4y7
    buffer_load_dwordx4 v[164:167], v230, s[28:31], s37 offen offset:3072 sc1
    buffer_load_dwordx4 v[168:171], v231, s[28:31], s37 offen offset:3072 sc1
L_rtw4y7:
    v_max3_u32 v198, v108, v109, v110
    v_max3_u32 v199, v111, v112, v113
    v_max3_u32 v198, v198, v114, v115
    v_max_u32 v198, v198, v199
    v_cmp_eq_u32 vcc, -1, v198
    s_nop 1
    s_cmp_eq_u64 vcc, 0
    s_cbranch_scc1 L_rtw4y8
    buffer_load_dwordx2 v[108:109], v232, s[28:31], s38 offen offset:0 sc1
    buffer_load_dwordx2 v[110:111], v232, s[28:31], s38 offen offset:256 sc1
    buffer_load_dwordx2 v[112:113], v233, s[28:31], s38 offen offset:0 sc1
    buffer_load_dwordx2 v[114:115], v233, s[28:31], s38 offen offset:256 sc1
L_rtw4y8:
    v_max3_u32 v198, v116, v117, v118
    v_max3_u32 v199, v119, v120, v121
    v_max3_u32 v198, v198, v122, v123
    v_max_u32 v198, v198, v199
    v_cmp_eq_u32 vcc, -1, v198
    s_nop 1
    s_cmp_eq_u64 vcc, 0
    s_cbranch_scc1 L_rtw4y9
    buffer_load_dwordx2 v[116:117], v232, s[28:31], s39 offen offset:0 sc1
    buffer_load_dwordx2 v[118:119], v232, s[28:31], s39 offen offset:256 sc1
    buffer_load_dwordx2 v[120:121], v233, s[28:31], s39 offen offset:0 sc1
    buffer_load_dwordx2 v[122:123], v233, s[28:31], s39 offen offset:256 sc1
L_rtw4y9:
    s_branch L_okw4
L_rtw5:
    s_sleep 2
    buffer_load_dwordx4 v[148:151], v230, s[28:31], s37 offen offset:1024 sc1
    buffer_load_dwordx4 v[152:155], v231, s[28:31], s37 offen offset:1024 sc1
    s_add_u32 s46, s46, 1
    s_waitcnt vmcnt(0)
    v_max3_u32 v198, v148, v149, v150
    v_max3_u32 v199, v151, v152, v153
    v_max3_u32 v198, v198, v154, v155
    v_max_u32 v198, v198, v199
    v_cmp_eq_u32 vcc, -1, v198
    s_cmp_gt_u32 s46, 0x40000
    s_cbranch_scc1 L_rtw5x
    s_cmp_lg_u64 vcc, 0
    s_cbranch_scc1 L_rtw5
L_rtw5x:
    v_max3_u32 v198, v156, v157, v158
    v_max3_u32 v199, v159, v160, v161
    v_max3_u32 v198, v198, v162, v163
    v_max_u32 v198, v198, v199
    v_cmp_eq_u32 vcc, -1, v198
    s_nop 1
    s_cmp_eq_u64 vcc, 0
    s_cbranch_scc1 L_rtw5y6
    buffer_load_dwordx4 v[156:159], v230, s[28:31], s37 offen offset:2048 sc1
    buffer_load_dwordx4 v[160:163], v231, s[28:31], s37 offen offset:2048 sc1
L_rtw5y6:
    v_max3_u32 v198, v164, v165, v166
    v_max3_u32 v199, v167, v168, v169
    v_max3_u32 v198, v198, v170, v171
    v_max_u32 v198, v198, v199
    v_cmp_eq_u32 vcc, -1, v198
    s_nop 1
    s_cmp_eq_u64 vcc, 0
    s_cbranch_scc1 L_rtw5y7
    buffer_load_dwordx4 v[164:167], v230, s[28:31], s37 offen offset:3072 sc1
    buffer_load_dwordx4 v[168:171], v231, s[28:31], s37 offen offset:3072 sc1
L_rtw5y7:
    v_max3_u32 v198, v108, v109, v110
    v_max3_u32 v199, v111, v112, v113
    v_max3_u32 v198, v198, v114, v115
    v_max_u32 v198, v198, v199
    v_cmp_eq_u32 vcc, -1, v198
    s_nop 1
    s_cmp_eq_u64 vcc, 0
    s_cbranch_scc1 L_rtw5y8
    buffer_load_dwordx2 v[108:109], v232, s[28:31], s38 offen offset:0 sc1
    buffer_load_dwordx2 v[110:111], v232, s[28:31], s38 offen offset:256 sc1
    buffer_load_dwordx2 v[112:113], v233, s[28:31], s38 offen offset:0 sc1
    buffer_load_dwordx2 v[114:115], v233, s[28:31], s38 offen offset:256 sc1
L_rtw5y8:
    v_max3_u32 v198, v116, v117, v118
    v_max3_u32 v199, v119, v120, v121
    v_max3_u32 v198, v198, v122, v123
    v_max_u32 v198, v198, v199
    v_cmp_eq_u32 vcc, -1, v198
    s_nop 1
    s_cmp_eq_u64 vcc, 0
    s_cbranch_scc1 L_rtw5y9
    buffer_load_dwordx2 v[116:117], v232, s[28:31], s39 offen offset:0 sc1
    buffer_load_dwordx2 v[118:119], v232, s[28:31], s39 offen offset:256 sc1
    buffer_load_dwordx2 v[120:121], v233, s[28:31], s39 offen offset:0 sc1
    buffer_load_dwordx2 v[122:123], v233, s[28:31], s39 offen offset:256 sc1
L_rtw5y9:
    s_branch L_okw5
L_rtw6:
    s_sleep 2
    buffer_load_dwordx4 v[156:159], v230, s[28:31], s37 offen offset:2048 sc1
    buffer_load_dwordx4 v[160:163], v231, s[28:31], s37 offen offset:2048 sc1
    s_add_u32 s46, s46, 1
    s_waitcnt vmcnt(0)
    v_max3_u32 v198, v156, v157, v158
    v_max3_u32 v199, v159, v160, v161
    v_max3_u32 v198, v198, v162, v163
    v_max_u32 v198, v198, v199
    v_cmp_eq_u32 vcc, -1, v198
    s_cmp_gt_u32 s46, 0x40000
    s_cbranch_scc1 L_rtw6x
    s_cmp_lg_u64 vcc, 0
    s_cbranch_scc1 L_rtw6
L_rtw6x:
    v_max3_u32 v198, v164, v165, v166
    v_max3_u32 v199, v167, v168, v169
    v_max3_u32 v198, v198, v170, v171
    v_max_u32 v198, v198, v199
    v_cmp_eq_u32 vcc, -1, v198
    s_nop 1
    s_cmp_eq_u64 vcc, 0
    s_cbranch_scc1 L_rtw6y7
    buffer_load_dwordx4 v[164:167], v230, s[28:31], s37 offen offset:3072 sc1
    buffer_load_dwordx4 v[168:171], v231, s[28:31], s37 offen offset:3072 sc1
L_rtw6y7:
    v_max3_u32 v198, v108, v109, v110
    v_max3_u32 v199, v111, v112, v113
    v_max3_u32 v198, v198, v114, v115
    v_max_u32 v198, v198, v199
    v_cmp_eq_u32 vcc, -1, v198
    s_nop 1
    s_cmp_eq_u64 vcc, 0
    s_cbranch_scc1 L_rtw6y8
    buffer_load_dwordx2 v[108:109], v232, s[28:31], s38 offen offset:0 sc1
    buffer_load_dwordx2 v[110:111], v232, s[28:31], s38 offen offset:256 sc1
    buffer_load_dwordx2 v[112:113], v233, s[28:31], s38 offen offset:0 sc1
    buffer_load_dwordx2 v[114:115], v233, s[28:31], s38 offen offset:256 sc1
L_rtw6y8:
    v_max3_u32 v198, v116, v117, v118
    v_max3_u32 v199, v119, v120, v121
    v_max3_u32 v198, v198, v122, v123
    v_max_u32 v198, v198, v199
    v_cmp_eq_u32 vcc, -1, v198
    s_nop 1
    s_cmp_eq_u64 vcc, 0
    s_cbranch_scc1 L_rtw6y9
    buffer_load_dwordx2 v[116:117], v232, s[28:31], s39 offen offset:0 sc1
    buffer_load_dwordx2 v[118:119], v232, s[28:31], s39 offen offset:256 sc1
    buffer_load_dwordx2 v[120:121], v233, s[28:31], s39 offen offset:0 sc1
    buffer_load_dwordx2 v[122:123], v233, s[28:31], s39 offen offset:256 sc1
L_rtw6y9:
    s_branch L_okw6
L_rtw7:
    s_sleep 2
    buffer_load_dwordx4 v[164:167], v230, s[28:31], s37 offen offset:3072 sc1
    buffer_load_dwordx4 v[168:171], v231, s[28:31], s37 offen offset:3072 sc1
    s_add_u32 s46, s46, 1
    s_waitcnt vmcnt(0)
    v_max3_u32 v198, v164, v165, v166
    v_max3_u32 v199, v167, v168, v169
    v_max3_u32 v198, v198, v170, v171
    v_max_u32 v198, v198, v199
    v_cmp_eq_u32 vcc, -1, v198
    s_cmp_gt_u32 s46, 0x40000
    s_cbranch_scc1 L_rtw7x
    s_cmp_lg_u64 vcc, 0
    s_cbranch_scc1 L_rtw7
L_rtw7x:
    v_max3_u32 v198, v108, v109, v110
    v_max3_u32 v199, v111, v112, v113
    v_max3_u32 v198, v198, v114, v115
    v_max_u32 v198, v198, v199
    v_cmp_eq_u32 vcc, -1, v198
    s_nop 1
    s_cmp_eq_u64 vcc, 0
    s_cbranch_scc1 L_rtw7y8
    buffer_load_dwordx2 v[108:109], v232, s[28:31], s38 offen offset:0 sc1
    buffer_load_dwordx2 v[110:111], v232, s[28:31], s38 offen offset:256 sc1
    buffer_load_dwordx2 v[112:113], v233, s[28:31], s38 offen offset:0 sc1
    buffer_load_dwordx2 v[114:115], v233, s[28:31], s38 offen offset:256 sc1
L_rtw7y8:
    v_max3_u32 v198, v116, v117, v118
    v_max3_u32 v199, v119, v120, v121
    v_max3_u32 v198, v198, v122, v123
    v_max_u32 v198, v198, v199
    v_cmp_eq_u32 vcc, -1, v198
    s_nop 1
    s_cmp_eq_u64 vcc, 0
    s_cbranch_scc1 L_rtw7y9
    buffer_load_dwordx2 v[116:117], v232, s[28:31], s39 offen offset:0 sc1
    buffer_load_dwordx2 v[118:119], v232, s[28:31], s39 offen offset:256 sc1
    buffer_load_dwordx2 v[120:121], v233, s[28:31], s39 offen offset:0 sc1
    buffer_load_dwordx2 v[122:123], v233, s[28:31], s39 offen offset:256 sc1
L_rtw7y9:
    s_branch L_okw7
L_rtw8:
    s_sleep 2
    buffer_load_dwordx2 v[108:109], v232, s[28:31], s38 offen offset:0 sc1
    buffer_load_dwordx2 v[110:111], v232, s[28:31], s38 offen offset:256 sc1
    buffer_load_dwordx2 v[112:113], v233, s[28:31], s38 offen offset:0 sc1
    buffer_load_dwordx2 v[114:115], v233, s[28:31], s38 offen offset:256 sc1
    s_add_u32 s46, s46, 1
    s_waitcnt vmcnt(0)
    v_max3_u32 v198, v108, v109, v110
    v_max3_u32 v199, v111, v112, v113
    v_max3_u32 v198, v198, v114, v115
    v_max_u32 v198, v198, v199
    v_cmp_eq_u32 vcc, -1, v198
    s_cmp_gt_u32 s46, 0x40000
    s_cbranch_scc1 L_rtw8x
    s_cmp_lg_u64 vcc, 0
    s_cbranch_scc1 L_rtw8
L_rtw8x:
    v_max3_u32 v198, v116, v117, v118
    v_max3_u32 v199, v119, v120, v121
    v_max3_u32 v198, v198, v122, v123
    v_max_u32 v198, v198, v199
    v_cmp_eq_u32 vcc, -1, v198
    s_nop 1
    s_cmp_eq_u64 vcc, 0
    s_cbranch_scc1 L_rtw8y9
    buffer_load_dwordx2 v[116:117], v232, s[28:31], s39 offen offset:0 sc1
    buffer_load_dwordx2 v[118:119], v232, s[28:31], s39 offen offset:256 sc1
    buffer_load_dwordx2 v[120:121], v233, s[28:31], s39 offen offset:0 sc1
    buffer_load_dwordx2 v[122:123], v233, s[28:31], s39 offen offset:256 sc1
L_rtw8y9:
    s_branch L_okw8
L_rtw9:
    s_sleep 2
    buffer_load_dwordx2 v[116:117], v232, s[28:31], s39 offen offset:0 sc1
    buffer_load_dwordx2 v[118:119], v232, s[28:31], s39 offen offset:256 sc1
    buffer_load_dwordx2 v[120:121], v233, s[28:31], s39 offen offset:0 sc1
    buffer_load_dwordx2 v[122:123], v233, s[28:31], s39 offen offset:256 sc1
    s_add_u32 s46, s46, 1
    s_waitcnt vmcnt(0)
    v_max3_u32 v198, v116, v117, v118
    v_max3_u32 v199, v119, v120, v121
    v_max3_u32 v198, v198, v122, v123
    v_max_u32 v198, v198, v199
    v_cmp_eq_u32 vcc, -1, v198
    s_cmp_gt_u32 s46, 0x40000
    s_cbranch_scc1 L_rtw9x
    s_cmp_lg_u64 vcc, 0
    s_cbranch_scc1 L_rtw9
L_rtw9x:
    s_branch L_okw9
L_end:
    s_endpgm
.section .rodata,"a"
.p2align 6
.amdhsa_kernel sequential_preLN__softmax_full_mha__glu_gated_glu__prompt_kernel
  .amdhsa_next_free_vgpr 256
  .amdhsa_next_free_sgpr 102
  .amdhsa_accum_offset 256
  .amdhsa_group_segment_fixed_size 0
  .amdhsa_kernarg_size 80
  .amdhsa_user_sgpr_count 2
  .amdhsa_user_sgpr_kernarg_segment_ptr 1
  .amdhsa_system_sgpr_workgroup_id_x 1
.end_amdhsa_kernel
```
